```python
import torch

def _softmax(x, axis=-1):
    return torch.softmax(x, dim=axis)
def _gelu(x):
    return torch.nn.functional.gelu(x, approximate="tanh")
def _silu(x):
    return torch.nn.functional.silu(x)
def _sigmoid(x):
    return torch.sigmoid(x)
def _layernorm(x, axis=-1, eps=1e-5):
    m = x.mean(dim=axis, keepdim=True)
    v = x.var(dim=axis, keepdim=True, unbiased=False)
    return (x - m) / torch.sqrt(v + eps)
def _scatter_add(tgt, idx, src, axis=0):
    return tgt.clone().index_add_(axis, idx, src)
def _segment_sum(src, seg, n):
    out = torch.zeros((n,) + src.shape[1:], dtype=src.dtype)
    return out.index_add_(0, seg, src)
def _pad(x, pw):
    flat = tuple(v for pair in reversed(pw) for v in pair)
    return torch.nn.functional.pad(x, flat)

kernel_name = 'interleave_layers__sliding_block__dense_activation_silu__prompt'

def setup_inputs():

    _w = (lambda a: (lambda t: t.to(torch.bfloat16) if t.is_floating_point() else t)(torch.as_tensor(a)))
    def _A_setup():
        B, S, D = 1, 2048, 512
        return {
            "x": _w((lambda *s: torch.randn(*s, dtype=torch.bfloat16) * 0.05)(B, S, D)),
            "wqkv": _w((lambda *s: torch.randn(*s, dtype=torch.bfloat16) * 0.05)(D, 3 * D)),
            "wo": _w((lambda *s: torch.randn(*s, dtype=torch.bfloat16) * 0.05)(D, D)),
        }
    _A_in = _A_setup()

    def _B_setup():
        B, S, D, F = 1, 2048, 512, 1792
        return {
            "x": _w((lambda *s: torch.randn(*s, dtype=torch.bfloat16) * 0.05)(B, S, D)),
            "w1": _w((lambda *s: torch.randn(*s, dtype=torch.bfloat16) * 0.8)(D, F) * (D ** -0.5)),
            "w2": _w((lambda *s: torch.randn(*s, dtype=torch.bfloat16) * 0.8)(F, D) * (F ** -0.5)),
        }
    _B_in = _B_setup()

    return {
        "A_x": _A_in["x"],
        "A_wqkv": _A_in["wqkv"],
        "A_wo": _A_in["wo"],
        "B_x": _B_in["x"],
        "B_w1": _B_in["w1"],
        "B_w2": _B_in["w2"],
    }

def reference(A_x, A_wqkv, A_wo, B_x, B_w1, B_w2):
    def _A_ref(x, wqkv, wo):
        B, S, D = x.shape
        H = 32; Dh = D // H; W = 256
        qkv = (lambda x, *d: x.permute(*d))((x @ wqkv).reshape(B, S, 3, H, Dh), 2, 0, 3, 1, 4)
        q, k, v = qkv[0], qkv[1], qkv[2]
        scores = torch.einsum("bhqd,bhkd->bhqk", q, k) * (Dh ** -0.5)
        idx = torch.arange(S)
        mask = (idx[:, None] - idx[None, :] >= 0) & (idx[:, None] - idx[None, :] < W)
        scores = torch.where(mask[None, None], scores, -1e9)
        p = _softmax(scores, axis=-1)
        o = torch.einsum("bhqk,bhkd->bhqd", p, v)
        return (lambda x, *d: x.permute(*d))(o, 0, 2, 1, 3).reshape(B, S, D) @ wo

    def _B_ref(x, w1, w2):
        h = torch.einsum("bsd,df->bsf", x, w1)
        h = _silu(h)
        out = torch.einsum("bsf,fd->bsd", h, w2)
        return out

    x = A_x
    x = x + _A_ref(_layernorm(x, axis=-1), A_wqkv, A_wo)
    x = x + _B_ref(_layernorm(x, axis=-1), B_w1, B_w2)
    x = x + _A_ref(_layernorm(x, axis=-1), A_wqkv, A_wo)
    x = x + _B_ref(_layernorm(x, axis=-1), B_w1, B_w2)
    return x
```

```asm
; @launch grid=(256,1,1) block=(256,1,1) lds=163840
.amdgcn_target "amdgcn-amd-amdhsa--gfx950"
.text
.globl interleave_layers__sliding_block__dense_activation_silu__prompt_kernel
.p2align 8
.type interleave_layers__sliding_block__dense_activation_silu__prompt_kernel,@function
interleave_layers__sliding_block__dense_activation_silu__prompt_kernel:
    s_cmp_ge_u32 s2, 256
    s_cbranch_scc1 L_exit
    s_load_dwordx2 s[8:9], s[0:1], 0
    s_load_dwordx2 s[12:13], s[0:1], 8
    s_load_dwordx2 s[4:5], s[0:1], 64
    s_load_dwordx2 s[16:17], s[0:1], 16
    s_load_dwordx2 s[20:21], s[0:1], 32
    s_load_dwordx2 s[24:25], s[0:1], 40
    s_load_dwordx2 s[28:29], s[0:1], 48
    s_load_dwordx2 s[32:33], s[0:1], 56
    s_getpc_b64 s[96:97]
    v_lshrrev_b32 v12, 4, v0
    s_lshr_b32 s49, s2, 3
    s_lshl_b32 s49, s49, 11
    v_lshl_add_u32 v12, v12, 7, s49
    v_min_u32 v12, (L_codeend-L_pcref), v12
L_pcref:
    global_load_dword a36, v12, s[96:97]
    v_lshrrev_b32 v12, 6, v0
    v_and_b32 v0, 63, v0
    v_readfirstlane_b32 s38, v12
    v_lshlrev_b32 v1, 4, v0
    s_and_b32 s42, s2, 7
    s_lshl_b32 s42, s42, 1
    s_bfe_u32 s43, s2, 0x10003
    s_or_b32 s36, s42, s43
    s_lshr_b32 s37, s2, 4
    s_and_b32 s40, s37, 1
    s_lshr_b32 s41, s37, 1
    s_lshl2_add_u32 s52, s36, s38
    s_lshl_b32 s50, s36, 13
    s_lshl_b32 s53, s40, 1
    s_and_b32 s43, s36, 1
    s_lshl2_add_u32 s53, s43, s53
    s_mov_b32 s10, 2097152
    s_mov_b32 s11, 0x20000
    s_mov_b32 s14, 1572864
    s_mov_b32 s15, 0x20000
    s_mov_b32 s6, 268435456
    s_mov_b32 s7, 0x20000
    v_bfe_u32 v21, v0, 2, 3
    v_lshlrev_b32 v20, 10, v21
    v_lshrrev_b32 v22, 5, v0
    v_lshl_add_u32 v20, v22, 6, v20
    v_and_b32 v22, 3, v0
    v_lshrrev_b32 v23, 2, v21
    v_xor_b32 v22, v22, v23
    v_lshl_add_u32 v224, v22, 4, v20
    v_xor_b32 v22, 2, v22
    v_lshl_add_u32 v225, v22, 4, v20
    v_add_u32 v226, 14336, v224
    v_add_u32 v227, 21504, v225
    v_add_u32 v225, 7168, v225
    s_lshl_b32 s54, s52, 15
    s_mul_i32 s57, s38, 12288
    s_add_u32 s57, s57, 98304
    v_lshrrev_b32 v228, 2, v0
    v_mul_u32_u24 v228, 3072, v228
    v_and_b32 v20, 3, v0
    v_lshl_add_u32 v228, v20, 4, v228
    s_mul_i32 s58, s38, 49152
    s_lshl_b32 s47, s37, 6
    s_add_u32 s58, s58, s47
    v_min_u32 v20, 15, v0
    v_lshlrev_b32 v20, 7, v20
    v_min_u32 v21, 1408, v20
    s_lshl2_add_u32 s42, s37, s38
    s_lshl_b32 s42, s42, 11
    s_lshl_b32 s43, s36, 17
    s_add_u32 s42, s42, s43
    s_lshl2_add_u32 s43, s2, s38
    s_mul_i32 s43, s43, 1536
    s_waitcnt lgkmcnt(0)
    s_and_b32 s1, s53, 2
    s_lshl2_add_u32 s44, s37, s38
    s_cmp_eq_u32 s44, 3
    s_cbranch_scc0 Lnolead_1
    v_mov_b32 v24, 0
    v_mov_b32 v25, 0
    v_mov_b32 v26, 0
    v_mov_b32 v27, 0
    s_add_u32 s44, s50, 4096
    buffer_store_dwordx4 v[24:27], v1, s[4:7], s50 offen offset:0 sc1
    buffer_store_dwordx4 v[24:27], v1, s[4:7], s50 offen offset:1024 sc1
    buffer_store_dwordx4 v[24:27], v1, s[4:7], s50 offen offset:2048 sc1
    buffer_store_dwordx4 v[24:27], v1, s[4:7], s44 offen offset:0 sc1
    buffer_store_dwordx4 v[24:27], v1, s[4:7], s44 offen offset:1024 sc1
    buffer_store_dwordx4 v[24:27], v1, s[4:7], s44 offen offset:2048 sc1
    buffer_store_dwordx4 v[24:27], v1, s[4:7], s44 offen offset:3072 sc1
Lnolead_1:
    s_mul_i32 s0, s38, 3072
    buffer_load_dword a32, v21, s[12:15], s43 offen
    buffer_load_dword a33, v20, s[8:11], s42 offen
    s_xor_b32 s55, s1, 0
    s_add_u32 m0, s57, 0
    s_lshl_b32 s56, s55, 7
    s_add_u32 s56, s56, s54
    buffer_load_dwordx4 v224, s[8:11], s56 offen offset:0 lds
    buffer_load_dwordx4 v225, s[8:11], s56 offen offset:1024 lds
    buffer_load_dwordx4 v226, s[8:11], s56 offen offset:2048 lds
    buffer_load_dwordx4 v227, s[8:11], s56 offen offset:3072 lds
    s_xor_b32 s101, s1, 0
    s_mul_i32 s101, s101, 196608
    s_add_u32 m0, s0, 0
    s_add_u32 s101, s101, s58
    buffer_load_dwordx4 v228, s[12:15], s101 offen offset:1024 lds
    buffer_load_dwordx4 v228, s[12:15], s101 offen offset:2048 lds
    buffer_load_dwordx4 v228, s[12:15], s101 offen offset:0 lds
    s_getreg_b32 s51, hwreg(HW_REG_XCC_ID)
    s_and_b32 s51, s51, 15
    s_mov_b32 s39, 0
    s_and_b32 s3, s38, 1
    s_lshl1_add_u32 s3, s3, s40
    s_lshl3_add_u32 s3, s3, s41
    s_lshl2_add_u32 s3, s3, s50
    s_cmp_lt_u32 s38, 2
    s_cselect_b32 s3, s3, 0x70000000
    s_mov_b32 s18, 524288
    s_mov_b32 s19, 0x20000
    s_mov_b32 s22, 1835008
    s_mov_b32 s23, 0x20000
    s_mov_b32 s26, 1835008
    s_mov_b32 s27, 0x20000
    s_mov_b32 s30, 2097152
    s_mov_b32 s31, 0x20000
    s_mov_b32 s34, 256
    s_mov_b32 s35, 0x20000
    v_lshrrev_b32 v12, 5, v0
    v_lshlrev_b32 v2, 9, v12
    v_bfe_u32 v12, v0, 2, 2
    v_lshl_add_u32 v2, v12, 6, v2
    v_bfe_u32 v12, v0, 4, 1
    v_lshl_add_u32 v2, v12, 5, v2
    v_and_b32 v12, 1, v0
    v_lshl_add_u32 v2, v12, 4, v2
    v_bfe_u32 v12, v0, 1, 1
    v_lshl_add_u32 v2, v12, 3, v2
    v_and_b32 v12, 31, v0
    v_lshrrev_b32 v13, 5, v0
    v_lshlrev_b32 v13, 2, v13
    v_sub_u32 v12, v12, v13
    v_cmp_le_i32 s[60:61], 0, v12
    v_cmp_le_i32 s[62:63], 1, v12
    v_cmp_le_i32 s[64:65], 2, v12
    v_cmp_le_i32 s[66:67], 3, v12
    v_cmp_le_i32 s[68:69], 8, v12
    v_cmp_le_i32 s[70:71], 9, v12
    v_cmp_le_i32 s[72:73], 10, v12
    v_cmp_le_i32 s[74:75], 11, v12
    v_cmp_le_i32 s[76:77], 16, v12
    v_cmp_le_i32 s[78:79], 17, v12
    v_cmp_le_i32 s[80:81], 18, v12
    v_cmp_le_i32 s[82:83], 19, v12
    v_cmp_le_i32 s[84:85], 24, v12
    v_cmp_le_i32 s[86:87], 25, v12
    v_cmp_le_i32 s[88:89], 26, v12
    v_cmp_le_i32 s[90:91], 27, v12
    v_mov_b32 v12, 0xffff
    v_mov_b32 v13, 0xffff0000
    v_cndmask_b32 v32, 0, v12, s[60:61]
    v_cndmask_b32 v14, 0, v13, s[62:63]
    v_or_b32 v32, v32, v14
    v_cndmask_b32 v33, 0, v12, s[64:65]
    v_cndmask_b32 v14, 0, v13, s[66:67]
    v_or_b32 v33, v33, v14
    v_cndmask_b32 v34, 0, v12, s[68:69]
    v_cndmask_b32 v14, 0, v13, s[70:71]
    v_or_b32 v34, v34, v14
    v_cndmask_b32 v35, 0, v12, s[72:73]
    v_cndmask_b32 v14, 0, v13, s[74:75]
    v_or_b32 v35, v35, v14
    v_cndmask_b32 v36, 0, v12, s[76:77]
    v_cndmask_b32 v14, 0, v13, s[78:79]
    v_or_b32 v36, v36, v14
    v_cndmask_b32 v37, 0, v12, s[80:81]
    v_cndmask_b32 v14, 0, v13, s[82:83]
    v_or_b32 v37, v37, v14
    v_cndmask_b32 v38, 0, v12, s[84:85]
    v_cndmask_b32 v14, 0, v13, s[86:87]
    v_or_b32 v38, v38, v14
    v_cndmask_b32 v39, 0, v12, s[88:89]
    v_cndmask_b32 v14, 0, v13, s[90:91]
    v_or_b32 v39, v39, v14
    v_add_u32 v12, 154880, v1
    ds_write_b128 v12, v[32:35]
    ds_write_b128 v12, v[36:39] offset:1024
    v_bfe_u32 v21, v0, 3, 2
    v_lshlrev_b32 v229, 10, v21
    v_and_b32 v21, 7, v0
    v_lshl_add_u32 v229, v21, 6, v229
    v_add_u32 v229, s57, v229
    v_bfe_u32 v21, v0, 2, 2
    v_lshrrev_b32 v22, 5, v0
    v_xor_b32 v21, v21, v22
    v_xor_b32 v22, 2, v21
    v_lshl_add_u32 v230, v22, 4, v229
    v_lshl_add_u32 v229, v21, 4, v229
    v_mov_b32 v21, 0x3f803f80
    v_accvgpr_write_b32 a0, v21
    v_accvgpr_write_b32 a1, v21
    v_accvgpr_write_b32 a2, v21
    v_accvgpr_write_b32 a3, v21
    s_min_u32 s42, s38, 2
    s_lshl_b32 s42, s42, 10
    v_add_u32 v231, s42, v2
    v_add_u32 v232, 49152, v231
    v_and_b32 v234, 15, v0
    v_lshl_add_u32 v234, v234, 2, 64
    v_mov_b32 v236, 1
    v_mov_b32 v237, 0
    v_lshlrev_b32 v241, 2, v0
    s_lshl_b32 s49, s38, 10
    s_add_u32 s49, s49, 150784
    v_add_u32 v242, s49, v1
    v_add_u32 v243, s49, v2
    s_lshl2_add_u32 s98, s37, s38
    s_lshl_b32 s98, s98, 15
    s_add_u32 s98, s98, 25165824
    s_and_b32 s48, s36, 1
    s_lshl1_add_u32 s48, s48, s40
    s_lshl2_add_u32 s48, s48, s38
    s_mul_i32 s48, s48, 114688
    s_add_u32 s48, s48, 27000832
    s_cmp_ge_u32 s37, 14
    s_cselect_b32 s98, 0x70000000, s98
    s_lshl2_add_u32 s49, s41, s38
    s_mul_i32 s99, s49, 57344
    s_add_u32 s99, s99, 27000832
    s_lshl_b32 s100, s49, 14
    s_add_u32 s100, s100, 28835840
    s_lshl2_add_u32 s48, s37, s38
    s_min_u32 s48, s48, 55
    s_lshr_b32 s48, s48, 1
    s_lshl_b32 s48, s48, 4
    v_add_u32 v238, s48, v0
    s_lshl2_add_u32 s49, s41, s38
    s_mul_i32 s48, s49, 14
    s_add_u32 s48, s48, 432
    v_add_u32 v20, s48, v0
    v_cmp_gt_u32 vcc, 16, v0
    s_lshl_b32 s48, s49, 2
    s_add_u32 s48, s48, 866
    v_cndmask_b32 v238, v20, v238, vcc
    v_min_u32 v20, 33, v0
    v_add_u32 v20, s48, v20
    v_cmp_gt_u32 vcc, 30, v0
    s_nop 0
    s_nop 0
    v_cndmask_b32 v238, v20, v238, vcc
    v_lshrrev_b32 v20, 6, v238
    v_lshlrev_b32 v20, 13, v20
    v_and_b32 v21, 3, v238
    v_lshl_add_u32 v20, v21, 2, v20
    v_bfe_u32 v238, v238, 2, 4
    v_lshl_add_u32 v238, v238, 7, v20
    v_add_u32 v238, 6144, v238
    s_mul_i32 s44, s52, 114688
    s_lshl_b32 s45, s37, 11
    s_add_u32 s44, s44, s45
    s_add_u32 s44, s44, 8388608
    s_lshl2_add_u32 s45, s36, s40
    s_lshl_b32 s45, s45, 5
    s_lshl2_add_u32 s46, s41, s38
    s_add_u32 s45, s45, s46
    s_lshl_b32 s45, s45, 10
    s_add_u32 s45, s45, 4194304
    v_and_b32 v20, 15, v0
    v_lshl_add_u32 v20, v20, 7, s44
    v_and_b32 v21, 7, v0
    v_lshl_add_u32 v21, v21, 7, s45
    v_bfe_u32 v22, v0, 3, 1
    v_lshl_add_u32 v21, v22, 16, v21
    v_cmp_gt_u32 vcc, 16, v0
    s_lshl_b32 s44, s38, 11
    s_add_u32 s44, s44, s50
    v_cndmask_b32 v20, v21, v20, vcc
    s_lshl_b32 s45, s36, 13
    s_and_b32 s46, s37, 3
    s_lshl_b32 s46, s46, 11
    s_add_u32 s45, s45, s46
    s_add_u32 s45, s45, 262144
    s_and_b32 s46, s38, 1
    s_mul_i32 s46, s46, 131072
    s_add_u32 s45, s45, s46
    s_cmp_lt_u32 s38, 2
    s_cselect_b32 s44, s44, s45
    v_and_b32 v21, 15, v0
    v_lshl_add_u32 v21, v21, 7, s44
    v_cmp_gt_u32 vcc, 48, v0
    s_nop 0
    s_nop 0
    v_cndmask_b32 v20, v21, v20, vcc
    v_mov_b32 v240, v20
    s_lshl2_add_u32 s42, s37, s38
    s_cmp_eq_u32 s42, 3
    s_cbranch_scc0 Lnoann_2
    s_lshl_b32 s42, s36, 2
    s_waitcnt vmcnt(9)
    s_mov_b64 exec, 1
    buffer_store_dword v236, v237, s[32:35], s42 offen offset:64 sc1
    s_mov_b64 exec, -1
Lnoann_2:
    s_lshl_b32 s42, s36, 4
    s_add_u32 s42, s42, s37
    s_lshl2_add_u32 s42, s42, s38
    s_sub_u32 s43, s42, 448
    s_mul_i32 s44, s43, 4682
    s_lshr_b32 s44, s44, 16
    s_mul_i32 s45, s44, 14
    s_sub_u32 s45, s43, s45
    s_and_b32 s46, s44, 3
    s_mul_i32 s47, s46, 14
    s_add_u32 s47, s47, s45
    s_mov_b64 s[92:93], s[24:25]
    s_mov_b32 s94, s26
    s_mov_b32 s95, 0x20000
    s_cmp_lt_u32 s42, 896
    s_cbranch_scc1 Lcv_3
    s_sub_u32 s43, s42, 896
    s_lshr_b32 s44, s43, 2
    s_and_b32 s46, s44, 3
    s_and_b32 s47, s43, 15
    s_mov_b64 s[92:93], s[16:17]
    s_mov_b32 s94, s18
Lcv_3:
    s_lshl_b32 s47, s47, 15
    s_lshr_b32 s44, s44, 2
    s_lshl_b32 s44, s44, 7
    s_add_u32 s47, s47, s44
    s_mov_b32 s48, 16384
    s_lshl_b32 s46, s46, 5
    v_lshrrev_b32 v216, 2, v0
    v_and_b32 v218, 3, v0
    v_lshlrev_b32 v218, 4, v218
    v_lshl_add_u32 v219, v216, 10, v218
    v_xor_b32 v219, s46, v219
    v_xor_b32 v217, 64, v219
    s_cmp_ge_u32 s42, 448
    s_cbranch_scc1 Lcv_4
    s_and_b32 s47, s42, 15
    s_mul_i32 s47, s47, 114688
    s_lshr_b32 s43, s42, 4
    s_lshl_b32 s43, s43, 7
    s_add_u32 s47, s47, s43
    s_mov_b32 s48, 57344
    s_mov_b64 s[92:93], s[20:21]
    s_mov_b32 s94, s22
    v_mul_u32_u24 v219, 3584, v216
    v_add_u32 v219, v219, v218
    v_add_u32 v217, 64, v219
Lcv_4:
    s_add_u32 s48, s48, s47
    v_add_u32 v216, s47, v219
    v_add_u32 v218, s48, v219
    v_add_u32 v219, s48, v217
    v_add_u32 v217, s47, v217
    s_lshl_b32 s42, s36, 4
    s_add_u32 s42, s42, s37
    s_lshl2_add_u32 s42, s42, s38
    s_lshl_b32 s43, s42, 12
    s_lshr_b32 s44, s42, 4
    s_lshl_b32 s44, s44, 16
    s_and_b32 s45, s42, 15
    s_lshl_b32 s46, s45, 11
    s_add_u32 s44, s44, s46
    s_cmp_lt_u32 s42, 448
    s_cselect_b32 s43, s44, s43
    s_cselect_b32 s46, 32, 1
    s_cselect_b32 s47, 1, 2
    s_add_u32 s43, s43, 25165824
    s_lshl_b32 s46, s46, 10
    s_lshl_b32 s47, s47, 10
    v_add_u32 v244, s43, v1
    v_add_u32 v245, s46, v244
    v_add_u32 v246, s47, v244
    v_add_u32 v247, s47, v245
    s_lshr_b32 s43, s42, 4
    s_lshl_b32 s43, s43, 12
    s_lshl_b32 s45, s45, 7
    s_add_u32 s43, s43, s45
    s_add_u32 s43, s43, 655360
    s_cmp_ge_u32 s42, 448
    s_cselect_b32 s43, 0x70000000, s43
    v_and_b32 v221, 127, v241
    v_add_u32 v221, s43, v221
    v_and_b32 v222, 31, v0
    v_lshlrev_b32 v222, 10, v222
    v_lshrrev_b32 v223, 5, v0
    v_lshl_add_u32 v222, v223, 4, v222
    s_lshl2_add_u32 s48, s36, s40
    s_lshl_b32 s48, s48, 15
    s_lshl2_add_u32 s49, s41, s38
    s_lshl_b32 s49, s49, 5
    s_add_u32 s48, s48, s49
    v_add_u32 v222, s48, v222
    v_add_u32 v223, 65536, v222
    s_xor_b32 s55, s1, 1
    s_add_u32 m0, s57, 4096
    s_lshl_b32 s56, s55, 7
    s_add_u32 s56, s56, s54
    buffer_load_dwordx4 v224, s[8:11], s56 offen offset:0 lds
    buffer_load_dwordx4 v225, s[8:11], s56 offen offset:1024 lds
    buffer_load_dwordx4 v226, s[8:11], s56 offen offset:2048 lds
    buffer_load_dwordx4 v227, s[8:11], s56 offen offset:3072 lds
    s_xor_b32 s101, s1, 1
    s_mul_i32 s101, s101, 196608
    s_add_u32 m0, s0, 12288
    s_add_u32 s101, s101, s58
    buffer_load_dwordx4 v228, s[12:15], s101 offen offset:1024 lds
    buffer_load_dwordx4 v228, s[12:15], s101 offen offset:2048 lds
    buffer_load_dwordx4 v228, s[12:15], s101 offen offset:0 lds
    v_mov_b32 v204, 0
    v_mov_b32 v205, 0
    v_mov_b32 v206, 0
    v_mov_b32 v207, 0
    v_mov_b32 v208, 0
    v_mov_b32 v209, 0
    v_mov_b32 v210, 0
    v_mov_b32 v211, 0
    v_mov_b32 v212, 0x3f803f80
    v_add_u32 v16, 49152, v2
    s_waitcnt vmcnt(10)
    ds_read_b128 v[20:23], v229 offset:0
    ds_read_b128 v[24:27], v230 offset:0
    ds_read_b128 v[28:31], v229 offset:512
    ds_read_b128 v[32:35], v230 offset:512
    s_waitcnt vmcnt(7)
    s_barrier
    ds_read_b64_tr_b16 v[136:137], v2 offset:1024
    ds_read_b64_tr_b16 v[138:139], v2 offset:1280
    ds_read_b64_tr_b16 v[140:141], v2 offset:2048
    ds_read_b64_tr_b16 v[142:143], v2 offset:2304
    ds_read_b64_tr_b16 v[132:133], v2 offset:0
    ds_read_b64_tr_b16 v[134:135], v2 offset:256
    ds_read_b64_tr_b16 a[8:9], v231 offset:0
    ds_read_b64_tr_b16 a[10:11], v231 offset:256
    s_waitcnt lgkmcnt(6)
    v_mfma_f32_32x32x16_bf16 v[100:115], v[136:139], v[20:23], 0
    ds_read_b64_tr_b16 v[148:149], v2 offset:4096
    ds_read_b64_tr_b16 v[150:151], v2 offset:4352
    s_xor_b32 s55, s1, 2
    s_add_u32 m0, s57, 8192
    s_lshl_b32 s56, s55, 7
    s_waitcnt lgkmcnt(6)
    v_mfma_f32_32x32x16_bf16 v[116:131], v[20:23], v[140:143], 0
    ds_read_b64_tr_b16 v[152:153], v2 offset:5120
    ds_read_b64_tr_b16 v[154:155], v2 offset:5376
    s_add_u32 s56, s56, s54
    s_waitcnt lgkmcnt(6)
    v_mfma_f32_32x32x16_bf16 v[84:99], v[132:135], v[20:23], 0
    ds_read_b64_tr_b16 v[144:145], v2 offset:3072
    ds_read_b64_tr_b16 v[146:147], v2 offset:3328
    buffer_load_dwordx4 v224, s[8:11], s56 offen offset:0 lds
    s_waitcnt lgkmcnt(6)
    v_mfma_f32_32x32x16_bf16 a[16:31], a[0:3], a[8:11], 0
    ds_read_b64_tr_b16 a[12:13], v231 offset:3072
    ds_read_b64_tr_b16 a[14:15], v231 offset:3328
    buffer_load_dwordx4 v225, s[8:11], s56 offen offset:1024 lds
    s_waitcnt lgkmcnt(6)
    v_mfma_f32_32x32x16_bf16 v[100:115], v[148:151], v[24:27], v[100:115]
    ds_read_b64_tr_b16 v[136:137], v2 offset:7168
    ds_read_b64_tr_b16 v[138:139], v2 offset:7424
    buffer_load_dwordx4 v226, s[8:11], s56 offen offset:2048 lds
    s_waitcnt lgkmcnt(6)
    v_mfma_f32_32x32x16_bf16 v[116:131], v[24:27], v[152:155], v[116:131]
    ds_read_b64_tr_b16 v[140:141], v2 offset:8192
    ds_read_b64_tr_b16 v[142:143], v2 offset:8448
    buffer_load_dwordx4 v227, s[8:11], s56 offen offset:3072 lds
    s_waitcnt lgkmcnt(6)
    v_mfma_f32_32x32x16_bf16 v[84:99], v[144:147], v[24:27], v[84:99]
    ds_read_b64_tr_b16 v[132:133], v2 offset:6144
    ds_read_b64_tr_b16 v[134:135], v2 offset:6400
    s_xor_b32 s101, s1, 2
    s_mul_i32 s101, s101, 196608
    s_add_u32 m0, s0, 24576
    s_waitcnt lgkmcnt(6)
    v_mfma_f32_32x32x16_bf16 a[16:31], a[0:3], a[12:15], a[16:31]
    ds_read_b64_tr_b16 a[8:9], v231 offset:6144
    ds_read_b64_tr_b16 a[10:11], v231 offset:6400
    s_add_u32 s101, s101, s58
    s_waitcnt vmcnt(7)
    ds_read_b128 v[36:39], v229 offset:4096
    ds_read_b128 v[40:43], v230 offset:4096
    ds_read_b128 v[44:47], v229 offset:4608
    ds_read_b128 v[48:51], v230 offset:4608
    v_dot2_f32_bf16 v204, v20, v212, v204
    v_dot2_f32_bf16 v205, v20, v20, v205
    v_dot2_f32_bf16 v206, v21, v212, v206
    v_dot2_f32_bf16 v207, v21, v21, v207
    v_dot2_f32_bf16 v208, v22, v212, v208
    v_dot2_f32_bf16 v209, v22, v22, v209
    v_dot2_f32_bf16 v210, v23, v212, v210
    v_dot2_f32_bf16 v211, v23, v23, v211
    v_dot2_f32_bf16 v204, v24, v212, v204
    v_dot2_f32_bf16 v205, v24, v24, v205
    v_dot2_f32_bf16 v206, v25, v212, v206
    v_dot2_f32_bf16 v207, v25, v25, v207
    v_dot2_f32_bf16 v208, v26, v212, v208
    v_dot2_f32_bf16 v209, v26, v26, v209
    v_dot2_f32_bf16 v210, v27, v212, v210
    v_dot2_f32_bf16 v211, v27, v27, v211
    v_dot2_f32_bf16 v204, v28, v212, v204
    v_dot2_f32_bf16 v205, v28, v28, v205
    v_dot2_f32_bf16 v206, v29, v212, v206
    v_dot2_f32_bf16 v207, v29, v29, v207
    v_dot2_f32_bf16 v208, v30, v212, v208
    v_dot2_f32_bf16 v209, v30, v30, v209
    v_dot2_f32_bf16 v210, v31, v212, v210
    v_dot2_f32_bf16 v211, v31, v31, v211
    v_dot2_f32_bf16 v204, v32, v212, v204
    v_dot2_f32_bf16 v205, v32, v32, v205
    v_dot2_f32_bf16 v206, v33, v212, v206
    v_dot2_f32_bf16 v207, v33, v33, v207
    v_dot2_f32_bf16 v208, v34, v212, v208
    v_dot2_f32_bf16 v209, v34, v34, v209
    v_dot2_f32_bf16 v210, v35, v212, v210
    v_dot2_f32_bf16 v211, v35, v35, v211
    s_waitcnt lgkmcnt(10)
    v_mfma_f32_32x32x16_bf16 v[100:115], v[136:139], v[28:31], v[100:115]
    ds_read_b64_tr_b16 v[148:149], v2 offset:10240
    ds_read_b64_tr_b16 v[150:151], v2 offset:10496
    buffer_load_dwordx4 v228, s[12:15], s101 offen offset:1024 lds
    s_waitcnt lgkmcnt(10)
    v_mfma_f32_32x32x16_bf16 v[116:131], v[28:31], v[140:143], v[116:131]
    ds_read_b64_tr_b16 v[152:153], v2 offset:11264
    ds_read_b64_tr_b16 v[154:155], v2 offset:11520
    buffer_load_dwordx4 v228, s[12:15], s101 offen offset:2048 lds
    s_waitcnt lgkmcnt(10)
    v_mfma_f32_32x32x16_bf16 v[84:99], v[132:135], v[28:31], v[84:99]
    ds_read_b64_tr_b16 v[144:145], v2 offset:9216
    ds_read_b64_tr_b16 v[146:147], v2 offset:9472
    buffer_load_dwordx4 v228, s[12:15], s101 offen offset:0 lds
    s_waitcnt lgkmcnt(10)
    v_mfma_f32_32x32x16_bf16 a[16:31], a[0:3], a[8:11], a[16:31]
    ds_read_b64_tr_b16 a[12:13], v231 offset:9216
    ds_read_b64_tr_b16 a[14:15], v231 offset:9472
    s_xor_b32 s55, s1, 3
    s_add_u32 m0, s57, 0
    s_lshl_b32 s56, s55, 7
    s_waitcnt vmcnt(3)
    ds_read_b128 v[52:55], v229 offset:8192
    ds_read_b128 v[56:59], v230 offset:8192
    ds_read_b128 v[60:63], v229 offset:8704
    ds_read_b128 v[64:67], v230 offset:8704
    s_waitcnt lgkmcnt(15)
    v_dot2_f32_bf16 v204, v36, v212, v204
    v_dot2_f32_bf16 v205, v36, v36, v205
    v_dot2_f32_bf16 v206, v37, v212, v206
    v_dot2_f32_bf16 v207, v37, v37, v207
    v_dot2_f32_bf16 v208, v38, v212, v208
    v_dot2_f32_bf16 v209, v38, v38, v209
    v_dot2_f32_bf16 v210, v39, v212, v210
    v_dot2_f32_bf16 v211, v39, v39, v211
    s_waitcnt lgkmcnt(14)
    v_dot2_f32_bf16 v204, v40, v212, v204
    v_dot2_f32_bf16 v205, v40, v40, v205
    v_dot2_f32_bf16 v206, v41, v212, v206
    v_dot2_f32_bf16 v207, v41, v41, v207
    v_dot2_f32_bf16 v208, v42, v212, v208
    v_dot2_f32_bf16 v209, v42, v42, v209
    v_dot2_f32_bf16 v210, v43, v212, v210
    v_dot2_f32_bf16 v211, v43, v43, v211
    s_waitcnt lgkmcnt(13)
    v_dot2_f32_bf16 v204, v44, v212, v204
    v_dot2_f32_bf16 v205, v44, v44, v205
    v_dot2_f32_bf16 v206, v45, v212, v206
    v_dot2_f32_bf16 v207, v45, v45, v207
    v_dot2_f32_bf16 v208, v46, v212, v208
    v_dot2_f32_bf16 v209, v46, v46, v209
    v_dot2_f32_bf16 v210, v47, v212, v210
    v_dot2_f32_bf16 v211, v47, v47, v211
    s_waitcnt lgkmcnt(12)
    v_dot2_f32_bf16 v204, v48, v212, v204
    v_dot2_f32_bf16 v205, v48, v48, v205
    v_dot2_f32_bf16 v206, v49, v212, v206
    v_dot2_f32_bf16 v207, v49, v49, v207
    v_dot2_f32_bf16 v208, v50, v212, v208
    v_dot2_f32_bf16 v209, v50, v50, v209
    v_dot2_f32_bf16 v210, v51, v212, v210
    v_dot2_f32_bf16 v211, v51, v51, v211
    s_barrier
    s_waitcnt lgkmcnt(10)
    v_mfma_f32_32x32x16_bf16 v[100:115], v[148:151], v[32:35], v[100:115]
    ds_read_b64_tr_b16 v[136:137], v2 offset:13312
    ds_read_b64_tr_b16 v[138:139], v2 offset:13568
    s_add_u32 s56, s56, s54
    s_waitcnt lgkmcnt(10)
    v_mfma_f32_32x32x16_bf16 v[116:131], v[32:35], v[152:155], v[116:131]
    ds_read_b64_tr_b16 v[140:141], v2 offset:14336
    ds_read_b64_tr_b16 v[142:143], v2 offset:14592
    buffer_load_dwordx4 v224, s[8:11], s56 offen offset:0 lds
    s_waitcnt lgkmcnt(10)
    v_mfma_f32_32x32x16_bf16 v[84:99], v[144:147], v[32:35], v[84:99]
    ds_read_b64_tr_b16 v[132:133], v2 offset:12288
    ds_read_b64_tr_b16 v[134:135], v2 offset:12544
    buffer_load_dwordx4 v225, s[8:11], s56 offen offset:1024 lds
    s_waitcnt lgkmcnt(10)
    v_mfma_f32_32x32x16_bf16 a[16:31], a[0:3], a[12:15], a[16:31]
    ds_read_b64_tr_b16 a[8:9], v231 offset:12288
    ds_read_b64_tr_b16 a[10:11], v231 offset:12544
    buffer_load_dwordx4 v226, s[8:11], s56 offen offset:2048 lds
    s_waitcnt lgkmcnt(11)
    v_dot2_f32_bf16 v204, v52, v212, v204
    v_dot2_f32_bf16 v205, v52, v52, v205
    v_dot2_f32_bf16 v206, v53, v212, v206
    v_dot2_f32_bf16 v207, v53, v53, v207
    v_dot2_f32_bf16 v208, v54, v212, v208
    v_dot2_f32_bf16 v209, v54, v54, v209
    v_dot2_f32_bf16 v210, v55, v212, v210
    v_dot2_f32_bf16 v211, v55, v55, v211
    s_waitcnt lgkmcnt(10)
    v_dot2_f32_bf16 v204, v56, v212, v204
    v_dot2_f32_bf16 v205, v56, v56, v205
    v_dot2_f32_bf16 v206, v57, v212, v206
    v_dot2_f32_bf16 v207, v57, v57, v207
    v_dot2_f32_bf16 v208, v58, v212, v208
    v_dot2_f32_bf16 v209, v58, v58, v209
    v_dot2_f32_bf16 v210, v59, v212, v210
    v_dot2_f32_bf16 v211, v59, v59, v211
    s_waitcnt lgkmcnt(9)
    v_dot2_f32_bf16 v204, v60, v212, v204
    v_dot2_f32_bf16 v205, v60, v60, v205
    v_dot2_f32_bf16 v206, v61, v212, v206
    v_dot2_f32_bf16 v207, v61, v61, v207
    v_dot2_f32_bf16 v208, v62, v212, v208
    v_dot2_f32_bf16 v209, v62, v62, v209
    v_dot2_f32_bf16 v210, v63, v212, v210
    v_dot2_f32_bf16 v211, v63, v63, v211
    s_waitcnt lgkmcnt(8)
    v_dot2_f32_bf16 v204, v64, v212, v204
    v_dot2_f32_bf16 v205, v64, v64, v205
    v_dot2_f32_bf16 v206, v65, v212, v206
    v_dot2_f32_bf16 v207, v65, v65, v207
    v_dot2_f32_bf16 v208, v66, v212, v208
    v_dot2_f32_bf16 v209, v66, v66, v209
    v_dot2_f32_bf16 v210, v67, v212, v210
    v_dot2_f32_bf16 v211, v67, v67, v211
    s_waitcnt lgkmcnt(6)
    v_mfma_f32_32x32x16_bf16 v[100:115], v[136:139], v[36:39], v[100:115]
    ds_read_b64_tr_b16 v[148:149], v2 offset:16384
    ds_read_b64_tr_b16 v[150:151], v2 offset:16640
    buffer_load_dwordx4 v227, s[8:11], s56 offen offset:3072 lds
    s_waitcnt lgkmcnt(6)
    v_mfma_f32_32x32x16_bf16 v[116:131], v[36:39], v[140:143], v[116:131]
    ds_read_b64_tr_b16 v[152:153], v2 offset:17408
    ds_read_b64_tr_b16 v[154:155], v2 offset:17664
    s_xor_b32 s101, s1, 3
    s_mul_i32 s101, s101, 196608
    s_add_u32 m0, s0, 36864
    s_waitcnt lgkmcnt(6)
    v_mfma_f32_32x32x16_bf16 v[84:99], v[132:135], v[36:39], v[84:99]
    ds_read_b64_tr_b16 v[144:145], v2 offset:15360
    ds_read_b64_tr_b16 v[146:147], v2 offset:15616
    s_add_u32 s101, s101, s58
    s_waitcnt lgkmcnt(6)
    v_mfma_f32_32x32x16_bf16 a[16:31], a[0:3], a[8:11], a[16:31]
    ds_read_b64_tr_b16 a[12:13], v231 offset:15360
    ds_read_b64_tr_b16 a[14:15], v231 offset:15616
    buffer_load_dwordx4 v228, s[12:15], s101 offen offset:1024 lds
    s_waitcnt lgkmcnt(6)
    v_mfma_f32_32x32x16_bf16 v[100:115], v[148:151], v[40:43], v[100:115]
    ds_read_b64_tr_b16 v[136:137], v2 offset:19456
    ds_read_b64_tr_b16 v[138:139], v2 offset:19712
    buffer_load_dwordx4 v228, s[12:15], s101 offen offset:2048 lds
    s_waitcnt lgkmcnt(6)
    v_mfma_f32_32x32x16_bf16 v[116:131], v[40:43], v[152:155], v[116:131]
    ds_read_b64_tr_b16 v[140:141], v2 offset:20480
    ds_read_b64_tr_b16 v[142:143], v2 offset:20736
    buffer_load_dwordx4 v228, s[12:15], s101 offen offset:0 lds
    s_waitcnt lgkmcnt(6)
    v_mfma_f32_32x32x16_bf16 v[84:99], v[144:147], v[40:43], v[84:99]
    ds_read_b64_tr_b16 v[132:133], v2 offset:18432
    ds_read_b64_tr_b16 v[134:135], v2 offset:18688
    s_xor_b32 s55, s1, 4
    s_add_u32 m0, s57, 4096
    s_lshl_b32 s56, s55, 7
    s_waitcnt lgkmcnt(6)
    v_mfma_f32_32x32x16_bf16 a[16:31], a[0:3], a[12:15], a[16:31]
    ds_read_b64_tr_b16 a[8:9], v231 offset:18432
    ds_read_b64_tr_b16 a[10:11], v231 offset:18688
    s_add_u32 s56, s56, s54
    s_waitcnt lgkmcnt(6)
    v_mfma_f32_32x32x16_bf16 v[100:115], v[136:139], v[44:47], v[100:115]
    ds_read_b64_tr_b16 v[148:149], v2 offset:22528
    ds_read_b64_tr_b16 v[150:151], v2 offset:22784
    buffer_load_dwordx4 v224, s[8:11], s56 offen offset:0 lds
    s_waitcnt lgkmcnt(6)
    v_mfma_f32_32x32x16_bf16 v[116:131], v[44:47], v[140:143], v[116:131]
    ds_read_b64_tr_b16 v[152:153], v2 offset:23552
    ds_read_b64_tr_b16 v[154:155], v2 offset:23808
    buffer_load_dwordx4 v225, s[8:11], s56 offen offset:1024 lds
    s_waitcnt lgkmcnt(6)
    v_mfma_f32_32x32x16_bf16 v[84:99], v[132:135], v[44:47], v[84:99]
    ds_read_b64_tr_b16 v[144:145], v2 offset:21504
    ds_read_b64_tr_b16 v[146:147], v2 offset:21760
    buffer_load_dwordx4 v226, s[8:11], s56 offen offset:2048 lds
    s_waitcnt lgkmcnt(6)
    v_mfma_f32_32x32x16_bf16 a[16:31], a[0:3], a[8:11], a[16:31]
    ds_read_b64_tr_b16 a[12:13], v231 offset:21504
    ds_read_b64_tr_b16 a[14:15], v231 offset:21760
    buffer_load_dwordx4 v227, s[8:11], s56 offen offset:3072 lds
    s_waitcnt vmcnt(7)
    ds_read_b128 v[68:71], v229 offset:0
    ds_read_b128 v[72:75], v230 offset:0
    ds_read_b128 v[76:79], v229 offset:512
    ds_read_b128 v[80:83], v230 offset:512
    s_barrier
    s_waitcnt lgkmcnt(10)
    v_mfma_f32_32x32x16_bf16 v[100:115], v[148:151], v[48:51], v[100:115]
    ds_read_b64_tr_b16 v[136:137], v2 offset:25600
    ds_read_b64_tr_b16 v[138:139], v2 offset:25856
    s_xor_b32 s101, s1, 4
    s_mul_i32 s101, s101, 196608
    s_add_u32 m0, s0, 49152
    s_waitcnt lgkmcnt(10)
    v_mfma_f32_32x32x16_bf16 v[116:131], v[48:51], v[152:155], v[116:131]
    ds_read_b64_tr_b16 v[140:141], v2 offset:26624
    ds_read_b64_tr_b16 v[142:143], v2 offset:26880
    s_add_u32 s101, s101, s58
    s_waitcnt lgkmcnt(10)
    v_mfma_f32_32x32x16_bf16 v[84:99], v[144:147], v[48:51], v[84:99]
    ds_read_b64_tr_b16 v[132:133], v2 offset:24576
    ds_read_b64_tr_b16 v[134:135], v2 offset:24832
    buffer_load_dwordx4 v228, s[12:15], s101 offen offset:1024 lds
    s_waitcnt lgkmcnt(10)
    v_mfma_f32_32x32x16_bf16 a[16:31], a[0:3], a[12:15], a[16:31]
    ds_read_b64_tr_b16 a[8:9], v231 offset:24576
    ds_read_b64_tr_b16 a[10:11], v231 offset:24832
    buffer_load_dwordx4 v228, s[12:15], s101 offen offset:2048 lds
    s_waitcnt lgkmcnt(11)
    v_dot2_f32_bf16 v204, v68, v212, v204
    v_dot2_f32_bf16 v205, v68, v68, v205
    v_dot2_f32_bf16 v206, v69, v212, v206
    v_dot2_f32_bf16 v207, v69, v69, v207
    v_dot2_f32_bf16 v208, v70, v212, v208
    v_dot2_f32_bf16 v209, v70, v70, v209
    v_dot2_f32_bf16 v210, v71, v212, v210
    v_dot2_f32_bf16 v211, v71, v71, v211
    s_waitcnt lgkmcnt(10)
    v_dot2_f32_bf16 v204, v72, v212, v204
    v_dot2_f32_bf16 v205, v72, v72, v205
    v_dot2_f32_bf16 v206, v73, v212, v206
    v_dot2_f32_bf16 v207, v73, v73, v207
    v_dot2_f32_bf16 v208, v74, v212, v208
    v_dot2_f32_bf16 v209, v74, v74, v209
    v_dot2_f32_bf16 v210, v75, v212, v210
    v_dot2_f32_bf16 v211, v75, v75, v211
    s_waitcnt lgkmcnt(9)
    v_dot2_f32_bf16 v204, v76, v212, v204
    v_dot2_f32_bf16 v205, v76, v76, v205
    v_dot2_f32_bf16 v206, v77, v212, v206
    v_dot2_f32_bf16 v207, v77, v77, v207
    v_dot2_f32_bf16 v208, v78, v212, v208
    v_dot2_f32_bf16 v209, v78, v78, v209
    v_dot2_f32_bf16 v210, v79, v212, v210
    v_dot2_f32_bf16 v211, v79, v79, v211
    s_waitcnt lgkmcnt(8)
    v_dot2_f32_bf16 v204, v80, v212, v204
    v_dot2_f32_bf16 v205, v80, v80, v205
    v_dot2_f32_bf16 v206, v81, v212, v206
    v_dot2_f32_bf16 v207, v81, v81, v207
    v_dot2_f32_bf16 v208, v82, v212, v208
    v_dot2_f32_bf16 v209, v82, v82, v209
    v_dot2_f32_bf16 v210, v83, v212, v210
    v_dot2_f32_bf16 v211, v83, v83, v211
    s_waitcnt lgkmcnt(6)
    v_mfma_f32_32x32x16_bf16 v[100:115], v[136:139], v[52:55], v[100:115]
    ds_read_b64_tr_b16 v[148:149], v2 offset:28672
    ds_read_b64_tr_b16 v[150:151], v2 offset:28928
    buffer_load_dwordx4 v228, s[12:15], s101 offen offset:0 lds
    s_waitcnt lgkmcnt(6)
    v_mfma_f32_32x32x16_bf16 v[116:131], v[52:55], v[140:143], v[116:131]
    ds_read_b64_tr_b16 v[152:153], v2 offset:29696
    ds_read_b64_tr_b16 v[154:155], v2 offset:29952
    s_xor_b32 s55, s1, 5
    s_add_u32 m0, s57, 8192
    s_lshl_b32 s56, s55, 7
    s_waitcnt lgkmcnt(6)
    v_mfma_f32_32x32x16_bf16 v[84:99], v[132:135], v[52:55], v[84:99]
    ds_read_b64_tr_b16 v[144:145], v2 offset:27648
    ds_read_b64_tr_b16 v[146:147], v2 offset:27904
    s_add_u32 s56, s56, s54
    s_waitcnt lgkmcnt(6)
    v_mfma_f32_32x32x16_bf16 a[16:31], a[0:3], a[8:11], a[16:31]
    ds_read_b64_tr_b16 a[12:13], v231 offset:27648
    ds_read_b64_tr_b16 a[14:15], v231 offset:27904
    buffer_load_dwordx4 v224, s[8:11], s56 offen offset:0 lds
    s_waitcnt lgkmcnt(6)
    v_mfma_f32_32x32x16_bf16 v[100:115], v[148:151], v[56:59], v[100:115]
    ds_read_b64_tr_b16 v[136:137], v2 offset:31744
    ds_read_b64_tr_b16 v[138:139], v2 offset:32000
    buffer_load_dwordx4 v225, s[8:11], s56 offen offset:1024 lds
    s_waitcnt lgkmcnt(6)
    v_mfma_f32_32x32x16_bf16 v[116:131], v[56:59], v[152:155], v[116:131]
    ds_read_b64_tr_b16 v[140:141], v2 offset:32768
    ds_read_b64_tr_b16 v[142:143], v2 offset:33024
    buffer_load_dwordx4 v226, s[8:11], s56 offen offset:2048 lds
    s_waitcnt lgkmcnt(6)
    v_mfma_f32_32x32x16_bf16 v[84:99], v[144:147], v[56:59], v[84:99]
    ds_read_b64_tr_b16 v[132:133], v2 offset:30720
    ds_read_b64_tr_b16 v[134:135], v2 offset:30976
    buffer_load_dwordx4 v227, s[8:11], s56 offen offset:3072 lds
    s_waitcnt lgkmcnt(6)
    v_mfma_f32_32x32x16_bf16 a[16:31], a[0:3], a[12:15], a[16:31]
    ds_read_b64_tr_b16 a[8:9], v231 offset:30720
    ds_read_b64_tr_b16 a[10:11], v231 offset:30976
    s_xor_b32 s101, s1, 5
    s_mul_i32 s101, s101, 196608
    s_add_u32 m0, s0, 61440
    s_waitcnt lgkmcnt(6)
    v_mfma_f32_32x32x16_bf16 v[100:115], v[136:139], v[60:63], v[100:115]
    ds_read_b64_tr_b16 v[148:149], v2 offset:34816
    ds_read_b64_tr_b16 v[150:151], v2 offset:35072
    s_add_u32 s101, s101, s58
    s_waitcnt lgkmcnt(6)
    v_mfma_f32_32x32x16_bf16 v[116:131], v[60:63], v[140:143], v[116:131]
    ds_read_b64_tr_b16 v[152:153], v2 offset:35840
    ds_read_b64_tr_b16 v[154:155], v2 offset:36096
    buffer_load_dwordx4 v228, s[12:15], s101 offen offset:1024 lds
    s_waitcnt lgkmcnt(6)
    v_mfma_f32_32x32x16_bf16 v[84:99], v[132:135], v[60:63], v[84:99]
    ds_read_b64_tr_b16 v[144:145], v2 offset:33792
    ds_read_b64_tr_b16 v[146:147], v2 offset:34048
    buffer_load_dwordx4 v228, s[12:15], s101 offen offset:2048 lds
    s_waitcnt lgkmcnt(6)
    v_mfma_f32_32x32x16_bf16 a[16:31], a[0:3], a[8:11], a[16:31]
    ds_read_b64_tr_b16 a[12:13], v231 offset:33792
    ds_read_b64_tr_b16 a[14:15], v231 offset:34048
    buffer_load_dwordx4 v228, s[12:15], s101 offen offset:0 lds
    s_waitcnt vmcnt(10)
    ds_read_b128 v[20:23], v229 offset:4096
    ds_read_b128 v[24:27], v230 offset:4096
    ds_read_b128 v[28:31], v229 offset:4608
    ds_read_b128 v[32:35], v230 offset:4608
    s_barrier
    s_waitcnt lgkmcnt(10)
    v_mfma_f32_32x32x16_bf16 v[100:115], v[148:151], v[64:67], v[100:115]
    ds_read_b64_tr_b16 v[136:137], v2 offset:37888
    ds_read_b64_tr_b16 v[138:139], v2 offset:38144
    s_xor_b32 s55, s1, 6
    s_add_u32 m0, s57, 0
    s_lshl_b32 s56, s55, 7
    s_waitcnt lgkmcnt(10)
    v_mfma_f32_32x32x16_bf16 v[116:131], v[64:67], v[152:155], v[116:131]
    ds_read_b64_tr_b16 v[140:141], v2 offset:38912
    ds_read_b64_tr_b16 v[142:143], v2 offset:39168
    s_add_u32 s56, s56, s54
    s_waitcnt lgkmcnt(10)
    v_mfma_f32_32x32x16_bf16 v[84:99], v[144:147], v[64:67], v[84:99]
    ds_read_b64_tr_b16 v[132:133], v2 offset:36864
    ds_read_b64_tr_b16 v[134:135], v2 offset:37120
    buffer_load_dwordx4 v224, s[8:11], s56 offen offset:0 lds
    s_waitcnt lgkmcnt(10)
    v_mfma_f32_32x32x16_bf16 a[16:31], a[0:3], a[12:15], a[16:31]
    ds_read_b64_tr_b16 a[8:9], v231 offset:36864
    ds_read_b64_tr_b16 a[10:11], v231 offset:37120
    buffer_load_dwordx4 v225, s[8:11], s56 offen offset:1024 lds
    s_waitcnt lgkmcnt(11)
    v_dot2_f32_bf16 v204, v20, v212, v204
    v_dot2_f32_bf16 v205, v20, v20, v205
    v_dot2_f32_bf16 v206, v21, v212, v206
    v_dot2_f32_bf16 v207, v21, v21, v207
    v_dot2_f32_bf16 v208, v22, v212, v208
    v_dot2_f32_bf16 v209, v22, v22, v209
    v_dot2_f32_bf16 v210, v23, v212, v210
    v_dot2_f32_bf16 v211, v23, v23, v211
    s_waitcnt lgkmcnt(10)
    v_dot2_f32_bf16 v204, v24, v212, v204
    v_dot2_f32_bf16 v205, v24, v24, v205
    v_dot2_f32_bf16 v206, v25, v212, v206
    v_dot2_f32_bf16 v207, v25, v25, v207
    v_dot2_f32_bf16 v208, v26, v212, v208
    v_dot2_f32_bf16 v209, v26, v26, v209
    v_dot2_f32_bf16 v210, v27, v212, v210
    v_dot2_f32_bf16 v211, v27, v27, v211
    s_waitcnt lgkmcnt(9)
    v_dot2_f32_bf16 v204, v28, v212, v204
    v_dot2_f32_bf16 v205, v28, v28, v205
    v_dot2_f32_bf16 v206, v29, v212, v206
    v_dot2_f32_bf16 v207, v29, v29, v207
    v_dot2_f32_bf16 v208, v30, v212, v208
    v_dot2_f32_bf16 v209, v30, v30, v209
    v_dot2_f32_bf16 v210, v31, v212, v210
    v_dot2_f32_bf16 v211, v31, v31, v211
    s_waitcnt lgkmcnt(8)
    v_dot2_f32_bf16 v204, v32, v212, v204
    v_dot2_f32_bf16 v205, v32, v32, v205
    v_dot2_f32_bf16 v206, v33, v212, v206
    v_dot2_f32_bf16 v207, v33, v33, v207
    v_dot2_f32_bf16 v208, v34, v212, v208
    v_dot2_f32_bf16 v209, v34, v34, v209
    v_dot2_f32_bf16 v210, v35, v212, v210
    v_dot2_f32_bf16 v211, v35, v35, v211
    s_waitcnt lgkmcnt(6)
    v_mfma_f32_32x32x16_bf16 v[100:115], v[136:139], v[68:71], v[100:115]
    ds_read_b64_tr_b16 v[148:149], v2 offset:40960
    ds_read_b64_tr_b16 v[150:151], v2 offset:41216
    buffer_load_dwordx4 v226, s[8:11], s56 offen offset:2048 lds
    s_waitcnt lgkmcnt(6)
    v_mfma_f32_32x32x16_bf16 v[116:131], v[68:71], v[140:143], v[116:131]
    ds_read_b64_tr_b16 v[152:153], v2 offset:41984
    ds_read_b64_tr_b16 v[154:155], v2 offset:42240
    buffer_load_dwordx4 v227, s[8:11], s56 offen offset:3072 lds
    s_waitcnt lgkmcnt(6)
    v_mfma_f32_32x32x16_bf16 v[84:99], v[132:135], v[68:71], v[84:99]
    ds_read_b64_tr_b16 v[144:145], v2 offset:39936
    ds_read_b64_tr_b16 v[146:147], v2 offset:40192
    s_xor_b32 s101, s1, 6
    s_mul_i32 s101, s101, 196608
    s_add_u32 m0, s0, 73728
    s_waitcnt lgkmcnt(6)
    v_mfma_f32_32x32x16_bf16 a[16:31], a[0:3], a[8:11], a[16:31]
    ds_read_b64_tr_b16 a[12:13], v231 offset:39936
    ds_read_b64_tr_b16 a[14:15], v231 offset:40192
    s_add_u32 s101, s101, s58
    s_waitcnt lgkmcnt(6)
    v_mfma_f32_32x32x16_bf16 v[100:115], v[148:151], v[72:75], v[100:115]
    ds_read_b64_tr_b16 v[136:137], v2 offset:44032
    ds_read_b64_tr_b16 v[138:139], v2 offset:44288
    buffer_load_dwordx4 v228, s[12:15], s101 offen offset:1024 lds
    s_waitcnt lgkmcnt(6)
    v_mfma_f32_32x32x16_bf16 v[116:131], v[72:75], v[152:155], v[116:131]
    ds_read_b64_tr_b16 v[140:141], v2 offset:45056
    ds_read_b64_tr_b16 v[142:143], v2 offset:45312
    buffer_load_dwordx4 v228, s[12:15], s101 offen offset:2048 lds
    s_waitcnt lgkmcnt(6)
    v_mfma_f32_32x32x16_bf16 v[84:99], v[144:147], v[72:75], v[84:99]
    ds_read_b64_tr_b16 v[132:133], v2 offset:43008
    ds_read_b64_tr_b16 v[134:135], v2 offset:43264
    buffer_load_dwordx4 v228, s[12:15], s101 offen offset:0 lds
    s_waitcnt lgkmcnt(6)
    v_mfma_f32_32x32x16_bf16 a[16:31], a[0:3], a[12:15], a[16:31]
    ds_read_b64_tr_b16 a[8:9], v231 offset:43008
    ds_read_b64_tr_b16 a[10:11], v231 offset:43264
    s_xor_b32 s55, s1, 7
    s_add_u32 m0, s57, 4096
    s_lshl_b32 s56, s55, 7
    s_waitcnt lgkmcnt(6)
    v_mfma_f32_32x32x16_bf16 v[100:115], v[136:139], v[76:79], v[100:115]
    ds_read_b64_tr_b16 v[148:149], v2 offset:47104
    ds_read_b64_tr_b16 v[150:151], v2 offset:47360
    s_add_u32 s56, s56, s54
    s_waitcnt lgkmcnt(6)
    v_mfma_f32_32x32x16_bf16 v[116:131], v[76:79], v[140:143], v[116:131]
    ds_read_b64_tr_b16 v[152:153], v2 offset:48128
    ds_read_b64_tr_b16 v[154:155], v2 offset:48384
    buffer_load_dwordx4 v224, s[8:11], s56 offen offset:0 lds
    s_waitcnt lgkmcnt(6)
    v_mfma_f32_32x32x16_bf16 v[84:99], v[132:135], v[76:79], v[84:99]
    ds_read_b64_tr_b16 v[144:145], v2 offset:46080
    ds_read_b64_tr_b16 v[146:147], v2 offset:46336
    buffer_load_dwordx4 v225, s[8:11], s56 offen offset:1024 lds
    s_waitcnt lgkmcnt(6)
    v_mfma_f32_32x32x16_bf16 a[16:31], a[0:3], a[8:11], a[16:31]
    ds_read_b64_tr_b16 a[12:13], v231 offset:46080
    ds_read_b64_tr_b16 a[14:15], v231 offset:46336
    buffer_load_dwordx4 v226, s[8:11], s56 offen offset:2048 lds
    s_waitcnt vmcnt(13)
    ds_read_b128 v[36:39], v229 offset:8192
    ds_read_b128 v[40:43], v230 offset:8192
    ds_read_b128 v[44:47], v229 offset:8704
    ds_read_b128 v[48:51], v230 offset:8704
    s_barrier
    s_waitcnt lgkmcnt(10)
    v_mfma_f32_32x32x16_bf16 v[100:115], v[148:151], v[80:83], v[100:115]
    ds_read_b64_tr_b16 v[136:137], v16 offset:1024
    ds_read_b64_tr_b16 v[138:139], v16 offset:1280
    buffer_load_dwordx4 v227, s[8:11], s56 offen offset:3072 lds
    s_waitcnt lgkmcnt(10)
    v_mfma_f32_32x32x16_bf16 v[116:131], v[80:83], v[152:155], v[116:131]
    ds_read_b64_tr_b16 v[140:141], v16 offset:2048
    ds_read_b64_tr_b16 v[142:143], v16 offset:2304
    s_xor_b32 s101, s1, 7
    s_mul_i32 s101, s101, 196608
    s_add_u32 m0, s0, 86016
    s_waitcnt lgkmcnt(10)
    v_mfma_f32_32x32x16_bf16 v[84:99], v[144:147], v[80:83], v[84:99]
    s_add_u32 s101, s101, s58
    s_waitcnt lgkmcnt(8)
    v_mfma_f32_32x32x16_bf16 a[16:31], a[0:3], a[12:15], a[16:31]
    ds_read_b64_tr_b16 a[8:9], v232 offset:0
    ds_read_b64_tr_b16 a[10:11], v232 offset:256
    buffer_load_dwordx4 v228, s[12:15], s101 offen offset:1024 lds
    s_waitcnt lgkmcnt(9)
    v_dot2_f32_bf16 v204, v36, v212, v204
    v_dot2_f32_bf16 v205, v36, v36, v205
    v_dot2_f32_bf16 v206, v37, v212, v206
    v_dot2_f32_bf16 v207, v37, v37, v207
    v_dot2_f32_bf16 v208, v38, v212, v208
    v_dot2_f32_bf16 v209, v38, v38, v209
    v_dot2_f32_bf16 v210, v39, v212, v210
    v_dot2_f32_bf16 v211, v39, v39, v211
    s_waitcnt lgkmcnt(8)
    v_dot2_f32_bf16 v204, v40, v212, v204
    v_dot2_f32_bf16 v205, v40, v40, v205
    v_dot2_f32_bf16 v206, v41, v212, v206
    v_dot2_f32_bf16 v207, v41, v41, v207
    v_dot2_f32_bf16 v208, v42, v212, v208
    v_dot2_f32_bf16 v209, v42, v42, v209
    v_dot2_f32_bf16 v210, v43, v212, v210
    v_dot2_f32_bf16 v211, v43, v43, v211
    s_waitcnt lgkmcnt(7)
    v_dot2_f32_bf16 v204, v44, v212, v204
    v_dot2_f32_bf16 v205, v44, v44, v205
    v_dot2_f32_bf16 v206, v45, v212, v206
    v_dot2_f32_bf16 v207, v45, v45, v207
    v_dot2_f32_bf16 v208, v46, v212, v208
    v_dot2_f32_bf16 v209, v46, v46, v209
    v_dot2_f32_bf16 v210, v47, v212, v210
    v_dot2_f32_bf16 v211, v47, v47, v211
    s_waitcnt lgkmcnt(6)
    v_dot2_f32_bf16 v204, v48, v212, v204
    v_dot2_f32_bf16 v205, v48, v48, v205
    v_dot2_f32_bf16 v206, v49, v212, v206
    v_dot2_f32_bf16 v207, v49, v49, v207
    v_dot2_f32_bf16 v208, v50, v212, v208
    v_dot2_f32_bf16 v209, v50, v50, v209
    v_dot2_f32_bf16 v210, v51, v212, v210
    v_dot2_f32_bf16 v211, v51, v51, v211
    s_waitcnt lgkmcnt(4)
    v_mfma_f32_32x32x16_bf16 v[100:115], v[136:139], v[20:23], v[100:115]
    ds_read_b64_tr_b16 v[148:149], v16 offset:4096
    ds_read_b64_tr_b16 v[150:151], v16 offset:4352
    buffer_load_dwordx4 v228, s[12:15], s101 offen offset:2048 lds
    s_waitcnt lgkmcnt(4)
    v_mfma_f32_32x32x16_bf16 v[116:131], v[20:23], v[140:143], v[116:131]
    ds_read_b64_tr_b16 v[152:153], v16 offset:5120
    ds_read_b64_tr_b16 v[154:155], v16 offset:5376
    buffer_load_dwordx4 v228, s[12:15], s101 offen offset:0 lds
    s_waitcnt lgkmcnt(4)
    v_mfma_f32_32x32x16_bf16 a[16:31], a[0:3], a[8:11], a[16:31]
    ds_read_b64_tr_b16 a[12:13], v232 offset:3072
    ds_read_b64_tr_b16 a[14:15], v232 offset:3328
    s_waitcnt lgkmcnt(4)
    v_mfma_f32_32x32x16_bf16 v[100:115], v[148:151], v[24:27], v[100:115]
    ds_read_b64_tr_b16 v[136:137], v16 offset:7168
    ds_read_b64_tr_b16 v[138:139], v16 offset:7424
    buffer_load_dword v235, v234, s[32:35], 0 offen sc1
    s_waitcnt lgkmcnt(4)
    v_mfma_f32_32x32x16_bf16 v[116:131], v[24:27], v[152:155], v[116:131]
    ds_read_b64_tr_b16 v[140:141], v16 offset:8192
    ds_read_b64_tr_b16 v[142:143], v16 offset:8448
    buffer_load_dwordx4 v[4:7], v222, s[8:11], 0 offen
    s_waitcnt lgkmcnt(4)
    v_mfma_f32_32x32x16_bf16 a[16:31], a[0:3], a[12:15], a[16:31]
    ds_read_b64_tr_b16 a[8:9], v232 offset:6144
    ds_read_b64_tr_b16 a[10:11], v232 offset:6400
    buffer_load_dwordx4 v[8:11], v223, s[8:11], 0 offen
    s_waitcnt lgkmcnt(4)
    v_mfma_f32_32x32x16_bf16 v[100:115], v[136:139], v[28:31], v[100:115]
    ds_read_b64_tr_b16 v[148:149], v16 offset:10240
    ds_read_b64_tr_b16 v[150:151], v16 offset:10496
    buffer_load_dwordx4 a[48:51], v216, s[92:95], 0 offen
    s_waitcnt lgkmcnt(4)
    v_mfma_f32_32x32x16_bf16 v[116:131], v[28:31], v[140:143], v[116:131]
    ds_read_b64_tr_b16 v[152:153], v16 offset:11264
    ds_read_b64_tr_b16 v[154:155], v16 offset:11520
    buffer_load_dwordx4 a[52:55], v217, s[92:95], 0 offen
    s_waitcnt lgkmcnt(4)
    v_mfma_f32_32x32x16_bf16 a[16:31], a[0:3], a[8:11], a[16:31]
    ds_read_b64_tr_b16 a[12:13], v232 offset:9216
    ds_read_b64_tr_b16 a[14:15], v232 offset:9472
    buffer_load_dwordx4 a[56:59], v218, s[92:95], 0 offen
    s_waitcnt vmcnt(16)
    ds_read_b128 v[52:55], v229 offset:0
    ds_read_b128 v[56:59], v230 offset:0
    ds_read_b128 v[60:63], v229 offset:512
    ds_read_b128 v[64:67], v230 offset:512
    s_barrier
    s_waitcnt lgkmcnt(8)
    v_mfma_f32_32x32x16_bf16 v[100:115], v[148:151], v[32:35], v[100:115]
    ds_read_b64_tr_b16 v[136:137], v16 offset:13312
    ds_read_b64_tr_b16 v[138:139], v16 offset:13568
    buffer_load_dwordx4 a[60:63], v219, s[92:95], 0 offen
    s_waitcnt lgkmcnt(8)
    v_mfma_f32_32x32x16_bf16 v[116:131], v[32:35], v[152:155], v[116:131]
    ds_read_b64_tr_b16 v[140:141], v16 offset:14336
    ds_read_b64_tr_b16 v[142:143], v16 offset:14592
    s_waitcnt lgkmcnt(8)
    v_mfma_f32_32x32x16_bf16 a[16:31], a[0:3], a[12:15], a[16:31]
    ds_read_b64_tr_b16 a[8:9], v232 offset:12288
    ds_read_b64_tr_b16 a[10:11], v232 offset:12544
    s_waitcnt lgkmcnt(9)
    v_dot2_f32_bf16 v204, v52, v212, v204
    v_dot2_f32_bf16 v205, v52, v52, v205
    v_dot2_f32_bf16 v206, v53, v212, v206
    v_dot2_f32_bf16 v207, v53, v53, v207
    v_dot2_f32_bf16 v208, v54, v212, v208
    v_dot2_f32_bf16 v209, v54, v54, v209
    v_dot2_f32_bf16 v210, v55, v212, v210
    v_dot2_f32_bf16 v211, v55, v55, v211
    s_waitcnt lgkmcnt(8)
    v_dot2_f32_bf16 v204, v56, v212, v204
    v_dot2_f32_bf16 v205, v56, v56, v205
    v_dot2_f32_bf16 v206, v57, v212, v206
    v_dot2_f32_bf16 v207, v57, v57, v207
    v_dot2_f32_bf16 v208, v58, v212, v208
    v_dot2_f32_bf16 v209, v58, v58, v209
    v_dot2_f32_bf16 v210, v59, v212, v210
    v_dot2_f32_bf16 v211, v59, v59, v211
    s_waitcnt lgkmcnt(7)
    v_dot2_f32_bf16 v204, v60, v212, v204
    v_dot2_f32_bf16 v205, v60, v60, v205
    v_dot2_f32_bf16 v206, v61, v212, v206
    v_dot2_f32_bf16 v207, v61, v61, v207
    v_dot2_f32_bf16 v208, v62, v212, v208
    v_dot2_f32_bf16 v209, v62, v62, v209
    v_dot2_f32_bf16 v210, v63, v212, v210
    v_dot2_f32_bf16 v211, v63, v63, v211
    s_waitcnt lgkmcnt(6)
    v_dot2_f32_bf16 v204, v64, v212, v204
    v_dot2_f32_bf16 v205, v64, v64, v205
    v_dot2_f32_bf16 v206, v65, v212, v206
    v_dot2_f32_bf16 v207, v65, v65, v207
    v_dot2_f32_bf16 v208, v66, v212, v208
    v_dot2_f32_bf16 v209, v66, v66, v209
    v_dot2_f32_bf16 v210, v67, v212, v210
    v_dot2_f32_bf16 v211, v67, v67, v211
    s_waitcnt lgkmcnt(4)
    v_mfma_f32_32x32x16_bf16 v[100:115], v[136:139], v[36:39], v[100:115]
    ds_read_b64_tr_b16 v[148:149], v16 offset:16384
    ds_read_b64_tr_b16 v[150:151], v16 offset:16640
    s_waitcnt lgkmcnt(4)
    v_mfma_f32_32x32x16_bf16 v[116:131], v[36:39], v[140:143], v[116:131]
    ds_read_b64_tr_b16 v[152:153], v16 offset:17408
    ds_read_b64_tr_b16 v[154:155], v16 offset:17664
    s_waitcnt lgkmcnt(4)
    v_mfma_f32_32x32x16_bf16 a[16:31], a[0:3], a[8:11], a[16:31]
    ds_read_b64_tr_b16 a[12:13], v232 offset:15360
    ds_read_b64_tr_b16 a[14:15], v232 offset:15616
    s_waitcnt lgkmcnt(4)
    v_mfma_f32_32x32x16_bf16 v[100:115], v[148:151], v[40:43], v[100:115]
    ds_read_b64_tr_b16 v[136:137], v16 offset:19456
    ds_read_b64_tr_b16 v[138:139], v16 offset:19712
    s_waitcnt lgkmcnt(4)
    v_mfma_f32_32x32x16_bf16 v[116:131], v[40:43], v[152:155], v[116:131]
    ds_read_b64_tr_b16 v[140:141], v16 offset:20480
    ds_read_b64_tr_b16 v[142:143], v16 offset:20736
    s_waitcnt lgkmcnt(4)
    v_mfma_f32_32x32x16_bf16 a[16:31], a[0:3], a[12:15], a[16:31]
    ds_read_b64_tr_b16 a[8:9], v232 offset:18432
    ds_read_b64_tr_b16 a[10:11], v232 offset:18688
    s_waitcnt lgkmcnt(4)
    v_mfma_f32_32x32x16_bf16 v[100:115], v[136:139], v[44:47], v[100:115]
    ds_read_b64_tr_b16 v[148:149], v16 offset:22528
    ds_read_b64_tr_b16 v[150:151], v16 offset:22784
    s_waitcnt lgkmcnt(4)
    v_mfma_f32_32x32x16_bf16 v[116:131], v[44:47], v[140:143], v[116:131]
    ds_read_b64_tr_b16 v[152:153], v16 offset:23552
    ds_read_b64_tr_b16 v[154:155], v16 offset:23808
    s_waitcnt lgkmcnt(4)
    v_mfma_f32_32x32x16_bf16 a[16:31], a[0:3], a[8:11], a[16:31]
    ds_read_b64_tr_b16 a[12:13], v232 offset:21504
    ds_read_b64_tr_b16 a[14:15], v232 offset:21760
    s_waitcnt vmcnt(10)
    ds_read_b128 v[68:71], v229 offset:4096
    ds_read_b128 v[72:75], v230 offset:4096
    ds_read_b128 v[76:79], v229 offset:4608
    ds_read_b128 v[80:83], v230 offset:4608
    s_barrier
    s_waitcnt lgkmcnt(8)
    v_mfma_f32_32x32x16_bf16 v[100:115], v[148:151], v[48:51], v[100:115]
    ds_read_b64_tr_b16 v[136:137], v16 offset:25600
    ds_read_b64_tr_b16 v[138:139], v16 offset:25856
    s_waitcnt lgkmcnt(8)
    v_mfma_f32_32x32x16_bf16 v[116:131], v[48:51], v[152:155], v[116:131]
    ds_read_b64_tr_b16 v[140:141], v16 offset:26624
    ds_read_b64_tr_b16 v[142:143], v16 offset:26880
    s_waitcnt lgkmcnt(8)
    v_mfma_f32_32x32x16_bf16 a[16:31], a[0:3], a[12:15], a[16:31]
    ds_read_b64_tr_b16 a[8:9], v232 offset:24576
    ds_read_b64_tr_b16 a[10:11], v232 offset:24832
    s_waitcnt lgkmcnt(9)
    v_dot2_f32_bf16 v204, v68, v212, v204
    v_dot2_f32_bf16 v205, v68, v68, v205
    v_dot2_f32_bf16 v206, v69, v212, v206
    v_dot2_f32_bf16 v207, v69, v69, v207
    v_dot2_f32_bf16 v208, v70, v212, v208
    v_dot2_f32_bf16 v209, v70, v70, v209
    v_dot2_f32_bf16 v210, v71, v212, v210
    v_dot2_f32_bf16 v211, v71, v71, v211
    s_waitcnt lgkmcnt(8)
    v_dot2_f32_bf16 v204, v72, v212, v204
    v_dot2_f32_bf16 v205, v72, v72, v205
    v_dot2_f32_bf16 v206, v73, v212, v206
    v_dot2_f32_bf16 v207, v73, v73, v207
    v_dot2_f32_bf16 v208, v74, v212, v208
    v_dot2_f32_bf16 v209, v74, v74, v209
    v_dot2_f32_bf16 v210, v75, v212, v210
    v_dot2_f32_bf16 v211, v75, v75, v211
    s_waitcnt lgkmcnt(7)
    v_dot2_f32_bf16 v204, v76, v212, v204
    v_dot2_f32_bf16 v205, v76, v76, v205
    v_dot2_f32_bf16 v206, v77, v212, v206
    v_dot2_f32_bf16 v207, v77, v77, v207
    v_dot2_f32_bf16 v208, v78, v212, v208
    v_dot2_f32_bf16 v209, v78, v78, v209
    v_dot2_f32_bf16 v210, v79, v212, v210
    v_dot2_f32_bf16 v211, v79, v79, v211
    s_waitcnt lgkmcnt(6)
    v_dot2_f32_bf16 v204, v80, v212, v204
    v_dot2_f32_bf16 v205, v80, v80, v205
    v_dot2_f32_bf16 v206, v81, v212, v206
    v_dot2_f32_bf16 v207, v81, v81, v207
    v_dot2_f32_bf16 v208, v82, v212, v208
    v_dot2_f32_bf16 v209, v82, v82, v209
    v_dot2_f32_bf16 v210, v83, v212, v210
    v_dot2_f32_bf16 v211, v83, v83, v211
    s_waitcnt lgkmcnt(4)
    v_mfma_f32_32x32x16_bf16 v[100:115], v[136:139], v[52:55], v[100:115]
    ds_read_b64_tr_b16 v[148:149], v16 offset:28672
    ds_read_b64_tr_b16 v[150:151], v16 offset:28928
    s_waitcnt lgkmcnt(4)
    v_mfma_f32_32x32x16_bf16 v[116:131], v[52:55], v[140:143], v[116:131]
    ds_read_b64_tr_b16 v[152:153], v16 offset:29696
    ds_read_b64_tr_b16 v[154:155], v16 offset:29952
    s_waitcnt lgkmcnt(4)
    v_mfma_f32_32x32x16_bf16 a[16:31], a[0:3], a[8:11], a[16:31]
    ds_read_b64_tr_b16 a[12:13], v232 offset:27648
    ds_read_b64_tr_b16 a[14:15], v232 offset:27904
    s_waitcnt lgkmcnt(4)
    v_mfma_f32_32x32x16_bf16 v[100:115], v[148:151], v[56:59], v[100:115]
    ds_read_b64_tr_b16 v[136:137], v16 offset:31744
    ds_read_b64_tr_b16 v[138:139], v16 offset:32000
    s_waitcnt lgkmcnt(4)
    v_mfma_f32_32x32x16_bf16 v[116:131], v[56:59], v[152:155], v[116:131]
    ds_read_b64_tr_b16 v[140:141], v16 offset:32768
    ds_read_b64_tr_b16 v[142:143], v16 offset:33024
    s_waitcnt lgkmcnt(4)
    v_mfma_f32_32x32x16_bf16 a[16:31], a[0:3], a[12:15], a[16:31]
    ds_read_b64_tr_b16 a[8:9], v232 offset:30720
    ds_read_b64_tr_b16 a[10:11], v232 offset:30976
    s_waitcnt lgkmcnt(4)
    v_mfma_f32_32x32x16_bf16 v[100:115], v[136:139], v[60:63], v[100:115]
    ds_read_b64_tr_b16 v[148:149], v16 offset:34816
    ds_read_b64_tr_b16 v[150:151], v16 offset:35072
    s_waitcnt lgkmcnt(4)
    v_mfma_f32_32x32x16_bf16 v[116:131], v[60:63], v[140:143], v[116:131]
    ds_read_b64_tr_b16 v[152:153], v16 offset:35840
    ds_read_b64_tr_b16 v[154:155], v16 offset:36096
    s_waitcnt lgkmcnt(4)
    v_mfma_f32_32x32x16_bf16 a[16:31], a[0:3], a[8:11], a[16:31]
    ds_read_b64_tr_b16 a[12:13], v232 offset:33792
    ds_read_b64_tr_b16 a[14:15], v232 offset:34048
    s_waitcnt vmcnt(7)
    s_barrier
    s_waitcnt lgkmcnt(4)
    v_mfma_f32_32x32x16_bf16 v[100:115], v[148:151], v[64:67], v[100:115]
    ds_read_b64_tr_b16 v[136:137], v16 offset:37888
    ds_read_b64_tr_b16 v[138:139], v16 offset:38144
    s_waitcnt vmcnt(6)
    v_cmp_gt_u32 vcc, 1, v235
    s_cbranch_vccnz Lspin_5
Lback_6:
    v_add_f32 v204, v204, v208
    s_waitcnt lgkmcnt(4)
    v_mfma_f32_32x32x16_bf16 v[116:131], v[64:67], v[152:155], v[116:131]
    ds_read_b64_tr_b16 v[140:141], v16 offset:38912
    ds_read_b64_tr_b16 v[142:143], v16 offset:39168
    v_add_f32 v205, v205, v209
    v_add_f32 v206, v206, v210
    v_add_f32 v207, v207, v211
    s_waitcnt lgkmcnt(4)
    v_mfma_f32_32x32x16_bf16 a[16:31], a[0:3], a[12:15], a[16:31]
    ds_read_b64_tr_b16 a[8:9], v232 offset:36864
    ds_read_b64_tr_b16 a[10:11], v232 offset:37120
    v_add_f32 v14, v204, v206
    v_add_f32 v15, v205, v207
    v_mov_b32 v17, v14
    s_waitcnt lgkmcnt(4)
    v_mfma_f32_32x32x16_bf16 v[100:115], v[136:139], v[68:71], v[100:115]
    ds_read_b64_tr_b16 v[148:149], v16 offset:40960
    ds_read_b64_tr_b16 v[150:151], v16 offset:41216
    v_mov_b32 v18, v15
    v_permlane32_swap_b32 v17, v14
    s_nop 0
    v_permlane32_swap_b32 v18, v15
    s_waitcnt lgkmcnt(4)
    v_mfma_f32_32x32x16_bf16 v[116:131], v[68:71], v[140:143], v[116:131]
    ds_read_b64_tr_b16 v[152:153], v16 offset:41984
    ds_read_b64_tr_b16 v[154:155], v16 offset:42240
    v_add_f32 v14, v14, v17
    v_add_f32 v15, v15, v18
    v_mul_f32 v12, 0xbb000000, v14
    s_waitcnt lgkmcnt(4)
    v_mfma_f32_32x32x16_bf16 a[16:31], a[0:3], a[8:11], a[16:31]
    ds_read_b64_tr_b16 a[12:13], v232 offset:39936
    ds_read_b64_tr_b16 a[14:15], v232 offset:40192
    v_mul_f32 v17, 0x3b000000, v15
    v_fma_f32 v17, -v12, v12, v17
    v_max_f32 v17, 0, v17
    s_waitcnt lgkmcnt(4)
    v_mfma_f32_32x32x16_bf16 v[100:115], v[148:151], v[72:75], v[100:115]
    ds_read_b64_tr_b16 v[136:137], v16 offset:44032
    ds_read_b64_tr_b16 v[138:139], v16 offset:44288
    v_add_f32 v17, 0x3727c5ac, v17
    v_rsq_f32 v13, v17
    s_waitcnt lgkmcnt(4)
    v_mfma_f32_32x32x16_bf16 v[116:131], v[72:75], v[152:155], v[116:131]
    ds_read_b64_tr_b16 v[140:141], v16 offset:45056
    ds_read_b64_tr_b16 v[142:143], v16 offset:45312
    v_cvt_pk_bf16_f32 v17, v12, v12
    v_and_b32 v17, 0xffff0000, v17
    v_sub_f32 v17, v12, v17
    s_waitcnt lgkmcnt(4)
    v_mfma_f32_32x32x16_bf16 a[16:31], a[0:3], a[12:15], a[16:31]
    ds_read_b64_tr_b16 a[8:9], v232 offset:43008
    ds_read_b64_tr_b16 a[10:11], v232 offset:43264
    v_cvt_pk_bf16_f32 v156, v12, v17
    v_mov_b32 v157, 0
    v_mov_b32 v158, 0
    s_waitcnt lgkmcnt(4)
    v_mfma_f32_32x32x16_bf16 v[100:115], v[136:139], v[76:79], v[100:115]
    ds_read_b64_tr_b16 v[148:149], v16 offset:47104
    ds_read_b64_tr_b16 v[150:151], v16 offset:47360
    v_mov_b32 v159, 0
    s_lshl_b32 s42, s38, 8
    s_add_u32 s42, s42, 149760
    s_waitcnt lgkmcnt(4)
    v_mfma_f32_32x32x16_bf16 v[116:131], v[76:79], v[140:143], v[116:131]
    ds_read_b64_tr_b16 v[152:153], v16 offset:48128
    ds_read_b64_tr_b16 v[154:155], v16 offset:48384
    v_and_b32 v17, 31, v0
    v_lshl_add_u32 v17, v17, 2, s42
    ds_write_b32 v17, v13
    s_waitcnt lgkmcnt(5)
    v_mfma_f32_32x32x16_bf16 a[16:31], a[0:3], a[8:11], a[16:31]
    ds_read_b64_tr_b16 a[12:13], v232 offset:46080
    ds_read_b64_tr_b16 a[14:15], v232 offset:46336
    v_lshrrev_b32 v18, 5, v0
    v_lshl_add_u32 v18, v18, 4, s42
    v_lshlrev_b32 v17, 2, v0
    v_add_u32 v17, 147712, v17
    s_lshl_b32 s57, s37, 6
    s_add_u32 s57, s57, s52
    s_lshl_b32 s57, s57, 12
    s_add_u32 s57, s57, 16777216
    s_add_u32 s42, s38, 4
    s_mul_i32 s42, s42, 4112
    s_add_u32 s42, s42, 98304
    v_add_u32 v19, s42, v1
    v_mov_b32 v193, 0
    v_mov_b32 v195, 0
    v_mov_b32 v197, 0
    v_mov_b32 v198, 0
    v_mov_b32 v199, 0
    s_min_u32 s43, s38, 2
    s_lshl_b32 s43, s43, 8
    s_add_u32 s43, s43, 147712
    v_add_u32 v203, s43, v241
    s_waitcnt lgkmcnt(5)
    v_mfma_f32_32x32x16_bf16 v[100:115], v[148:151], v[80:83], v[100:115]
    ds_read_b64_tr_b16 v[132:133], v16 offset:0
    ds_read_b64_tr_b16 v[134:135], v16 offset:256
    s_waitcnt lgkmcnt(5)
    v_mfma_f32_32x32x16_bf16 v[116:131], v[80:83], v[152:155], v[116:131]
    s_waitcnt lgkmcnt(2)
    v_mfma_f32_32x32x16_bf16 a[16:31], a[0:3], a[12:15], a[16:31]
    ds_read_b64_tr_b16 v[144:145], v16 offset:3072
    ds_read_b64_tr_b16 v[146:147], v16 offset:3328
    s_waitcnt lgkmcnt(2)
    v_mfma_f32_32x32x16_bf16 v[84:99], v[132:135], v[20:23], v[84:99]
    ds_read_b128 v[136:139], v18 offset:0
    ds_read_b128 v[140:143], v18 offset:32
    ds_read_b128 v[148:151], v18 offset:64
    ds_read_b128 v[152:155], v18 offset:96
    v_cmp_gt_u32 vcc, 32, v0
    s_nop 2
    v_accvgpr_read_b32 v200, a16
    v_cvt_pk_bf16_f32 v201, v200, v200
    v_and_b32 v202, 0xffff0000, v201
    v_sub_f32 v202, v200, v202
    v_cvt_pk_bf16_f32 v202, v202, v202
    v_cndmask_b32 v201, v202, v201, vcc
    ds_write_b32 v203, v201
    s_waitcnt lgkmcnt(0)
    s_barrier
    ds_read_b32 v192, v17 offset:256
    ds_read_b64_tr_b16 v[132:133], v16 offset:6144
    ds_read_b64_tr_b16 v[134:135], v16 offset:6400
    v_mfma_f32_32x32x16_bf16 v[84:99], v[144:147], v[24:27], v[84:99]
    ds_read_b32 v194, v17 offset:512
    ds_read_b32 v196, v17
    ds_read_b64_tr_b16 v[144:145], v16 offset:9216
    ds_read_b64_tr_b16 v[146:147], v16 offset:9472
    s_waitcnt lgkmcnt(4)
    v_mfma_f32_32x32x16_bf16 v[84:99], v[132:135], v[28:31], v[84:99]
    ds_read_b64_tr_b16 v[132:133], v16 offset:12288
    ds_read_b64_tr_b16 v[134:135], v16 offset:12544
    s_waitcnt lgkmcnt(2)
    v_mfma_f32_32x32x16_bf16 v[84:99], v[144:147], v[32:35], v[84:99]
    v_mfma_f32_32x32x16_bf16 v[100:115], v[192:195], v[156:159], v[100:115]
    v_mfma_f32_32x32x16_bf16 v[116:131], v[156:159], v[194:197], v[116:131]
    v_mfma_f32_32x32x16_bf16 v[84:99], v[196:199], v[156:159], v[84:99]
    s_nop 9
    v_mul_f32 v100, v100, v13
    v_mul_f32 v101, v101, v13
    v_mul_f32 v102, v102, v13
    v_mul_f32 v103, v103, v13
    v_mul_f32 v104, v104, v13
    v_mul_f32 v105, v105, v13
    v_mul_f32 v106, v106, v13
    v_mul_f32 v107, v107, v13
    v_cvt_pk_bf16_f32 v100, v100, v101
    v_cvt_pk_bf16_f32 v101, v102, v103
    v_cvt_pk_bf16_f32 v102, v104, v105
    ds_read_b64_tr_b16 v[144:145], v16 offset:15360
    ds_read_b64_tr_b16 v[146:147], v16 offset:15616
    s_waitcnt lgkmcnt(2)
    v_mfma_f32_32x32x16_bf16 v[84:99], v[132:135], v[36:39], v[84:99]
    v_cvt_pk_bf16_f32 v103, v106, v107
    buffer_store_dwordx4 v[100:103], v1, s[4:7], s57 offen offset:0 sc1
    v_mul_f32 v108, v108, v13
    v_mul_f32 v109, v109, v13
    v_mul_f32 v110, v110, v13
    v_mul_f32 v111, v111, v13
    v_mul_f32 v112, v112, v13
    v_mul_f32 v113, v113, v13
    v_mul_f32 v114, v114, v13
    v_mul_f32 v115, v115, v13
    v_cvt_pk_bf16_f32 v104, v108, v109
    v_cvt_pk_bf16_f32 v105, v110, v111
    v_cvt_pk_bf16_f32 v106, v112, v113
    v_cvt_pk_bf16_f32 v107, v114, v115
    ds_read_b64_tr_b16 v[132:133], v16 offset:18432
    ds_read_b64_tr_b16 v[134:135], v16 offset:18688
    s_waitcnt lgkmcnt(2)
    v_mfma_f32_32x32x16_bf16 v[84:99], v[144:147], v[40:43], v[84:99]
    buffer_store_dwordx4 v[104:107], v1, s[4:7], s57 offen offset:1024 sc1
    v_mul_f32 v116, v116, v136
    v_mul_f32 v117, v117, v137
    v_mul_f32 v118, v118, v138
    v_mul_f32 v119, v119, v139
    v_mul_f32 v120, v120, v140
    v_mul_f32 v121, v121, v141
    v_mul_f32 v122, v122, v142
    v_mul_f32 v123, v123, v143
    v_cvt_pk_bf16_f32 v116, v116, v117
    v_cvt_pk_bf16_f32 v117, v118, v119
    v_cvt_pk_bf16_f32 v118, v120, v121
    v_cvt_pk_bf16_f32 v119, v122, v123
    buffer_store_dwordx4 v[116:119], v1, s[4:7], s57 offen offset:2048 sc1
    ds_read_b64_tr_b16 v[144:145], v16 offset:21504
    ds_read_b64_tr_b16 v[146:147], v16 offset:21760
    s_waitcnt lgkmcnt(2)
    v_mfma_f32_32x32x16_bf16 v[84:99], v[132:135], v[44:47], v[84:99]
    v_mul_f32 v124, v124, v148
    v_mul_f32 v125, v125, v149
    v_mul_f32 v126, v126, v150
    v_mul_f32 v127, v127, v151
    v_mul_f32 v128, v128, v152
    v_mul_f32 v129, v129, v153
    v_mul_f32 v130, v130, v154
    v_mul_f32 v131, v131, v155
    v_cvt_pk_bf16_f32 v120, v124, v125
    v_cvt_pk_bf16_f32 v121, v126, v127
    v_cvt_pk_bf16_f32 v122, v128, v129
    v_cvt_pk_bf16_f32 v123, v130, v131
    buffer_store_dwordx4 v[120:123], v1, s[4:7], s57 offen offset:3072 sc1
    ds_read_b64_tr_b16 v[132:133], v16 offset:24576
    ds_read_b64_tr_b16 v[134:135], v16 offset:24832
    s_waitcnt lgkmcnt(2)
    v_mfma_f32_32x32x16_bf16 v[84:99], v[144:147], v[48:51], v[84:99]
    ds_write_b128 v19, v[100:103] offset:0
    ds_write_b128 v19, v[104:107] offset:1024
    ds_read_b64_tr_b16 v[144:145], v16 offset:27648
    ds_read_b64_tr_b16 v[146:147], v16 offset:27904
    s_waitcnt lgkmcnt(4)
    v_mfma_f32_32x32x16_bf16 v[84:99], v[132:135], v[52:55], v[84:99]
    ds_write_b128 v19, v[116:119] offset:2048
    ds_write_b128 v19, v[120:123] offset:3072
    v_min_u32 v17, 11, v0
    ds_read_b64_tr_b16 v[132:133], v16 offset:30720
    ds_read_b64_tr_b16 v[134:135], v16 offset:30976
    s_waitcnt lgkmcnt(4)
    v_mfma_f32_32x32x16_bf16 v[84:99], v[144:147], v[56:59], v[84:99]
    v_lshrrev_b32 v15, 1, v17
    v_and_b32 v15, 6, v15
    v_bfe_u32 v15, 18, v15, 2
    v_mov_b32 v108, 0x3f803f80
    v_cmp_ge_u32 vcc, s36, v15
    ds_read_b64_tr_b16 v[144:145], v16 offset:33792
    ds_read_b64_tr_b16 v[146:147], v16 offset:34048
    s_waitcnt lgkmcnt(2)
    v_mfma_f32_32x32x16_bf16 v[84:99], v[132:135], v[60:63], v[84:99]
    v_mul_u32_u24 v17, 4112, v17
    v_add_u32 v17, 102400, v17
    v_cndmask_b32 v108, 0, v108, vcc
    v_mov_b32 v109, v108
    v_mov_b32 v110, v108
    ds_read_b64_tr_b16 v[132:133], v16 offset:36864
    ds_read_b64_tr_b16 v[134:135], v16 offset:37120
    s_waitcnt lgkmcnt(2)
    v_mfma_f32_32x32x16_bf16 v[84:99], v[144:147], v[64:67], v[84:99]
    v_mov_b32 v111, v108
    ds_write_b128 v17, v[108:111]
    s_lshl_b32 s42, s37, 7
    s_lshl2_add_u32 s42, s38, s42
    ds_read_b64_tr_b16 v[144:145], v16 offset:39936
    ds_read_b64_tr_b16 v[146:147], v16 offset:40192
    s_waitcnt lgkmcnt(3)
    v_mfma_f32_32x32x16_bf16 v[84:99], v[132:135], v[68:71], v[84:99]
    s_add_u32 s42, s42, s50
    s_add_u32 s42, s42, 4096
    s_add_u32 s43, s51, 256
    v_mov_b32 v14, s43
    v_mov_b32 v19, 0
    ds_read_b64_tr_b16 v[132:133], v16 offset:43008
    ds_read_b64_tr_b16 v[134:135], v16 offset:43264
    s_waitcnt lgkmcnt(2)
    v_mfma_f32_32x32x16_bf16 v[84:99], v[144:147], v[72:75], v[84:99]
    v_mul_f32 v12, 0x3eb8aa3b, v13
    s_waitcnt vmcnt(7)
    ds_write_b128 v242, a[48:51] offset:0
    ds_read_b64_tr_b16 a[48:49], v243 offset:0
    ds_read_b64_tr_b16 a[50:51], v243 offset:256
    ds_read_b64_tr_b16 v[144:145], v16 offset:46080
    ds_read_b64_tr_b16 v[146:147], v16 offset:46336
    s_waitcnt lgkmcnt(5)
    v_mfma_f32_32x32x16_bf16 v[84:99], v[132:135], v[76:79], v[84:99]
    s_waitcnt vmcnt(6)
    ds_write_b128 v242, a[52:55] offset:0
    ds_read_b64_tr_b16 a[52:53], v243 offset:0
    ds_read_b64_tr_b16 a[54:55], v243 offset:256
    s_waitcnt lgkmcnt(3)
    v_mfma_f32_32x32x16_bf16 v[84:99], v[144:147], v[80:83], v[84:99]
    s_waitcnt vmcnt(5)
    ds_write_b128 v242, a[56:59] offset:0
    ds_read_b64_tr_b16 a[56:57], v243 offset:0
    ds_read_b64_tr_b16 a[58:59], v243 offset:256
    s_waitcnt vmcnt(4)
    ds_write_b128 v242, a[60:63] offset:0
    ds_read_b64_tr_b16 a[60:61], v243 offset:0
    ds_read_b64_tr_b16 a[62:63], v243 offset:256
    buffer_store_dwordx4 a[48:51], v244, s[4:7], 0 offen sc1
    v_mfma_f32_32x32x16_bf16 a[64:79], a[0:3], a[48:51], 0
    s_waitcnt lgkmcnt(6)
    buffer_store_dwordx4 a[52:55], v245, s[4:7], 0 offen sc1
    v_mfma_f32_32x32x16_bf16 a[80:95], a[0:3], a[52:55], 0
    s_waitcnt lgkmcnt(3)
    buffer_store_dwordx4 a[56:59], v246, s[4:7], 0 offen sc1
    v_mfma_f32_32x32x16_bf16 a[64:79], a[0:3], a[56:59], a[64:79]
    s_waitcnt lgkmcnt(0)
    buffer_store_dwordx4 a[60:63], v247, s[4:7], 0 offen sc1
    v_mfma_f32_32x32x16_bf16 a[80:95], a[0:3], a[60:63], a[80:95]
    s_nop 8
    buffer_store_dword a64, v221, s[4:7], 0 offen sc1
    s_nop 1
    buffer_store_dword a80, v221, s[4:7], 0 offen offset:2048 sc1
    s_sub_u32 s56, s42, 8192
    s_sub_u32 s58, s42, 16384
    s_sub_u32 s59, s57, 32768
    s_sub_u32 s57, s57, 16384
    s_cmp_lt_u32 s36, 1
    s_cselect_b32 s56, s42, s56
    s_cselect_b32 s57, 0x7ff00000, s57
    s_cmp_lt_u32 s36, 2
    s_cselect_b32 s58, s56, s58
    s_cselect_b32 s59, 0x7ff00000, s59
    s_mul_i32 s47, s38, 4112
    s_add_u32 s47, s47, 98304
    s_add_u32 s0, s47, 32896
    v_mov_b32 v112, v14
    s_mov_b32 s92, s42
    s_waitcnt vmcnt(6)
    buffer_store_dword v14, v19, s[4:7], s42 offen offset:0 sc1
    v_and_b32 v16, 1, v0
    s_sub_u32 s43, s56, s58
    v_mul_lo_u32 v16, v16, s43
    v_pk_mul_f32 v[84:85], v[84:85], v[12:13] op_sel_hi:[1,0]
    v_pk_mul_f32 v[86:87], v[86:87], v[12:13] op_sel_hi:[1,0]
    v_pk_mul_f32 v[88:89], v[88:89], v[12:13] op_sel_hi:[1,0]
    v_pk_mul_f32 v[90:91], v[90:91], v[12:13] op_sel_hi:[1,0]
    v_pk_mul_f32 v[92:93], v[92:93], v[12:13] op_sel_hi:[1,0]
    v_pk_mul_f32 v[94:95], v[94:95], v[12:13] op_sel_hi:[1,0]
    v_pk_mul_f32 v[96:97], v[96:97], v[12:13] op_sel_hi:[1,0]
    v_pk_mul_f32 v[98:99], v[98:99], v[12:13] op_sel_hi:[1,0]
    v_cvt_pk_bf16_f32 v20, v84, v85
    v_cvt_pk_bf16_f32 v21, v86, v87
    v_cvt_pk_bf16_f32 v22, v88, v89
    v_cvt_pk_bf16_f32 v23, v90, v91
    v_cvt_pk_bf16_f32 v24, v92, v93
    v_cvt_pk_bf16_f32 v25, v94, v95
    v_cvt_pk_bf16_f32 v26, v96, v97
    v_cvt_pk_bf16_f32 v27, v98, v99
    s_mul_i32 s54, s38, 4112
    v_add_u32 v18, 98304, v1
    v_add_u32 v12, s54, v18
    v_add_u32 v15, 154880, v1
    s_mul_i32 s55, s52, 114688
    s_lshl_b32 s43, s37, 11
    s_add_u32 s55, s55, s43
    s_add_u32 s55, s55, 8388608
    s_mov_b64 s[96:97], 0
    v_bfe_u32 v28, v0, 4, 1
    v_cmp_eq_u32 vcc, 0, v28
    v_sub_u32 v28, v18, v1
    v_add_u32 v29, 2048, v18
    v_add_u32 v28, 4096, v28
    v_cndmask_b32 v13, v28, v29, vcc
    v_bfe_u32 v28, v0, 4, 1
    v_cmp_eq_u32 vcc, 0, v28
    v_sub_u32 v28, v18, v1
    v_add_u32 v29, 3072, v18
    v_add_u32 v28, 4096, v28
    v_cndmask_b32 v14, v28, v29, vcc
    s_mul_i32 s43, s38, 24576
    v_add_u32 v136, s43, v2
    v_add_u32 v137, s43, v1
    s_barrier
    ds_read_b64_tr_b16 v[112:113], v136 offset:0
    ds_read_b64_tr_b16 v[114:115], v136 offset:256
    ds_read_b64_tr_b16 v[116:117], v136 offset:1024
    ds_read_b64_tr_b16 v[118:119], v136 offset:1280
    ds_read_b64_tr_b16 v[120:121], v136 offset:2048
    ds_read_b64_tr_b16 v[122:123], v136 offset:2304
    ds_read_b64_tr_b16 v[124:125], v136 offset:3072
    ds_read_b64_tr_b16 v[126:127], v136 offset:3328
    ds_read_b64_tr_b16 v[128:129], v136 offset:4096
    ds_read_b64_tr_b16 v[130:131], v136 offset:4352
    ds_read_b64_tr_b16 v[132:133], v136 offset:5120
    ds_read_b64_tr_b16 v[134:135], v136 offset:5376
    s_waitcnt lgkmcnt(10)
    ds_write_b128 v137, v[112:115] offset:0
    s_waitcnt lgkmcnt(9)
    ds_write_b128 v137, v[116:119] offset:1024
    s_waitcnt lgkmcnt(8)
    ds_write_b128 v137, v[120:123] offset:2048
    s_waitcnt lgkmcnt(7)
    ds_write_b128 v137, v[124:127] offset:3072
    s_waitcnt lgkmcnt(6)
    ds_write_b128 v137, v[128:131] offset:4096
    s_waitcnt lgkmcnt(5)
    ds_write_b128 v137, v[132:135] offset:5120
    s_waitcnt vmcnt(1)
    buffer_store_dword v236, v237, s[4:7], s92 offen offset:2048 sc1
    buffer_load_dword v44, v16, s[4:7], s58 offen sc1
    ds_read_b64_tr_b16 v[112:113], v136 offset:6144
    ds_read_b64_tr_b16 v[114:115], v136 offset:6400
    ds_read_b64_tr_b16 v[116:117], v136 offset:7168
    ds_read_b64_tr_b16 v[118:119], v136 offset:7424
    ds_read_b64_tr_b16 v[120:121], v136 offset:8192
    ds_read_b64_tr_b16 v[122:123], v136 offset:8448
    ds_read_b64_tr_b16 v[124:125], v136 offset:9216
    ds_read_b64_tr_b16 v[126:127], v136 offset:9472
    ds_read_b64_tr_b16 v[128:129], v136 offset:10240
    ds_read_b64_tr_b16 v[130:131], v136 offset:10496
    ds_read_b64_tr_b16 v[132:133], v136 offset:11264
    ds_read_b64_tr_b16 v[134:135], v136 offset:11520
    s_waitcnt lgkmcnt(10)
    ds_write_b128 v137, v[112:115] offset:6144
    s_waitcnt lgkmcnt(9)
    ds_write_b128 v137, v[116:119] offset:7168
    s_waitcnt lgkmcnt(8)
    ds_write_b128 v137, v[120:123] offset:8192
    s_waitcnt lgkmcnt(7)
    ds_write_b128 v137, v[124:127] offset:9216
    s_waitcnt lgkmcnt(6)
    ds_write_b128 v137, v[128:131] offset:10240
    s_waitcnt lgkmcnt(5)
    ds_write_b128 v137, v[132:135] offset:11264
    buffer_load_dword v45, v16, s[4:7], s58 offen sc1
    s_waitcnt vmcnt(1)
    v_cmp_gt_u32 vcc, 256, v44
    s_cbranch_vccnz Lspin_7
Lback_8:
    s_mov_b32 m0, s0
    s_nop 0
    buffer_load_dwordx4 v1, s[4:7], s57 offen offset:0 sc1 lds
    buffer_load_dwordx4 v1, s[4:7], s57 offen offset:1024 sc1 lds
    buffer_load_dwordx4 v1, s[4:7], s57 offen offset:2048 sc1 lds
    buffer_load_dwordx4 v1, s[4:7], s57 offen offset:3072 sc1 lds
    s_mov_b32 m0, s47
    s_nop 0
    buffer_load_dwordx4 v1, s[4:7], s59 offen offset:0 sc1 lds
    buffer_load_dwordx4 v1, s[4:7], s59 offen offset:1024 sc1 lds
    buffer_load_dwordx4 v1, s[4:7], s59 offen offset:2048 sc1 lds
    buffer_load_dwordx4 v1, s[4:7], s59 offen offset:3072 sc1 lds
    v_lshrrev_b32 v60, 2, v0
    v_lshlrev_b32 v60, 7, v60
    v_and_b32 v61, 3, v0
    v_lshl_add_u32 v248, v61, 2, v60
    s_add_u32 s101, s50, 4096
    buffer_load_dword a35, v240, s[4:7], 0 offen sc1
    ds_read_b64_tr_b16 v[112:113], v136 offset:12288
    ds_read_b64_tr_b16 v[114:115], v136 offset:12544
    ds_read_b64_tr_b16 v[116:117], v136 offset:13312
    ds_read_b64_tr_b16 v[118:119], v136 offset:13568
    ds_read_b64_tr_b16 v[120:121], v136 offset:14336
    ds_read_b64_tr_b16 v[122:123], v136 offset:14592
    ds_read_b64_tr_b16 v[124:125], v136 offset:15360
    ds_read_b64_tr_b16 v[126:127], v136 offset:15616
    ds_read_b64_tr_b16 v[128:129], v136 offset:16384
    ds_read_b64_tr_b16 v[130:131], v136 offset:16640
    ds_read_b64_tr_b16 v[132:133], v136 offset:17408
    ds_read_b64_tr_b16 v[134:135], v136 offset:17664
    s_waitcnt lgkmcnt(10)
    ds_write_b128 v137, v[112:115] offset:12288
    s_waitcnt lgkmcnt(9)
    ds_write_b128 v137, v[116:119] offset:13312
    s_waitcnt lgkmcnt(8)
    ds_write_b128 v137, v[120:123] offset:14336
    s_waitcnt lgkmcnt(7)
    ds_write_b128 v137, v[124:127] offset:15360
    s_waitcnt lgkmcnt(6)
    ds_write_b128 v137, v[128:131] offset:16384
    s_waitcnt lgkmcnt(5)
    ds_write_b128 v137, v[132:135] offset:17408
    ds_read_b64_tr_b16 v[112:113], v136 offset:18432
    ds_read_b64_tr_b16 v[114:115], v136 offset:18688
    ds_read_b64_tr_b16 v[116:117], v136 offset:19456
    ds_read_b64_tr_b16 v[118:119], v136 offset:19712
    ds_read_b64_tr_b16 v[120:121], v136 offset:20480
    ds_read_b64_tr_b16 v[122:123], v136 offset:20736
    ds_read_b64_tr_b16 v[124:125], v136 offset:21504
    ds_read_b64_tr_b16 v[126:127], v136 offset:21760
    ds_read_b64_tr_b16 v[128:129], v136 offset:22528
    ds_read_b64_tr_b16 v[130:131], v136 offset:22784
    ds_read_b64_tr_b16 v[132:133], v136 offset:23552
    ds_read_b64_tr_b16 v[134:135], v136 offset:23808
    s_waitcnt lgkmcnt(10)
    ds_write_b128 v137, v[112:115] offset:18432
    s_waitcnt lgkmcnt(9)
    ds_write_b128 v137, v[116:119] offset:19456
    s_waitcnt lgkmcnt(8)
    ds_write_b128 v137, v[120:123] offset:20480
    s_waitcnt lgkmcnt(7)
    ds_write_b128 v137, v[124:127] offset:21504
    s_waitcnt lgkmcnt(6)
    ds_write_b128 v137, v[128:131] offset:22528
    s_waitcnt lgkmcnt(5)
    ds_write_b128 v137, v[132:135] offset:23552
    s_waitcnt vmcnt(5)
    s_waitcnt lgkmcnt(0)
    s_barrier
    ds_read_b128 v[68:71], v18 offset:32896
    ds_read_b128 v[72:75], v13 offset:32896
    s_waitcnt lgkmcnt(1)
    v_mfma_f32_32x32x16_bf16 v[28:43], v[68:71], v[20:23], 0
    ds_read_b128 v[68:71], v18 offset:37008
    s_nop 10
    v_exp_f32 v28, v28
    v_exp_f32 v29, v29
    ds_read_b128 v[76:79], v14 offset:32896
    v_exp_f32 v30, v30
    v_exp_f32 v31, v31
    v_cvt_pk_bf16_f32 v60, v28, v29
    v_exp_f32 v32, v32
    v_exp_f32 v33, v33
    v_cvt_pk_bf16_f32 v61, v30, v31
    s_waitcnt lgkmcnt(1)
    v_mfma_f32_32x32x16_bf16 v[44:59], v[68:71], v[20:23], 0
    ds_read_b128 v[68:71], v18 offset:41120
    v_exp_f32 v34, v34
    v_exp_f32 v35, v35
    v_cvt_pk_bf16_f32 v62, v32, v33
    v_exp_f32 v36, v36
    v_cvt_pk_bf16_f32 v63, v34, v35
    v_exp_f32 v37, v37
    v_exp_f32 v38, v38
    v_mfma_f32_32x32x16_bf16 v[80:95], v[72:75], v[60:63], 0
    ds_read_b128 v[72:75], v13 offset:37008
    v_exp_f32 v39, v39
    v_cvt_pk_bf16_f32 v64, v36, v37
    v_exp_f32 v40, v40
    v_exp_f32 v41, v41
    v_cvt_pk_bf16_f32 v65, v38, v39
    v_exp_f32 v42, v42
    v_exp_f32 v43, v43
    v_cvt_pk_bf16_f32 v66, v40, v41
    v_cvt_pk_bf16_f32 v67, v42, v43
    buffer_load_dword v239, v238, s[4:7], 0 offen sc1
    buffer_load_dword v249, v248, s[4:7], s101 offen sc1
    v_exp_f32 v44, v44
    v_exp_f32 v45, v45
    s_waitcnt lgkmcnt(2)
    v_mfma_f32_32x32x16_bf16 v[80:95], v[76:79], v[64:67], v[80:95]
    ds_read_b128 v[76:79], v14 offset:37008
    v_exp_f32 v46, v46
    v_exp_f32 v47, v47
    v_cvt_pk_bf16_f32 v60, v44, v45
    v_exp_f32 v48, v48
    v_exp_f32 v49, v49
    v_cvt_pk_bf16_f32 v61, v46, v47
    s_waitcnt lgkmcnt(2)
    v_mfma_f32_32x32x16_bf16 v[28:43], v[68:71], v[20:23], 0
    ds_read_b128 v[68:71], v18 offset:45232
    v_exp_f32 v50, v50
    v_exp_f32 v51, v51
    v_cvt_pk_bf16_f32 v62, v48, v49
    v_exp_f32 v52, v52
    v_cvt_pk_bf16_f32 v63, v50, v51
    v_exp_f32 v53, v53
    v_exp_f32 v54, v54
    s_waitcnt lgkmcnt(2)
    v_mfma_f32_32x32x16_bf16 v[80:95], v[72:75], v[60:63], v[80:95]
    ds_read_b128 v[72:75], v13 offset:41120
    v_exp_f32 v55, v55
    v_cvt_pk_bf16_f32 v64, v52, v53
    v_exp_f32 v56, v56
    v_exp_f32 v57, v57
    v_cvt_pk_bf16_f32 v65, v54, v55
    v_exp_f32 v58, v58
    v_exp_f32 v59, v59
    v_cvt_pk_bf16_f32 v66, v56, v57
    v_cvt_pk_bf16_f32 v67, v58, v59
    v_exp_f32 v28, v28
    v_exp_f32 v29, v29
    s_waitcnt lgkmcnt(2)
    v_mfma_f32_32x32x16_bf16 v[80:95], v[76:79], v[64:67], v[80:95]
    ds_read_b128 v[76:79], v14 offset:41120
    v_exp_f32 v30, v30
    v_exp_f32 v31, v31
    v_cvt_pk_bf16_f32 v60, v28, v29
    v_exp_f32 v32, v32
    v_exp_f32 v33, v33
    v_cvt_pk_bf16_f32 v61, v30, v31
    s_waitcnt lgkmcnt(2)
    v_mfma_f32_32x32x16_bf16 v[44:59], v[68:71], v[20:23], 0
    ds_read_b128 v[68:71], v12 offset:16448
    v_exp_f32 v34, v34
    v_exp_f32 v35, v35
    v_cvt_pk_bf16_f32 v62, v32, v33
    v_exp_f32 v36, v36
    v_cvt_pk_bf16_f32 v63, v34, v35
    v_exp_f32 v37, v37
    v_exp_f32 v38, v38
    s_waitcnt lgkmcnt(2)
    v_mfma_f32_32x32x16_bf16 v[80:95], v[72:75], v[60:63], v[80:95]
    ds_read_b128 v[72:75], v13 offset:45232
    v_exp_f32 v39, v39
    v_cvt_pk_bf16_f32 v64, v36, v37
    v_exp_f32 v40, v40
    v_exp_f32 v41, v41
    v_cvt_pk_bf16_f32 v65, v38, v39
    v_exp_f32 v42, v42
    v_exp_f32 v43, v43
    v_cvt_pk_bf16_f32 v66, v40, v41
    v_cvt_pk_bf16_f32 v67, v42, v43
    v_exp_f32 v44, v44
    v_exp_f32 v45, v45
    s_waitcnt lgkmcnt(2)
    v_mfma_f32_32x32x16_bf16 v[80:95], v[76:79], v[64:67], v[80:95]
    ds_read_b128 v[76:79], v14 offset:45232
    v_exp_f32 v46, v46
    v_exp_f32 v47, v47
    v_cvt_pk_bf16_f32 v60, v44, v45
    v_exp_f32 v48, v48
    v_exp_f32 v49, v49
    v_cvt_pk_bf16_f32 v61, v46, v47
    s_waitcnt lgkmcnt(2)
    v_mfma_f32_32x32x16_bf16 v[28:43], v[68:71], v[20:23], 0
    s_waitcnt vmcnt(3)
    s_barrier
    ds_read_b128 v[68:71], v12 offset:0
    v_exp_f32 v50, v50
    v_exp_f32 v51, v51
    v_cvt_pk_bf16_f32 v62, v48, v49
    v_exp_f32 v52, v52
    v_cvt_pk_bf16_f32 v63, v50, v51
    v_exp_f32 v53, v53
    v_exp_f32 v54, v54
    s_waitcnt lgkmcnt(2)
    v_mfma_f32_32x32x16_bf16 v[80:95], v[72:75], v[60:63], v[80:95]
    v_add_u32 v13, s54, v13
    ds_read_b128 v[72:75], v13 offset:16448
    v_exp_f32 v55, v55
    v_cvt_pk_bf16_f32 v64, v52, v53
    v_exp_f32 v56, v56
    s_waitcnt lgkmcnt(1)
    v_mfma_f32_32x32x16_bf16 v[96:111], v[68:71], v[20:23], 0
    ds_read_b128 v[68:71], v12 offset:12336
    v_exp_f32 v57, v57
    v_cvt_pk_bf16_f32 v65, v54, v55
    v_exp_f32 v58, v58
    v_exp_f32 v59, v59
    v_cvt_pk_bf16_f32 v66, v56, v57
    v_cvt_pk_bf16_f32 v67, v58, v59
    s_waitcnt vmcnt(1)
    v_cmp_gt_u32 vcc, 1, v239
    s_cbranch_vccnz Lspin_9
Lback_10:
    s_waitcnt vmcnt(0)
    v_cmp_gt_u32 vcc, 256, v249
    s_cbranch_vccnz Lspin_11
Lback_12:
    v_and_b32 v249, 255, v249
    v_cmp_ne_u32 vcc, s51, v249
    s_nop 0
    s_cmp_eq_u64 vcc, 0
    s_cselect_b32 s39, 1, 0
    v_cndmask_b32 v28, v96, v28, s[60:61]
    v_cndmask_b32 v29, v97, v29, s[62:63]
    v_mfma_f32_32x32x16_bf16 v[80:95], v[76:79], v[64:67], v[80:95]
    v_add_u32 v14, s54, v14
    ds_read_b128 v[76:79], v14 offset:16448
    v_cndmask_b32 v30, v98, v30, s[64:65]
    v_cndmask_b32 v31, v99, v31, s[66:67]
    v_cndmask_b32 v32, v100, v32, s[68:69]
    v_cndmask_b32 v33, v101, v33, s[70:71]
    v_cndmask_b32 v34, v102, v34, s[72:73]
    v_cndmask_b32 v35, v103, v35, s[74:75]
    v_cndmask_b32 v36, v104, v36, s[76:77]
    v_cndmask_b32 v37, v105, v37, s[78:79]
    v_cndmask_b32 v38, v106, v38, s[80:81]
    v_cndmask_b32 v39, v107, v39, s[82:83]
    v_cndmask_b32 v40, v108, v40, s[84:85]
    v_cndmask_b32 v41, v109, v41, s[86:87]
    v_cndmask_b32 v42, v110, v42, s[88:89]
    v_cndmask_b32 v43, v111, v43, s[90:91]
    ds_read_b128 v[96:99], v15
    ds_read_b128 v[100:103], v15 offset:1024
    ds_read_b128 v[104:107], v13 offset:0
    ds_read_b128 v[108:111], v14 offset:0
    s_waitcnt lgkmcnt(5)
    v_mfma_f32_32x32x16_bf16 v[44:59], v[68:71], v[20:23], 0
    ds_read_b128 v[68:71], v12 offset:8224
    s_lshl2_add_u32 s45, s37, s38
    s_min_u32 s45, s45, 55
    s_lshl_b32 s45, s45, 11
    s_add_u32 s45, s45, 655360
    buffer_load_dword v224, v241, s[4:7], s45 offen offset:0 sc1
    buffer_load_dword v225, v241, s[4:7], s45 offen offset:256 sc1
    buffer_load_dword v226, v241, s[4:7], s45 offen offset:512 sc1
    buffer_load_dword v227, v241, s[4:7], s45 offen offset:768 sc1
    buffer_load_dword v228, v241, s[4:7], s45 offen offset:1024 sc1
    buffer_load_dword v229, v241, s[4:7], s45 offen offset:1280 sc1
    buffer_load_dword v230, v241, s[4:7], s45 offen offset:1536 sc1
    buffer_load_dword v231, v241, s[4:7], s45 offen offset:1792 sc1
    s_add_u32 s49, s100, 4096
    v_exp_f32 v28, v28
    v_exp_f32 v29, v29
    v_exp_f32 v30, v30
    v_exp_f32 v31, v31
    v_cvt_pk_bf16_f32 v60, v28, v29
    v_exp_f32 v32, v32
    v_exp_f32 v33, v33
    v_cvt_pk_bf16_f32 v61, v30, v31
    v_exp_f32 v34, v34
    buffer_load_dwordx4 v[112:115], v1, s[4:7], s49 offen offset:0 sc1
    v_exp_f32 v35, v35
    v_cvt_pk_bf16_f32 v62, v32, v33
    v_exp_f32 v36, v36
    v_cvt_pk_bf16_f32 v63, v34, v35
    v_exp_f32 v37, v37
    s_waitcnt lgkmcnt(4)
    v_and_b32 v96, v96, v60
    v_and_b32 v97, v97, v61
    v_and_b32 v98, v98, v62
    v_and_b32 v99, v99, v63
    v_exp_f32 v38, v38
    v_exp_f32 v39, v39
    v_mfma_f32_32x32x16_bf16 v[80:95], v[72:75], v[96:99], v[80:95]
    ds_read_b128 v[72:75], v13 offset:12336
    v_xor_b32 v60, v96, v60
    v_xor_b32 v61, v97, v61
    v_xor_b32 v62, v98, v62
    v_xor_b32 v63, v99, v63
    v_cvt_pk_bf16_f32 v64, v36, v37
    v_exp_f32 v40, v40
    v_exp_f32 v41, v41
    s_waitcnt lgkmcnt(3)
    v_mfma_f32_32x32x16_bf16 v[80:95], v[104:107], v[60:63], v[80:95]
    v_cvt_pk_bf16_f32 v65, v38, v39
    v_exp_f32 v42, v42
    v_exp_f32 v43, v43
    v_cvt_pk_bf16_f32 v66, v40, v41
    buffer_load_dwordx4 v[116:119], v1, s[4:7], s49 offen offset:1024 sc1
    v_cvt_pk_bf16_f32 v67, v42, v43
    v_and_b32 v100, v100, v64
    v_and_b32 v101, v101, v65
    v_and_b32 v102, v102, v66
    v_and_b32 v103, v103, v67
    v_xor_b32 v64, v100, v64
    v_xor_b32 v65, v101, v65
    v_mfma_f32_32x32x16_bf16 v[80:95], v[76:79], v[100:103], v[80:95]
    v_xor_b32 v66, v102, v66
    v_xor_b32 v67, v103, v67
    v_exp_f32 v44, v44
    v_exp_f32 v45, v45
    s_waitcnt lgkmcnt(2)
    v_mfma_f32_32x32x16_bf16 v[80:95], v[108:111], v[64:67], v[80:95]
    ds_read_b128 v[76:79], v14 offset:12336
    v_exp_f32 v46, v46
    v_exp_f32 v47, v47
    v_cvt_pk_bf16_f32 v60, v44, v45
    v_exp_f32 v48, v48
    v_exp_f32 v49, v49
    buffer_load_dwordx4 v[120:123], v1, s[4:7], s49 offen offset:2048 sc1
    v_cvt_pk_bf16_f32 v61, v46, v47
    s_waitcnt lgkmcnt(2)
    v_mfma_f32_32x32x16_bf16 v[28:43], v[68:71], v[20:23], 0
    ds_read_b128 v[68:71], v12 offset:4112
    v_exp_f32 v50, v50
    v_exp_f32 v51, v51
    v_cvt_pk_bf16_f32 v62, v48, v49
    v_exp_f32 v52, v52
    v_cvt_pk_bf16_f32 v63, v50, v51
    v_exp_f32 v53, v53
    v_exp_f32 v54, v54
    s_waitcnt lgkmcnt(2)
    v_mfma_f32_32x32x16_bf16 v[80:95], v[72:75], v[60:63], v[80:95]
    ds_read_b128 v[72:75], v13 offset:8224
    v_exp_f32 v55, v55
    v_cvt_pk_bf16_f32 v64, v52, v53
    v_exp_f32 v56, v56
    v_exp_f32 v57, v57
    buffer_load_dwordx4 v[124:127], v1, s[4:7], s49 offen offset:3072 sc1
    s_add_u32 s49, s100, 8192
    v_cvt_pk_bf16_f32 v65, v54, v55
    v_exp_f32 v58, v58
    v_exp_f32 v59, v59
    v_cvt_pk_bf16_f32 v66, v56, v57
    buffer_load_dwordx4 v[128:131], v1, s[4:7], s49 offen offset:0 sc1
    v_cvt_pk_bf16_f32 v67, v58, v59
    v_exp_f32 v28, v28
    v_exp_f32 v29, v29
    s_waitcnt lgkmcnt(2)
    v_mfma_f32_32x32x16_bf16 v[80:95], v[76:79], v[64:67], v[80:95]
    ds_read_b128 v[76:79], v14 offset:8224
    v_exp_f32 v30, v30
    v_exp_f32 v31, v31
    v_cvt_pk_bf16_f32 v60, v28, v29
    v_exp_f32 v32, v32
    v_exp_f32 v33, v33
    buffer_load_dwordx4 v[132:135], v1, s[4:7], s49 offen offset:1024 sc1
    v_cvt_pk_bf16_f32 v61, v30, v31
    s_waitcnt lgkmcnt(2)
    v_mfma_f32_32x32x16_bf16 v[44:59], v[68:71], v[20:23], 0
    ds_read_b128 v[68:71], v12 offset:17472
    v_exp_f32 v34, v34
    v_exp_f32 v35, v35
    v_cvt_pk_bf16_f32 v62, v32, v33
    v_exp_f32 v36, v36
    v_cvt_pk_bf16_f32 v63, v34, v35
    v_exp_f32 v37, v37
    v_exp_f32 v38, v38
    s_waitcnt lgkmcnt(2)
    v_mfma_f32_32x32x16_bf16 v[80:95], v[72:75], v[60:63], v[80:95]
    ds_read_b128 v[72:75], v13 offset:4112
    v_exp_f32 v39, v39
    v_cvt_pk_bf16_f32 v64, v36, v37
    v_exp_f32 v40, v40
    v_exp_f32 v41, v41
    buffer_load_dwordx4 v[136:139], v1, s[4:7], s49 offen offset:2048 sc1
    v_cvt_pk_bf16_f32 v65, v38, v39
    v_exp_f32 v42, v42
    v_exp_f32 v43, v43
    v_cvt_pk_bf16_f32 v66, v40, v41
    buffer_load_dwordx4 v[140:143], v1, s[4:7], s49 offen offset:3072 sc1
    s_add_u32 s49, s100, 12288
    v_cvt_pk_bf16_f32 v67, v42, v43
    v_exp_f32 v44, v44
    v_exp_f32 v45, v45
    s_waitcnt lgkmcnt(2)
    v_mfma_f32_32x32x16_bf16 v[80:95], v[76:79], v[64:67], v[80:95]
    ds_read_b128 v[76:79], v14 offset:4112
    v_exp_f32 v46, v46
    v_exp_f32 v47, v47
    v_cvt_pk_bf16_f32 v60, v44, v45
    v_exp_f32 v48, v48
    v_exp_f32 v49, v49
    buffer_load_dwordx4 v[144:147], v1, s[4:7], s49 offen offset:0 sc1
    v_cvt_pk_bf16_f32 v61, v46, v47
    s_waitcnt lgkmcnt(2)
    v_mfma_f32_32x32x16_bf16 v[28:43], v[68:71], v[24:27], 0
    ds_read_b128 v[68:71], v12 offset:1024
    v_exp_f32 v50, v50
    v_exp_f32 v51, v51
    v_cvt_pk_bf16_f32 v62, v48, v49
    v_exp_f32 v52, v52
    v_cvt_pk_bf16_f32 v63, v50, v51
    v_exp_f32 v53, v53
    v_exp_f32 v54, v54
    s_waitcnt lgkmcnt(2)
    v_mfma_f32_32x32x16_bf16 v[80:95], v[72:75], v[60:63], v[80:95]
    v_bfe_u32 v16, v0, 4, 1
    v_cmp_eq_u32 vcc, 1, v16
    v_sub_u32 v16, v12, v1
    v_add_u32 v17, 2048, v12
    v_add_u32 v16, 4096, v16
    v_cndmask_b32 v13, v16, v17, vcc
    ds_read_b128 v[72:75], v13 offset:16448
    v_exp_f32 v55, v55
    v_cvt_pk_bf16_f32 v64, v52, v53
    v_exp_f32 v56, v56
    s_waitcnt lgkmcnt(1)
    v_mfma_f32_32x32x16_bf16 v[96:111], v[68:71], v[24:27], 0
    ds_read_b128 v[68:71], v12 offset:13360
    v_exp_f32 v57, v57
    buffer_load_dwordx4 v[148:151], v1, s[4:7], s49 offen offset:1024 sc1
    v_cvt_pk_bf16_f32 v65, v54, v55
    v_exp_f32 v58, v58
    v_exp_f32 v59, v59
    v_cvt_pk_bf16_f32 v66, v56, v57
    buffer_load_dwordx4 v[152:155], v1, s[4:7], s49 offen offset:2048 sc1
    v_cvt_pk_bf16_f32 v67, v58, v59
    s_nop 2
    v_cndmask_b32 v28, v96, v28, s[60:61]
    v_cndmask_b32 v29, v97, v29, s[62:63]
    v_mfma_f32_32x32x16_bf16 v[80:95], v[76:79], v[64:67], v[80:95]
    v_bfe_u32 v16, v0, 4, 1
    v_cmp_eq_u32 vcc, 1, v16
    v_sub_u32 v16, v12, v1
    v_add_u32 v17, 3072, v12
    v_add_u32 v16, 4096, v16
    v_cndmask_b32 v14, v16, v17, vcc
    ds_read_b128 v[76:79], v14 offset:16448
    v_cndmask_b32 v30, v98, v30, s[64:65]
    v_cndmask_b32 v31, v99, v31, s[66:67]
    v_cndmask_b32 v32, v100, v32, s[68:69]
    v_cndmask_b32 v33, v101, v33, s[70:71]
    v_cndmask_b32 v34, v102, v34, s[72:73]
    v_cndmask_b32 v35, v103, v35, s[74:75]
    v_cndmask_b32 v36, v104, v36, s[76:77]
    v_cndmask_b32 v37, v105, v37, s[78:79]
    v_cndmask_b32 v38, v106, v38, s[80:81]
    v_cndmask_b32 v39, v107, v39, s[82:83]
    v_cndmask_b32 v40, v108, v40, s[84:85]
    v_cndmask_b32 v41, v109, v41, s[86:87]
    v_cndmask_b32 v42, v110, v42, s[88:89]
    v_cndmask_b32 v43, v111, v43, s[90:91]
    ds_read_b128 v[96:99], v15
    ds_read_b128 v[100:103], v15 offset:1024
    ds_read_b128 v[104:107], v13 offset:0
    ds_read_b128 v[108:111], v14 offset:0
    s_waitcnt lgkmcnt(5)
    v_mfma_f32_32x32x16_bf16 v[44:59], v[68:71], v[24:27], 0
    ds_read_b128 v[68:71], v12 offset:9248
    v_rcp_f32 v16, v88
    v_subrev_u32 v92, 729808896, v88
    v_mul_f32 v80, v80, v16
    v_mul_f32 v81, v81, v16
    v_mul_f32 v82, v82, v16
    v_mul_f32 v83, v83, v16
    v_mul_f32 v84, v84, v16
    v_mul_f32 v85, v85, v16
    v_mul_f32 v86, v86, v16
    v_mul_f32 v87, v87, v16
    v_cmp_lt_u32 vcc, 671088640, v92
    v_cvt_pk_bf16_f32 v88, v80, v81
    v_cvt_pk_bf16_f32 v89, v82, v83
    v_cvt_pk_bf16_f32 v90, v84, v85
    v_cvt_pk_bf16_f32 v91, v86, v87
    s_or_b64 s[96:97], s[96:97], vcc
    s_cmp_eq_u32 s39, 0
    s_cbranch_scc1 Lslow_51
    buffer_store_dwordx4 v[88:91], v1, s[4:7], s55 offen offset:0
Ldual_51:
    buffer_load_dwordx4 v[156:159], v1, s[4:7], s49 offen offset:3072 sc1
    v_exp_f32 v28, v28
    v_exp_f32 v29, v29
    v_exp_f32 v30, v30
    v_exp_f32 v31, v31
    v_cvt_pk_bf16_f32 v60, v28, v29
    v_exp_f32 v32, v32
    v_exp_f32 v33, v33
    v_cvt_pk_bf16_f32 v61, v30, v31
    v_exp_f32 v34, v34
    buffer_load_dwordx4 a[224:227], v1, s[4:7], s98 offen offset:0 sc1
    v_exp_f32 v35, v35
    v_cvt_pk_bf16_f32 v62, v32, v33
    v_exp_f32 v36, v36
    v_cvt_pk_bf16_f32 v63, v34, v35
    v_exp_f32 v37, v37
    s_waitcnt lgkmcnt(4)
    v_and_b32 v96, v96, v60
    v_and_b32 v97, v97, v61
    v_and_b32 v98, v98, v62
    v_and_b32 v99, v99, v63
    v_exp_f32 v38, v38
    v_exp_f32 v39, v39
    v_mfma_f32_32x32x16_bf16 v[80:95], v[72:75], v[96:99], 0
    ds_read_b128 v[72:75], v13 offset:12336
    v_xor_b32 v60, v96, v60
    v_xor_b32 v61, v97, v61
    v_xor_b32 v62, v98, v62
    v_xor_b32 v63, v99, v63
    v_cvt_pk_bf16_f32 v64, v36, v37
    v_exp_f32 v40, v40
    v_exp_f32 v41, v41
    s_waitcnt lgkmcnt(3)
    v_mfma_f32_32x32x16_bf16 v[80:95], v[104:107], v[60:63], v[80:95]
    v_cvt_pk_bf16_f32 v65, v38, v39
    v_exp_f32 v42, v42
    v_exp_f32 v43, v43
    v_cvt_pk_bf16_f32 v66, v40, v41
    buffer_load_dwordx4 a[228:231], v1, s[4:7], s98 offen offset:1024 sc1
    v_cvt_pk_bf16_f32 v67, v42, v43
    v_and_b32 v100, v100, v64
    v_and_b32 v101, v101, v65
    v_and_b32 v102, v102, v66
    v_and_b32 v103, v103, v67
    v_xor_b32 v64, v100, v64
    v_xor_b32 v65, v101, v65
    v_mfma_f32_32x32x16_bf16 v[80:95], v[76:79], v[100:103], v[80:95]
    v_xor_b32 v66, v102, v66
    v_xor_b32 v67, v103, v67
    v_exp_f32 v44, v44
    v_exp_f32 v45, v45
    s_waitcnt lgkmcnt(2)
    v_mfma_f32_32x32x16_bf16 v[80:95], v[108:111], v[64:67], v[80:95]
    ds_read_b128 v[76:79], v14 offset:12336
    v_exp_f32 v46, v46
    v_exp_f32 v47, v47
    v_cvt_pk_bf16_f32 v60, v44, v45
    v_exp_f32 v48, v48
    v_exp_f32 v49, v49
    buffer_load_dwordx4 a[232:235], v1, s[4:7], s98 offen offset:2048 sc1
    v_cvt_pk_bf16_f32 v61, v46, v47
    s_waitcnt lgkmcnt(2)
    v_mfma_f32_32x32x16_bf16 v[28:43], v[68:71], v[24:27], 0
    ds_read_b128 v[68:71], v12 offset:5136
    v_exp_f32 v50, v50
    v_exp_f32 v51, v51
    v_cvt_pk_bf16_f32 v62, v48, v49
    v_exp_f32 v52, v52
    v_cvt_pk_bf16_f32 v63, v50, v51
    v_exp_f32 v53, v53
    v_exp_f32 v54, v54
    s_waitcnt lgkmcnt(2)
    v_mfma_f32_32x32x16_bf16 v[80:95], v[72:75], v[60:63], v[80:95]
    ds_read_b128 v[72:75], v13 offset:8224
    v_exp_f32 v55, v55
    v_cvt_pk_bf16_f32 v64, v52, v53
    v_exp_f32 v56, v56
    v_exp_f32 v57, v57
    buffer_load_dwordx4 a[236:239], v1, s[4:7], s98 offen offset:3072 sc1
    s_add_u32 s98, s98, 4096
    v_cvt_pk_bf16_f32 v65, v54, v55
    v_exp_f32 v58, v58
    v_exp_f32 v59, v59
    v_cvt_pk_bf16_f32 v66, v56, v57
    buffer_load_dwordx4 a[240:243], v1, s[4:7], s98 offen offset:0 sc1
    v_cvt_pk_bf16_f32 v67, v58, v59
    v_exp_f32 v28, v28
    v_exp_f32 v29, v29
    s_waitcnt lgkmcnt(2)
    v_mfma_f32_32x32x16_bf16 v[80:95], v[76:79], v[64:67], v[80:95]
    ds_read_b128 v[76:79], v14 offset:8224
    v_exp_f32 v30, v30
    v_exp_f32 v31, v31
    v_cvt_pk_bf16_f32 v60, v28, v29
    v_exp_f32 v32, v32
    v_exp_f32 v33, v33
    buffer_load_dwordx4 v[96:99], v1, s[4:7], s100 offen offset:0 sc1
    v_cvt_pk_bf16_f32 v61, v30, v31
    s_waitcnt lgkmcnt(2)
    v_mfma_f32_32x32x16_bf16 v[44:59], v[68:71], v[24:27], 0
    ds_read_b128 v[68:71], v18 offset:33920
    v_exp_f32 v34, v34
    v_exp_f32 v35, v35
    v_cvt_pk_bf16_f32 v62, v32, v33
    v_exp_f32 v36, v36
    v_cvt_pk_bf16_f32 v63, v34, v35
    v_exp_f32 v37, v37
    v_exp_f32 v38, v38
    s_waitcnt lgkmcnt(2)
    v_mfma_f32_32x32x16_bf16 v[80:95], v[72:75], v[60:63], v[80:95]
    ds_read_b128 v[72:75], v13 offset:4112
    v_exp_f32 v39, v39
    v_cvt_pk_bf16_f32 v64, v36, v37
    v_exp_f32 v40, v40
    v_exp_f32 v41, v41
    buffer_load_dwordx4 v[100:103], v1, s[4:7], s100 offen offset:1024 sc1
    v_cvt_pk_bf16_f32 v65, v38, v39
    v_exp_f32 v42, v42
    v_exp_f32 v43, v43
    v_cvt_pk_bf16_f32 v66, v40, v41
    buffer_load_dwordx4 v[104:107], v1, s[4:7], s100 offen offset:2048 sc1
    v_cvt_pk_bf16_f32 v67, v42, v43
    v_exp_f32 v44, v44
    v_exp_f32 v45, v45
    s_waitcnt lgkmcnt(2)
    v_mfma_f32_32x32x16_bf16 v[80:95], v[76:79], v[64:67], v[80:95]
    ds_read_b128 v[76:79], v14 offset:4112
    v_exp_f32 v46, v46
    v_exp_f32 v47, v47
    v_cvt_pk_bf16_f32 v60, v44, v45
    v_exp_f32 v48, v48
    v_exp_f32 v49, v49
    buffer_load_dwordx4 v[108:111], v1, s[4:7], s100 offen offset:3072 sc1
    v_cvt_pk_bf16_f32 v61, v46, v47
    s_waitcnt lgkmcnt(2)
    v_mfma_f32_32x32x16_bf16 v[28:43], v[68:71], v[24:27], 0
    ds_read_b128 v[68:71], v18 offset:38032
    v_exp_f32 v50, v50
    v_exp_f32 v51, v51
    v_cvt_pk_bf16_f32 v62, v48, v49
    v_exp_f32 v52, v52
    v_cvt_pk_bf16_f32 v63, v50, v51
    v_exp_f32 v53, v53
    v_exp_f32 v54, v54
    s_waitcnt lgkmcnt(2)
    v_mfma_f32_32x32x16_bf16 v[80:95], v[72:75], v[60:63], v[80:95]
    v_subrev_u32 v13, s54, v13
    ds_read_b128 v[72:75], v13 offset:32896
    v_exp_f32 v55, v55
    v_cvt_pk_bf16_f32 v64, v52, v53
    v_exp_f32 v56, v56
    v_exp_f32 v57, v57
    buffer_load_dwordx4 a[244:247], v1, s[4:7], s98 offen offset:1024 sc1
    v_cvt_pk_bf16_f32 v65, v54, v55
    v_exp_f32 v58, v58
    v_exp_f32 v59, v59
    v_cvt_pk_bf16_f32 v66, v56, v57
    buffer_load_dwordx4 a[248:251], v1, s[4:7], s98 offen offset:2048 sc1
    v_cvt_pk_bf16_f32 v67, v58, v59
    v_exp_f32 v28, v28
    v_exp_f32 v29, v29
    s_waitcnt lgkmcnt(2)
    v_mfma_f32_32x32x16_bf16 v[80:95], v[76:79], v[64:67], v[80:95]
    v_subrev_u32 v14, s54, v14
    ds_read_b128 v[76:79], v14 offset:32896
    v_exp_f32 v30, v30
    v_exp_f32 v31, v31
    v_cvt_pk_bf16_f32 v60, v28, v29
    v_exp_f32 v32, v32
    v_exp_f32 v33, v33
    buffer_load_dwordx4 a[252:255], v1, s[4:7], s98 offen offset:3072 sc1
    s_add_u32 s98, s98, 4096
    v_cvt_pk_bf16_f32 v61, v30, v31
    s_waitcnt lgkmcnt(2)
    v_mfma_f32_32x32x16_bf16 v[44:59], v[68:71], v[24:27], 0
    ds_read_b128 v[68:71], v18 offset:42144
    v_exp_f32 v34, v34
    v_exp_f32 v35, v35
    v_cvt_pk_bf16_f32 v62, v32, v33
    v_exp_f32 v36, v36
    v_cvt_pk_bf16_f32 v63, v34, v35
    v_exp_f32 v37, v37
    v_exp_f32 v38, v38
    s_waitcnt lgkmcnt(2)
    v_mfma_f32_32x32x16_bf16 v[80:95], v[72:75], v[60:63], v[80:95]
    ds_read_b128 v[72:75], v13 offset:37008
    v_exp_f32 v39, v39
    v_cvt_pk_bf16_f32 v64, v36, v37
    v_exp_f32 v40, v40
    v_exp_f32 v41, v41
    buffer_load_dwordx4 v[160:163], v1, s[4:7], s98 offen offset:0 sc1
    v_cvt_pk_bf16_f32 v65, v38, v39
    v_exp_f32 v42, v42
    v_exp_f32 v43, v43
    v_cvt_pk_bf16_f32 v66, v40, v41
    buffer_load_dwordx4 v[164:167], v1, s[4:7], s98 offen offset:1024 sc1
    v_cvt_pk_bf16_f32 v67, v42, v43
    v_exp_f32 v44, v44
    v_exp_f32 v45, v45
    s_waitcnt lgkmcnt(2)
    v_mfma_f32_32x32x16_bf16 v[80:95], v[76:79], v[64:67], v[80:95]
    ds_read_b128 v[76:79], v14 offset:37008
    v_exp_f32 v46, v46
    v_exp_f32 v47, v47
    v_cvt_pk_bf16_f32 v60, v44, v45
    v_exp_f32 v48, v48
    v_exp_f32 v49, v49
    buffer_load_dwordx4 v[168:171], v1, s[4:7], s98 offen offset:2048 sc1
    v_cvt_pk_bf16_f32 v61, v46, v47
    s_waitcnt lgkmcnt(2)
    v_mfma_f32_32x32x16_bf16 v[28:43], v[68:71], v[24:27], 0
    ds_read_b128 v[68:71], v18 offset:46256
    v_exp_f32 v50, v50
    v_exp_f32 v51, v51
    v_cvt_pk_bf16_f32 v62, v48, v49
    v_exp_f32 v52, v52
    v_cvt_pk_bf16_f32 v63, v50, v51
    v_exp_f32 v53, v53
    v_exp_f32 v54, v54
    s_waitcnt lgkmcnt(2)
    v_mfma_f32_32x32x16_bf16 v[80:95], v[72:75], v[60:63], v[80:95]
    ds_read_b128 v[72:75], v13 offset:41120
    v_exp_f32 v55, v55
    v_cvt_pk_bf16_f32 v64, v52, v53
    v_exp_f32 v56, v56
    v_exp_f32 v57, v57
    buffer_load_dwordx4 v[172:175], v1, s[4:7], s98 offen offset:3072 sc1
    s_add_u32 s98, s98, 4096
    v_cvt_pk_bf16_f32 v65, v54, v55
    v_exp_f32 v58, v58
    v_exp_f32 v59, v59
    v_cvt_pk_bf16_f32 v66, v56, v57
    buffer_load_dwordx4 v[176:179], v1, s[4:7], s98 offen offset:0 sc1
    v_cvt_pk_bf16_f32 v67, v58, v59
    v_exp_f32 v28, v28
    v_exp_f32 v29, v29
    s_waitcnt lgkmcnt(2)
    v_mfma_f32_32x32x16_bf16 v[80:95], v[76:79], v[64:67], v[80:95]
    ds_read_b128 v[76:79], v14 offset:41120
    v_exp_f32 v30, v30
    v_exp_f32 v31, v31
    v_cvt_pk_bf16_f32 v60, v28, v29
    v_exp_f32 v32, v32
    v_exp_f32 v33, v33
    buffer_load_dwordx4 v[180:183], v1, s[4:7], s98 offen offset:1024 sc1
    v_cvt_pk_bf16_f32 v61, v30, v31
    s_waitcnt lgkmcnt(2)
    v_mfma_f32_32x32x16_bf16 v[44:59], v[68:71], v[24:27], 0
    v_exp_f32 v34, v34
    v_exp_f32 v35, v35
    v_cvt_pk_bf16_f32 v62, v32, v33
    v_exp_f32 v36, v36
    v_cvt_pk_bf16_f32 v63, v34, v35
    v_exp_f32 v37, v37
    v_exp_f32 v38, v38
    s_waitcnt lgkmcnt(1)
    v_mfma_f32_32x32x16_bf16 v[80:95], v[72:75], v[60:63], v[80:95]
    ds_read_b128 v[72:75], v13 offset:45232
    v_exp_f32 v39, v39
    v_cvt_pk_bf16_f32 v64, v36, v37
    v_exp_f32 v40, v40
    v_exp_f32 v41, v41
    buffer_load_dwordx4 v[184:187], v1, s[4:7], s98 offen offset:2048 sc1
    v_cvt_pk_bf16_f32 v65, v38, v39
    v_exp_f32 v42, v42
    v_exp_f32 v43, v43
    v_cvt_pk_bf16_f32 v66, v40, v41
    buffer_load_dwordx4 v[188:191], v1, s[4:7], s98 offen offset:3072 sc1
    v_cvt_pk_bf16_f32 v67, v42, v43
    v_exp_f32 v44, v44
    v_exp_f32 v45, v45
    s_waitcnt lgkmcnt(1)
    v_mfma_f32_32x32x16_bf16 v[80:95], v[76:79], v[64:67], v[80:95]
    ds_read_b128 v[76:79], v14 offset:45232
    v_exp_f32 v46, v46
    v_exp_f32 v47, v47
    v_cvt_pk_bf16_f32 v60, v44, v45
    v_exp_f32 v48, v48
    v_exp_f32 v49, v49
    s_cmp_ge_u32 s37, 14
    s_cselect_b32 s48, 44, 4
    s_lshl_b32 s48, s48, 10
    s_add_u32 s98, s98, s48
    v_cvt_pk_bf16_f32 v61, v46, v47
    v_exp_f32 v50, v50
    v_exp_f32 v51, v51
    v_cvt_pk_bf16_f32 v62, v48, v49
    v_exp_f32 v52, v52
    v_cvt_pk_bf16_f32 v63, v50, v51
    v_exp_f32 v53, v53
    v_exp_f32 v54, v54
    s_waitcnt lgkmcnt(1)
    v_mfma_f32_32x32x16_bf16 v[80:95], v[72:75], v[60:63], v[80:95]
    v_exp_f32 v55, v55
    v_cvt_pk_bf16_f32 v64, v52, v53
    v_exp_f32 v56, v56
    v_exp_f32 v57, v57
    buffer_load_dwordx4 v[192:195], v1, s[4:7], s98 offen offset:0 sc1
    v_cvt_pk_bf16_f32 v65, v54, v55
    v_exp_f32 v58, v58
    v_exp_f32 v59, v59
    v_cvt_pk_bf16_f32 v66, v56, v57
    buffer_load_dwordx4 v[196:199], v1, s[4:7], s98 offen offset:1024 sc1
    v_cvt_pk_bf16_f32 v67, v58, v59
    s_waitcnt lgkmcnt(0)
    s_nop 0
    v_mfma_f32_32x32x16_bf16 v[80:95], v[76:79], v[64:67], v[80:95]
    buffer_load_dwordx4 v[200:203], v1, s[4:7], s98 offen offset:2048 sc1
    buffer_load_dwordx4 v[204:207], v1, s[4:7], s98 offen offset:3072 sc1
    s_add_u32 s98, s98, 4096
    s_lshl_b32 s44, s38, 8
    s_add_u32 s44, s44, 148736
    s_waitcnt vmcnt(40)
    v_add_f32 v224, v224, v228
    s_waitcnt vmcnt(39)
    v_add_f32 v225, v225, v229
    s_waitcnt vmcnt(38)
    v_add_f32 v226, v226, v230
    s_waitcnt vmcnt(37)
    v_add_f32 v227, v227, v231
    v_add_f32 v224, v224, v226
    v_add_f32 v225, v225, v227
    v_add_f32 v224, v224, v225
    v_mov_b32 v225, v224
    v_cmp_gt_u32 vcc, 32, v0
    v_lshl_add_u32 v227, v0, 2, s44
    v_permlane32_swap_b32 v225, v224
    v_add_f32 v224, v224, v225
    v_cvt_pk_bf16_f32 v225, v224, v224
    v_and_b32 v226, 0xffff0000, v225
    v_sub_f32 v226, v224, v226
    v_cvt_pk_bf16_f32 v226, v226, v226
    v_cndmask_b32 v225, v226, v225, vcc
    ds_write_b32 v227, v225
    s_lshl_b32 s42, s38, 6
    s_lshl2_add_u32 s42, s37, s42
    s_add_u32 s42, s42, s50
    v_rcp_f32 v16, v80
    v_subrev_u32 v84, 729808896, v80
    v_mul_f32 v88, v88, v16
    v_mul_f32 v89, v89, v16
    v_mul_f32 v90, v90, v16
    v_mul_f32 v91, v91, v16
    v_mul_f32 v92, v92, v16
    v_mul_f32 v93, v93, v16
    v_mul_f32 v94, v94, v16
    v_mul_f32 v95, v95, v16
    v_cmp_lt_u32 vcc, 671088640, v84
    v_cvt_pk_bf16_f32 v28, v88, v89
    v_cvt_pk_bf16_f32 v29, v90, v91
    v_cvt_pk_bf16_f32 v30, v92, v93
    v_cvt_pk_bf16_f32 v31, v94, v95
    s_or_b64 s[96:97], s[96:97], vcc
    s_cmp_eq_u32 s39, 0
    s_cbranch_scc1 Lslow_52
    buffer_store_dwordx4 v[28:31], v1, s[4:7], s55 offen offset:1024
Ldual_52:
    s_cmp_lg_u64 s[96:97], 0
    s_cbranch_scc1 Lsafe_13
Lsafeback_14:
    v_mov_b32 v17, 1
    v_mov_b32 v19, 0
    s_barrier
    v_bfe_u32 v16, v0, 2, 1
    v_lshlrev_b32 v16, 7, v16
    v_and_b32 v18, 3, v0
    v_lshl_add_u32 v16, v18, 2, v16
    s_lshl_b32 s59, s40, 6
    s_lshl_b32 s43, s38, 4
    s_add_u32 s59, s59, s43
    s_add_u32 s59, s59, s50
    s_lshl2_add_u32 s57, s36, s40
    s_mul_i32 s57, s57, 114688
    s_lshl_b32 s43, s38, 13
    s_add_u32 s57, s57, s43
    s_add_u32 s57, s57, 8388608
    s_add_u32 s58, s57, 229376
    s_add_u32 s46, s57, 4096
    s_add_u32 s47, s58, 4096
    s_xor_b32 s49, s38, 1
    s_mul_i32 s49, s49, 6144
    s_add_u32 s49, s49, 98304
    v_add_u32 v12, s49, v1
    s_xor_b32 s49, s38, 2
    s_mul_i32 s49, s49, 6144
    s_add_u32 s49, s49, 100352
    v_add_u32 v13, s49, v1
    s_xor_b32 s49, s38, 3
    s_mul_i32 s49, s49, 6144
    s_add_u32 s49, s49, 102400
    v_add_u32 v14, s49, v1
    s_mul_i32 s49, s38, 6144
    s_add_u32 s49, s49, 98304
    v_add_u32 v15, s49, v1
    s_lshl2_add_u32 s48, s36, s40
    s_lshl2_add_u32 s49, s41, s38
    s_lshl_b32 s54, s48, 5
    s_add_u32 s54, s54, s49
    s_lshl_b32 s54, s54, 10
    s_add_u32 s54, s54, 4194304
    s_lshl_b32 s56, s40, 5
    s_add_u32 s56, s56, s49
    s_lshl2_add_u32 s56, s56, s50
    s_add_u32 s56, s56, 256
    s_waitcnt vmcnt(0)
    s_cmp_eq_u32 s39, 0
    s_cbranch_scc1 Lslow_53
    buffer_store_dword v17, v19, s[4:7], s42 offen offset:0
Ldual_53:
    s_lshl_b32 s55, s36, 17
    s_lshl_b32 s44, s38, 11
    s_add_u32 s55, s55, s44
    s_add_u32 s55, s55, 4194304
    s_add_u32 s92, s44, 98304
    s_mul_i32 s93, s36, 458752
    s_lshl2_add_u32 s45, s37, s38
    s_lshl_b32 s44, s45, 11
    s_add_u32 s93, s93, s44
    s_add_u32 s93, s93, 8388608
    s_lshl2_add_u32 s94, s45, s50
    s_cmp_ge_u32 s37, 14
    s_cselect_b32 s55, 0x70000000, s55
    s_cselect_b32 s93, 0x70000000, s93
    s_lshl_b32 s95, s52, 11
    s_add_u32 s95, s95, 262144
    s_lshl_b32 s101, s38, 5
    s_add_u32 s101, s101, s50
    s_add_u32 s101, s101, 2304
    buffer_load_dword v92, v16, s[4:7], s59 offen sc1
    s_waitcnt vmcnt(0)
    v_cmp_gt_u32 vcc, 1, v92
    s_cbranch_vccnz Lspin_15
Lback_16:
    buffer_load_dwordx4 v[52:55], v1, s[4:7], s57 offen offset:0 sc1
    buffer_load_dwordx4 v[56:59], v1, s[4:7], s57 offen offset:1024 sc1
    buffer_load_dwordx4 v[60:63], v1, s[4:7], s57 offen offset:2048 sc1
    buffer_load_dwordx4 v[64:67], v1, s[4:7], s57 offen offset:3072 sc1
    buffer_load_dwordx4 v[68:71], v1, s[4:7], s46 offen offset:0 sc1
    buffer_load_dwordx4 v[72:75], v1, s[4:7], s46 offen offset:1024 sc1
    buffer_load_dwordx4 v[76:79], v1, s[4:7], s46 offen offset:2048 sc1
    buffer_load_dwordx4 v[80:83], v1, s[4:7], s46 offen offset:3072 sc1
    buffer_load_dwordx4 v[84:87], v1, s[4:7], s58 offen offset:0 sc1
    buffer_load_dwordx4 v[88:91], v1, s[4:7], s58 offen offset:1024 sc1
    buffer_load_dwordx4 v[92:95], v1, s[4:7], s58 offen offset:2048 sc1
    v_lshlrev_b32 v16, 2, v0
    s_add_u32 s59, s50, 256
    s_waitcnt vmcnt(10)
    v_mfma_f32_32x32x16_bf16 v[20:35], v[96:99], v[52:55], 0
    v_mfma_f32_32x32x16_bf16 v[36:51], v[100:103], v[52:55], 0
    buffer_load_dwordx4 v[52:55], v1, s[4:7], s58 offen offset:3072 sc1
    s_waitcnt vmcnt(10)
    v_mfma_f32_32x32x16_bf16 v[20:35], v[104:107], v[56:59], v[20:35]
    v_mfma_f32_32x32x16_bf16 v[36:51], v[108:111], v[56:59], v[36:51]
    buffer_load_dwordx4 v[56:59], v1, s[4:7], s47 offen offset:0 sc1
    s_waitcnt vmcnt(10)
    v_mfma_f32_32x32x16_bf16 v[20:35], v[112:115], v[60:63], v[20:35]
    v_mfma_f32_32x32x16_bf16 v[36:51], v[116:119], v[60:63], v[36:51]
    buffer_load_dwordx4 v[60:63], v1, s[4:7], s47 offen offset:1024 sc1
    s_waitcnt vmcnt(10)
    v_mfma_f32_32x32x16_bf16 v[20:35], v[120:123], v[64:67], v[20:35]
    v_mfma_f32_32x32x16_bf16 v[36:51], v[124:127], v[64:67], v[36:51]
    buffer_load_dwordx4 v[64:67], v1, s[4:7], s47 offen offset:2048 sc1
    s_waitcnt vmcnt(10)
    v_mfma_f32_32x32x16_bf16 v[20:35], v[128:131], v[68:71], v[20:35]
    v_mfma_f32_32x32x16_bf16 v[36:51], v[132:135], v[68:71], v[36:51]
    buffer_load_dwordx4 v[68:71], v1, s[4:7], s47 offen offset:3072 sc1
    s_waitcnt vmcnt(10)
    v_mfma_f32_32x32x16_bf16 v[20:35], v[136:139], v[72:75], v[20:35]
    v_mfma_f32_32x32x16_bf16 v[36:51], v[140:143], v[72:75], v[36:51]
    buffer_load_dwordx4 v[208:211], v1, s[4:7], s98 offen offset:0 sc1
    s_waitcnt vmcnt(10)
    v_mfma_f32_32x32x16_bf16 v[20:35], v[144:147], v[76:79], v[20:35]
    v_mfma_f32_32x32x16_bf16 v[36:51], v[148:151], v[76:79], v[36:51]
    buffer_load_dwordx4 v[212:215], v1, s[4:7], s98 offen offset:1024 sc1
    s_waitcnt vmcnt(10)
    v_mfma_f32_32x32x16_bf16 v[20:35], v[152:155], v[80:83], v[20:35]
    v_mfma_f32_32x32x16_bf16 v[36:51], v[156:159], v[80:83], v[36:51]
    buffer_load_dwordx4 v[216:219], v1, s[4:7], s98 offen offset:2048 sc1
    v_lshlrev_b32 v72, 16, v4
    v_and_b32 v73, 0xffff0000, v4
    v_lshlrev_b32 v74, 16, v5
    v_and_b32 v75, 0xffff0000, v5
    v_lshlrev_b32 v76, 16, v6
    v_and_b32 v77, 0xffff0000, v6
    v_lshlrev_b32 v78, 16, v7
    v_and_b32 v79, 0xffff0000, v7
    s_nop 1
    ds_write_b128 v12, v[28:31] offset:0
    ds_write_b128 v12, v[32:35] offset:1024
    ds_write_b128 v13, v[36:39] offset:0
    ds_write_b128 v13, v[40:43] offset:1024
    ds_write_b128 v14, v[44:47] offset:0
    ds_write_b128 v14, v[48:51] offset:1024
    v_pk_add_f32 v[72:73], v[72:73], v[20:21]
    v_pk_add_f32 v[74:75], v[74:75], v[22:23]
    v_pk_add_f32 v[76:77], v[76:77], v[24:25]
    v_pk_add_f32 v[78:79], v[78:79], v[26:27]
    s_waitcnt vmcnt(10)
    v_mfma_f32_32x32x16_bf16 v[20:35], v[96:99], v[84:87], 0
    v_mfma_f32_32x32x16_bf16 v[36:51], v[100:103], v[84:87], 0
    buffer_load_dwordx4 v[220:223], v1, s[4:7], s98 offen offset:3072 sc1
    s_add_u32 s98, s98, 4096
    s_waitcnt vmcnt(10)
    v_mfma_f32_32x32x16_bf16 v[20:35], v[104:107], v[88:91], v[20:35]
    v_mfma_f32_32x32x16_bf16 v[36:51], v[108:111], v[88:91], v[36:51]
    buffer_load_dwordx4 v[224:227], v1, s[4:7], s98 offen offset:0 sc1
    s_waitcnt vmcnt(10)
    v_mfma_f32_32x32x16_bf16 v[20:35], v[112:115], v[92:95], v[20:35]
    v_mfma_f32_32x32x16_bf16 v[36:51], v[116:119], v[92:95], v[36:51]
    buffer_load_dwordx4 v[228:231], v1, s[4:7], s98 offen offset:1024 sc1
    s_waitcnt lgkmcnt(0)
    s_barrier
    s_waitcnt vmcnt(10)
    v_mfma_f32_32x32x16_bf16 v[20:35], v[120:123], v[52:55], v[20:35]
    ds_read_b128 v[96:99], v15 offset:0
    ds_read_b128 v[100:103], v15 offset:1024
    ds_read_b128 v[104:107], v15 offset:2048
    ds_read_b128 v[108:111], v15 offset:3072
    ds_read_b128 v[112:115], v15 offset:4096
    ds_read_b128 v[116:119], v15 offset:5120
    v_mfma_f32_32x32x16_bf16 v[36:51], v[124:127], v[52:55], v[36:51]
    s_waitcnt lgkmcnt(3)
    v_add_f32 v96, v96, v104
    v_add_f32 v97, v97, v105
    v_add_f32 v98, v98, v106
    v_add_f32 v99, v99, v107
    s_waitcnt lgkmcnt(2)
    v_add_f32 v100, v100, v108
    v_add_f32 v101, v101, v109
    buffer_load_dwordx4 v[232:235], v1, s[4:7], s98 offen offset:2048 sc1
    s_waitcnt vmcnt(10)
    v_mfma_f32_32x32x16_bf16 v[20:35], v[128:131], v[56:59], v[20:35]
    v_add_f32 v102, v102, v110
    v_add_f32 v103, v103, v111
    s_waitcnt lgkmcnt(1)
    v_add_f32 v72, v72, v112
    v_add_f32 v73, v73, v113
    v_add_f32 v74, v74, v114
    v_add_f32 v75, v75, v115
    v_mfma_f32_32x32x16_bf16 v[36:51], v[132:135], v[56:59], v[36:51]
    s_waitcnt lgkmcnt(0)
    v_add_f32 v76, v76, v116
    v_add_f32 v77, v77, v117
    v_add_f32 v78, v78, v118
    v_add_f32 v79, v79, v119
    v_add_f32 v72, v72, v96
    v_add_f32 v73, v73, v97
    buffer_load_dwordx4 v[236:239], v1, s[4:7], s98 offen offset:3072 sc1
    s_add_u32 s98, s98, 4096
    s_waitcnt vmcnt(10)
    v_mfma_f32_32x32x16_bf16 v[20:35], v[136:139], v[60:63], v[20:35]
    v_add_f32 v74, v74, v98
    v_add_f32 v75, v75, v99
    v_add_f32 v76, v76, v100
    v_add_f32 v77, v77, v101
    v_add_f32 v78, v78, v102
    v_add_f32 v79, v79, v103
    v_mfma_f32_32x32x16_bf16 v[36:51], v[140:143], v[60:63], v[36:51]
    v_cvt_pk_bf16_f32 v4, v72, v73
    v_cvt_pk_bf16_f32 v5, v74, v75
    v_cvt_pk_bf16_f32 v6, v76, v77
    v_cvt_pk_bf16_f32 v7, v78, v79
    s_cmp_eq_u32 s39, 0
    s_cbranch_scc1 Lslow_54
    buffer_store_dwordx4 v[4:7], v1, s[4:7], s54 offen
Ldual_54:
    v_mul_f32 v97, v72, v72
    buffer_load_dwordx4 v[240:243], v1, s[4:7], s98 offen offset:0 sc1
    s_waitcnt vmcnt(11)
    v_mfma_f32_32x32x16_bf16 v[20:35], v[144:147], v[64:67], v[20:35]
    v_add_f32 v96, v72, v73
    v_fmac_f32 v97, v73, v73
    v_add_f32 v96, v96, v74
    v_fmac_f32 v97, v74, v74
    v_add_f32 v96, v96, v75
    v_fmac_f32 v97, v75, v75
    v_mfma_f32_32x32x16_bf16 v[36:51], v[148:151], v[64:67], v[36:51]
    v_add_f32 v96, v96, v76
    v_fmac_f32 v97, v76, v76
    v_add_f32 v96, v96, v77
    v_fmac_f32 v97, v77, v77
    v_add_f32 v96, v96, v78
    v_fmac_f32 v97, v78, v78
    buffer_load_dwordx4 v[244:247], v1, s[4:7], s98 offen offset:1024 sc1
    s_waitcnt vmcnt(11)
    v_mfma_f32_32x32x16_bf16 v[20:35], v[152:155], v[68:71], v[20:35]
    v_add_f32 v96, v96, v79
    v_fmac_f32 v97, v79, v79
    s_lshl_b32 s49, s38, 9
    s_add_u32 s49, s49, 156928
    v_lshl_add_u32 v98, v0, 3, s49
    ds_write_b64 v98, v[96:97]
    v_mfma_f32_32x32x16_bf16 v[36:51], v[156:159], v[68:71], v[36:51]
    buffer_load_dwordx4 v[248:251], v1, s[4:7], s98 offen offset:2048 sc1
    v_lshlrev_b32 v52, 16, v8
    v_and_b32 v53, 0xffff0000, v8
    v_lshlrev_b32 v54, 16, v9
    v_and_b32 v55, 0xffff0000, v9
    v_lshlrev_b32 v56, 16, v10
    v_and_b32 v57, 0xffff0000, v10
    v_lshlrev_b32 v58, 16, v11
    v_and_b32 v59, 0xffff0000, v11
    ds_write_b128 v12, v[28:31] offset:24576
    ds_write_b128 v12, v[32:35] offset:25600
    s_nop 0
    ds_write_b128 v13, v[36:39] offset:24576
    ds_write_b128 v13, v[40:43] offset:25600
    ds_write_b128 v14, v[44:47] offset:24576
    ds_write_b128 v14, v[48:51] offset:25600
    v_pk_add_f32 v[52:53], v[52:53], v[20:21]
    v_pk_add_f32 v[54:55], v[54:55], v[22:23]
    v_pk_add_f32 v[56:57], v[56:57], v[24:25]
    v_pk_add_f32 v[58:59], v[58:59], v[26:27]
    s_add_u32 s54, s54, 65536
    s_waitcnt vmcnt(3)
    s_cmp_eq_u32 s39, 0
    s_cbranch_scc1 Lslow_55
    buffer_store_dword v17, v19, s[4:7], s56 offen offset:0
Ldual_55:
    s_waitcnt lgkmcnt(0)
    s_barrier
    ds_read_b128 v[124:127], v15 offset:24576
    ds_read_b128 v[128:131], v15 offset:25600
    ds_read_b128 v[132:135], v15 offset:26624
    ds_read_b128 v[136:139], v15 offset:27648
    ds_read_b128 v[140:143], v15 offset:28672
    ds_read_b128 v[144:147], v15 offset:29696
    buffer_load_dword v18, v16, s[4:7], s59 offen sc1
    s_waitcnt lgkmcnt(3)
    v_pk_add_f32 v[124:125], v[124:125], v[132:133]
    v_pk_add_f32 v[126:127], v[126:127], v[134:135]
    s_waitcnt lgkmcnt(2)
    v_pk_add_f32 v[128:129], v[128:129], v[136:137]
    v_pk_add_f32 v[130:131], v[130:131], v[138:139]
    s_waitcnt lgkmcnt(1)
    v_pk_add_f32 v[52:53], v[52:53], v[140:141]
    v_pk_add_f32 v[54:55], v[54:55], v[142:143]
    s_waitcnt lgkmcnt(0)
    v_pk_add_f32 v[56:57], v[56:57], v[144:145]
    v_pk_add_f32 v[58:59], v[58:59], v[146:147]
    v_pk_add_f32 v[52:53], v[52:53], v[124:125]
    v_pk_add_f32 v[54:55], v[54:55], v[126:127]
    v_pk_add_f32 v[56:57], v[56:57], v[128:129]
    v_pk_add_f32 v[58:59], v[58:59], v[130:131]
    buffer_load_dword v150, v16, s[4:7], s59 offen sc1
    v_cvt_pk_bf16_f32 v8, v52, v53
    v_cvt_pk_bf16_f32 v9, v54, v55
    v_cvt_pk_bf16_f32 v10, v56, v57
    v_cvt_pk_bf16_f32 v11, v58, v59
    s_cmp_eq_u32 s39, 0
    s_cbranch_scc1 Lslow_56
    buffer_store_dwordx4 v[8:11], v1, s[4:7], s54 offen
Ldual_56:
    v_pk_mul_f32 v[126:127], v[52:53], v[52:53]
    v_pk_add_f32 v[124:125], v[52:53], v[54:55]
    v_pk_fma_f32 v[126:127], v[54:55], v[54:55], v[126:127]
    v_pk_fma_f32 v[126:127], v[56:57], v[56:57], v[126:127]
    v_pk_fma_f32 v[126:127], v[58:59], v[58:59], v[126:127]
    v_pk_add_f32 v[124:125], v[124:125], v[56:57]
    v_pk_add_f32 v[124:125], v[124:125], v[58:59]
    v_add_f32 v124, v124, v125
    v_add_f32 v125, v126, v127
    s_lshl_b32 s49, s38, 9
    s_add_u32 s49, s49, 158976
    v_lshl_add_u32 v126, v0, 3, s49
    ds_write_b64 v126, v[124:125]
    buffer_load_dword v151, v16, s[4:7], s59 offen sc1
    s_waitcnt vmcnt(3)
    v_cmp_gt_u32 vcc, 1, v18
    s_cbranch_vccnz Lspin_17
Lback_18:
    s_add_u32 m0, s92, 0
    s_nop 0
    buffer_load_dwordx4 v1, s[4:7], s55 offen offset:0 sc1 lds
    buffer_load_dwordx4 v1, s[4:7], s55 offen offset:1024 sc1 lds
    s_add_u32 s55, s55, 8192
    s_add_u32 m0, s92, 8192
    s_nop 0
    buffer_load_dwordx4 v1, s[4:7], s55 offen offset:0 sc1 lds
    buffer_load_dwordx4 v1, s[4:7], s55 offen offset:1024 sc1 lds
    s_add_u32 s55, s55, 8192
    s_add_u32 m0, s92, 16384
    s_nop 0
    buffer_load_dwordx4 v1, s[4:7], s55 offen offset:0 sc1 lds
    buffer_load_dwordx4 v1, s[4:7], s55 offen offset:1024 sc1 lds
    s_add_u32 s55, s55, 8192
    v_add_u32 v12, 98304, v1
    v_mov_b32 v14, 0xbfb8aa3b
    s_waitcnt lgkmcnt(0)
    s_barrier
    s_add_u32 m0, s92, 24576
    s_nop 0
    buffer_load_dwordx4 v1, s[4:7], s55 offen offset:0 sc1 lds
    buffer_load_dwordx4 v1, s[4:7], s55 offen offset:1024 sc1 lds
    s_add_u32 s55, s55, 8192
    s_and_b32 s49, s38, 1
    s_lshl_b32 s48, s49, 11
    s_add_u32 s48, s48, 156928
    v_lshl_add_u32 v108, v0, 3, s48
    ds_read2st64_b64 v[100:103], v108 offset0:0 offset1:1
    ds_read2st64_b64 v[104:107], v108 offset0:2 offset1:3
    s_lshl1_add_u32 s48, s36, s49
    s_lshl1_add_u32 s48, s48, s40
    s_lshl3_add_u32 s48, s48, s41
    s_lshl_b32 s48, s48, 8
    s_add_u32 s48, s48, 262144
    s_cmp_lt_u32 s38, 2
    s_cselect_b32 s48, s48, 0x70000000
    v_and_b32 v109, 31, v0
    v_lshlrev_b32 v109, 3, v109
    s_waitcnt lgkmcnt(1)
    v_pk_add_f32 v[100:101], v[100:101], v[102:103]
    s_waitcnt lgkmcnt(0)
    v_pk_add_f32 v[104:105], v[104:105], v[106:107]
    v_pk_add_f32 v[100:101], v[100:101], v[104:105]
    v_mov_b32 v102, v100
    v_mov_b32 v103, v101
    s_nop 0
    v_permlane32_swap_b32 v102, v100
    v_permlane32_swap_b32 v103, v101
    v_pk_add_f32 v[100:101], v[100:101], v[102:103]
    s_cmp_eq_u32 s39, 0
    s_cbranch_scc1 Lslow_57
    buffer_store_dwordx2 v[100:101], v109, s[4:7], s48 offen
Ldual_57:
    buffer_load_dwordx4 v[252:255], v1, s[4:7], s98 offen offset:3072 sc1
    s_add_u32 s98, s98, 4096
    s_waitcnt vmcnt(11)
    s_cmp_eq_u32 s39, 0
    s_cbranch_scc1 Lslow_58
    buffer_store_dword v17, v19, s[4:7], s56 offen offset:256
Ldual_58:
    v_lshrrev_b32 v13, 5, v0
    v_lshlrev_b32 v13, 10, v13
    v_and_b32 v15, 31, v0
    v_lshl_add_u32 v13, v15, 3, v13
    v_and_b32 v15, 7, v0
    v_lshlrev_b32 v15, 2, v15
    v_mov_b32 v85, 0
    v_mov_b32 v86, 0
    v_mov_b32 v87, 0
    v_mov_b32 v89, 0
    v_mov_b32 v90, 0
    v_mov_b32 v91, 0
    s_lshl_b32 s49, s38, 8
    s_add_u32 s49, s49, 148736
    v_lshl_add_u32 v94, v0, 2, s49
    ds_read_b32 v84, v94
    s_waitcnt vmcnt(9)
    s_barrier
    ds_read_b128 v[52:55], v12 offset:0
    s_add_u32 m0, s92, 32768
    ds_read_b128 v[56:59], v12 offset:1024
    buffer_load_dwordx4 v1, s[4:7], s55 offen offset:0 sc1 lds
    ds_read_b128 v[60:63], v12 offset:2048
    ds_read_b128 v[64:67], v12 offset:3072
    ds_read_b128 v[68:71], v12 offset:4096
    ds_read_b128 v[72:75], v12 offset:5120
    buffer_load_dwordx4 v1, s[4:7], s55 offen offset:1024 sc1 lds
    s_add_u32 s55, s55, 8192
    s_add_u32 s59, s59, 256
    s_waitcnt lgkmcnt(4)
    v_mfma_f32_32x32x16_bf16 v[20:35], a[224:227], v[52:55], 0
    ds_read_b128 v[76:79], v12 offset:6144
    s_lshl2_add_u32 s57, s36, s40
    s_mul_i32 s57, s57, 114688
    s_mul_i32 s48, s38, 28672
    s_add_u32 s57, s57, s48
    s_add_u32 s57, s57, 8388608
    s_add_u32 s58, s57, 229376
    buffer_load_dwordx4 a[0:3], v1, s[4:7], s99 offen offset:0 sc1
    v_mfma_f32_32x32x16_bf16 v[20:35], a[228:231], v[56:59], v[20:35]
    ds_read_b128 v[80:83], v12 offset:7168
    s_mul_i32 s0, s38, 56
    s_add_u32 s0, s0, s50
    s_add_u32 s0, s0, 1536
    s_waitcnt lgkmcnt(4)
    v_mfma_f32_32x32x16_bf16 v[20:35], a[232:235], v[60:63], v[20:35]
    s_waitcnt vmcnt(10)
    s_barrier
    ds_read_b128 v[52:55], v12 offset:8192
    buffer_load_dwordx4 a[4:7], v1, s[4:7], s99 offen offset:1024 sc1
    s_waitcnt vmcnt(6)
    s_cmp_eq_u32 s39, 0
    s_cbranch_scc1 Lslow_59
    buffer_store_dword v17, v19, s[4:7], s3 offen offset:2304
Ldual_59:
    v_mfma_f32_32x32x16_bf16 v[20:35], a[236:239], v[64:67], v[20:35]
    s_add_u32 m0, s92, 40960
    ds_read_b128 v[56:59], v12 offset:9216
    buffer_load_dwordx4 v1, s[4:7], s55 offen offset:0 sc1 lds
    s_waitcnt lgkmcnt(4)
    v_mfma_f32_32x32x16_bf16 v[20:35], a[240:243], v[68:71], v[20:35]
    ds_read_b128 v[60:63], v12 offset:10240
    v_mfma_f32_32x32x16_bf16 v[20:35], a[244:247], v[72:75], v[20:35]
    ds_read_b128 v[64:67], v12 offset:11264
    s_waitcnt lgkmcnt(4)
    v_mfma_f32_32x32x16_bf16 v[20:35], a[248:251], v[76:79], v[20:35]
    ds_read_b128 v[68:71], v12 offset:12288
    v_mfma_f32_32x32x16_bf16 v[20:35], a[252:255], v[80:83], v[20:35]
    ds_read_b128 v[72:75], v12 offset:13312
    buffer_load_dwordx4 v1, s[4:7], s55 offen offset:1024 sc1 lds
    s_add_u32 s55, s55, 8192
    s_waitcnt lgkmcnt(4)
    v_mfma_f32_32x32x16_bf16 v[20:35], v[160:163], v[52:55], v[20:35]
    ds_read_b128 v[76:79], v12 offset:14336
    v_mfma_f32_32x32x16_bf16 v[20:35], v[164:167], v[56:59], v[20:35]
    ds_read_b128 v[80:83], v12 offset:15360
    s_waitcnt lgkmcnt(4)
    v_mfma_f32_32x32x16_bf16 v[20:35], v[168:171], v[60:63], v[20:35]
    s_barrier
    ds_read_b128 v[52:55], v12 offset:16384
    v_mfma_f32_32x32x16_bf16 v[20:35], v[172:175], v[64:67], v[20:35]
    s_add_u32 m0, s92, 0
    ds_read_b128 v[56:59], v12 offset:17408
    buffer_load_dwordx4 v1, s[4:7], s55 offen offset:0 sc1 lds
    buffer_load_dword v18, v15, s[4:7], s101 offen sc1
    s_waitcnt lgkmcnt(4)
    v_mfma_f32_32x32x16_bf16 v[20:35], v[176:179], v[68:71], v[20:35]
    ds_read_b128 v[60:63], v12 offset:18432
    v_mfma_f32_32x32x16_bf16 v[20:35], v[180:183], v[72:75], v[20:35]
    ds_read_b128 v[64:67], v12 offset:19456
    s_waitcnt lgkmcnt(4)
    v_mfma_f32_32x32x16_bf16 v[20:35], v[184:187], v[76:79], v[20:35]
    ds_read_b128 v[68:71], v12 offset:20480
    buffer_load_dword v112, v16, s[4:7], s59 offen sc1
    v_mfma_f32_32x32x16_bf16 v[20:35], v[188:191], v[80:83], v[20:35]
    ds_read_b128 v[72:75], v12 offset:21504
    buffer_load_dwordx4 v1, s[4:7], s55 offen offset:1024 sc1 lds
    s_add_u32 s55, s55, 8192
    s_waitcnt lgkmcnt(4)
    v_mfma_f32_32x32x16_bf16 v[20:35], v[192:195], v[52:55], v[20:35]
    ds_read_b128 v[76:79], v12 offset:22528
    v_mfma_f32_32x32x16_bf16 v[20:35], v[196:199], v[56:59], v[20:35]
    ds_read_b128 v[80:83], v12 offset:23552
    s_waitcnt lgkmcnt(4)
    v_mfma_f32_32x32x16_bf16 v[20:35], v[200:203], v[60:63], v[20:35]
    s_barrier
    ds_read_b128 v[52:55], v12 offset:24576
    s_waitcnt vmcnt(2)
    v_cmp_gt_u32 vcc, 1, v18
    s_cbranch_vccnz Lspin_19
Lback_20:
    v_mfma_f32_32x32x16_bf16 v[20:35], v[204:207], v[64:67], v[20:35]
    s_add_u32 m0, s92, 8192
    ds_read_b128 v[56:59], v12 offset:25600
    buffer_load_dwordx4 v1, s[4:7], s55 offen offset:0 sc1 lds
    buffer_load_dwordx2 v[100:101], v13, s[4:7], s95 offen offset:0 sc1
    s_waitcnt lgkmcnt(4)
    v_mfma_f32_32x32x16_bf16 v[20:35], v[208:211], v[68:71], v[20:35]
    ds_read_b128 v[60:63], v12 offset:26624
    buffer_load_dwordx2 v[102:103], v13, s[4:7], s95 offen offset:256 sc1
    buffer_load_dwordx2 v[104:105], v13, s[4:7], s95 offen offset:512 sc1
    v_mfma_f32_32x32x16_bf16 v[20:35], v[212:215], v[72:75], v[20:35]
    ds_read_b128 v[64:67], v12 offset:27648
    buffer_load_dwordx2 v[106:107], v13, s[4:7], s95 offen offset:768 sc1
    s_lshl_b32 s42, s38, 8
    s_add_u32 s42, s42, 149760
    v_and_b32 v15, 31, v0
    s_waitcnt lgkmcnt(4)
    v_mfma_f32_32x32x16_bf16 v[20:35], v[216:219], v[76:79], v[20:35]
    ds_read_b128 v[68:71], v12 offset:28672
    v_lshlrev_b32 v15, 2, v15
    v_add_u32 v108, s42, v15
    v_add_u32 v15, 149760, v15
    v_mfma_f32_32x32x16_bf16 v[20:35], v[220:223], v[80:83], v[20:35]
    ds_read_b128 v[72:75], v12 offset:29696
    buffer_load_dwordx4 v1, s[4:7], s55 offen offset:1024 sc1 lds
    s_add_u32 s55, s55, 8192
    s_waitcnt lgkmcnt(4)
    v_mfma_f32_32x32x16_bf16 v[20:35], v[224:227], v[52:55], v[20:35]
    ds_read_b128 v[76:79], v12 offset:30720
    buffer_load_dwordx4 a[8:11], v1, s[4:7], s99 offen offset:2048 sc1
    v_mfma_f32_32x32x16_bf16 v[20:35], v[228:231], v[56:59], v[20:35]
    ds_read_b128 v[80:83], v12 offset:31744
    s_waitcnt vmcnt(8)
    v_cmp_gt_u32 vcc, 1, v112
    s_cbranch_vccnz Lspin_21
Lback_22:
    s_waitcnt lgkmcnt(4)
    v_mfma_f32_32x32x16_bf16 v[20:35], v[232:235], v[60:63], v[20:35]
    s_barrier
    ds_read_b128 v[52:55], v12 offset:32768
    v_min_u32 v16, 13, v0
    v_lshlrev_b32 v16, 2, v16
    s_lshl2_add_u32 s48, s36, s40
    s_lshl2_add_u32 s49, s41, s38
    buffer_load_dwordx4 a[12:15], v1, s[4:7], s99 offen offset:3072 sc1
    s_add_u32 s99, s99, 4096
    v_mfma_f32_32x32x16_bf16 v[20:35], v[236:239], v[64:67], v[20:35]
    s_add_u32 m0, s92, 16384
    ds_read_b128 v[56:59], v12 offset:33792
    buffer_load_dwordx4 v1, s[4:7], s55 offen offset:0 sc1 lds
    s_lshl_b32 s54, s48, 5
    s_add_u32 s54, s54, s49
    s_lshl_b32 s54, s54, 10
    s_add_u32 s54, s54, 4194304
    s_waitcnt lgkmcnt(4)
    v_mfma_f32_32x32x16_bf16 v[20:35], v[240:243], v[68:71], v[20:35]
    ds_read_b128 v[60:63], v12 offset:34816
    s_lshl_b32 s56, s40, 5
    s_add_u32 s56, s56, s49
    s_lshl2_add_u32 s56, s56, s50
    s_add_u32 s56, s56, 768
    buffer_load_dwordx4 a[16:19], v1, s[4:7], s99 offen offset:0 sc1
    v_mfma_f32_32x32x16_bf16 v[20:35], v[244:247], v[72:75], v[20:35]
    ds_read_b128 v[64:67], v12 offset:35840
    s_waitcnt lgkmcnt(4)
    v_mfma_f32_32x32x16_bf16 v[20:35], v[248:251], v[76:79], v[20:35]
    ds_read_b128 v[68:71], v12 offset:36864
    s_waitcnt vmcnt(6)
    v_add_f32 v100, v100, v104
    v_add_f32 v101, v101, v105
    s_waitcnt vmcnt(5)
    v_add_f32 v102, v102, v106
    v_add_f32 v103, v103, v107
    v_add_f32 v116, v100, v102
    v_add_f32 v117, v101, v103
    buffer_load_dwordx4 a[20:23], v1, s[4:7], s99 offen offset:1024 sc1
    v_mfma_f32_32x32x16_bf16 v[20:35], v[252:255], v[80:83], v[20:35]
    ds_read_b128 v[72:75], v12 offset:37888
    buffer_load_dwordx4 v1, s[4:7], s55 offen offset:1024 sc1 lds
    s_add_u32 s55, s55, 8192
    v_mov_b32 v100, v116
    v_mov_b32 v101, v117
    s_nop 0
    v_permlane32_swap_b32 v100, v116
    v_permlane32_swap_b32 v101, v117
    s_waitcnt lgkmcnt(4)
    v_mfma_f32_32x32x16_bf16 v[144:159], a[224:227], v[52:55], 0
    ds_read_b128 v[76:79], v12 offset:38912
    v_add_f32 v116, v116, v100
    v_add_f32 v117, v117, v101
    v_mul_f32 v102, 0xbb000000, v116
    v_mul_f32 v100, 0x3b000000, v117
    v_fma_f32 v100, -v102, v102, v100
    v_max_f32 v100, 0, v100
    buffer_load_dwordx4 a[24:27], v1, s[4:7], s99 offen offset:2048 sc1
    v_mfma_f32_32x32x16_bf16 v[144:159], a[228:231], v[56:59], v[144:159]
    ds_read_b128 v[80:83], v12 offset:39936
    v_add_f32 v100, 0x3727c5ac, v100
    v_rsq_f32 v103, v100
    v_cvt_pk_bf16_f32 v100, v102, v102
    v_and_b32 v100, 0xffff0000, v100
    v_sub_f32 v100, v102, v100
    s_waitcnt lgkmcnt(4)
    v_mfma_f32_32x32x16_bf16 v[144:159], a[232:235], v[60:63], v[144:159]
    s_barrier
    ds_read_b128 v[52:55], v12 offset:40960
    v_cvt_pk_bf16_f32 v102, v102, v100
    v_mul_f32 v103, v14, v103
    ds_write2_b32 v108, v102, v103 offset0:0 offset1:32
    buffer_load_dwordx4 a[28:31], v1, s[4:7], s99 offen offset:3072 sc1
    s_add_u32 s99, s99, 4096
    v_mfma_f32_32x32x16_bf16 v[144:159], a[236:239], v[64:67], v[144:159]
    s_add_u32 m0, s92, 24576
    ds_read_b128 v[56:59], v12 offset:41984
    buffer_load_dwordx4 v1, s[4:7], s55 offen offset:0 sc1 lds
    s_waitcnt lgkmcnt(5)
    v_mfma_f32_32x32x16_bf16 v[144:159], a[240:243], v[68:71], v[144:159]
    ds_read_b128 v[60:63], v12 offset:43008
    buffer_load_dwordx4 a[32:35], v1, s[4:7], s99 offen offset:0 sc1
    v_mfma_f32_32x32x16_bf16 v[144:159], a[244:247], v[72:75], v[144:159]
    ds_read_b128 v[64:67], v12 offset:44032
    s_waitcnt lgkmcnt(5)
    v_mfma_f32_32x32x16_bf16 v[144:159], a[248:251], v[76:79], v[144:159]
    ds_read_b128 v[68:71], v12 offset:45056
    buffer_load_dwordx4 a[36:39], v1, s[4:7], s99 offen offset:1024 sc1
    v_mfma_f32_32x32x16_bf16 v[144:159], a[252:255], v[80:83], v[144:159]
    ds_read_b128 v[72:75], v12 offset:46080
    buffer_load_dwordx4 v1, s[4:7], s55 offen offset:1024 sc1 lds
    s_add_u32 s55, s55, 8192
    s_waitcnt lgkmcnt(4)
    v_mfma_f32_32x32x16_bf16 v[144:159], v[160:163], v[52:55], v[144:159]
    ds_read_b128 v[76:79], v12 offset:47104
    buffer_load_dwordx4 a[40:43], v1, s[4:7], s99 offen offset:2048 sc1
    v_mfma_f32_32x32x16_bf16 v[144:159], v[164:167], v[56:59], v[144:159]
    ds_read_b128 v[80:83], v12 offset:48128
    s_waitcnt lgkmcnt(0)
    v_mfma_f32_32x32x16_bf16 v[144:159], v[168:171], v[60:63], v[144:159]
    s_barrier
    ds_read_b128 v[52:55], v12 offset:0
    ds_read_b32 v88, v15
    ds_read2st64_b32 v[92:93], v15 offset0:0 offset1:1
    ds_read2st64_b32 v[94:95], v15 offset0:2 offset1:3
    ds_read2_b32 v[96:97], v15 offset0:32 offset1:96
    ds_read2_b32 v[98:99], v15 offset0:160 offset1:224
    buffer_load_dwordx4 a[44:47], v1, s[4:7], s99 offen offset:3072 sc1
    s_add_u32 s99, s99, 4096
    v_mfma_f32_32x32x16_bf16 v[144:159], v[172:175], v[64:67], v[144:159]
    s_add_u32 m0, s92, 32768
    ds_read_b128 v[56:59], v12 offset:1024
    buffer_load_dwordx4 v1, s[4:7], s55 offen offset:0 sc1 lds
    v_mfma_f32_32x32x16_bf16 v[144:159], v[176:179], v[68:71], v[144:159]
    ds_read_b128 v[60:63], v12 offset:2048
    buffer_load_dwordx4 a[48:51], v1, s[4:7], s99 offen offset:0 sc1
    v_mfma_f32_32x32x16_bf16 v[144:159], v[180:183], v[72:75], v[144:159]
    ds_read_b128 v[64:67], v12 offset:3072
    s_waitcnt lgkmcnt(7)
    v_mfma_f32_32x32x16_bf16 v[20:35], v[84:87], v[88:91], v[20:35]
    v_mfma_f32_32x32x16_bf16 v[144:159], v[184:187], v[76:79], v[144:159]
    ds_read_b128 v[68:71], v12 offset:4096
    buffer_load_dwordx4 a[52:55], v1, s[4:7], s99 offen offset:1024 sc1
    v_mfma_f32_32x32x16_bf16 v[144:159], v[188:191], v[80:83], v[144:159]
    ds_read_b128 v[72:75], v12 offset:5120
    buffer_load_dwordx4 v1, s[4:7], s55 offen offset:1024 sc1 lds
    s_add_u32 s55, s55, 8192
    s_waitcnt lgkmcnt(6)
    s_nop 3
    v_mul_f32 v20, v20, v96
    v_mul_f32 v21, v21, v96
    v_mul_f32 v22, v22, v96
    s_waitcnt lgkmcnt(4)
    v_mfma_f32_32x32x16_bf16 v[144:159], v[192:195], v[52:55], v[144:159]
    ds_read_b128 v[76:79], v12 offset:6144
    v_exp_f32 v100, v20
    v_mul_f32 v23, v23, v96
    v_exp_f32 v101, v21
    v_mul_f32 v24, v24, v96
    buffer_load_dwordx4 a[56:59], v1, s[4:7], s99 offen offset:2048 sc1
    v_mfma_f32_32x32x16_bf16 v[144:159], v[196:199], v[56:59], v[144:159]
    ds_read_b128 v[80:83], v12 offset:7168
    v_exp_f32 v102, v22
    v_fma_f32 v100, v100, v14, v14
    v_mul_f32 v25, v25, v96
    v_exp_f32 v103, v23
    s_waitcnt lgkmcnt(4)
    v_mfma_f32_32x32x16_bf16 v[144:159], v[200:203], v[60:63], v[144:159]
    s_waitcnt vmcnt(19)
    s_barrier
    ds_read_b128 v[52:55], v12 offset:8192
    v_fma_f32 v101, v101, v14, v14
    v_mul_f32 v26, v26, v96
    v_exp_f32 v104, v24
    buffer_load_dwordx4 a[60:63], v1, s[4:7], s99 offen offset:3072 sc1
    s_add_u32 s99, s99, 4096
    v_mfma_f32_32x32x16_bf16 v[144:159], v[204:207], v[64:67], v[144:159]
    s_add_u32 m0, s92, 40960
    ds_read_b128 v[56:59], v12 offset:9216
    buffer_load_dwordx4 v1, s[4:7], s55 offen offset:0 sc1 lds
    v_fma_f32 v102, v102, v14, v14
    v_rcp_f32 v100, v100
    v_mul_f32 v27, v27, v96
    s_waitcnt lgkmcnt(4)
    v_mfma_f32_32x32x16_bf16 v[144:159], v[208:211], v[68:71], v[144:159]
    ds_read_b128 v[60:63], v12 offset:10240
    v_exp_f32 v105, v25
    v_fma_f32 v103, v103, v14, v14
    v_rcp_f32 v101, v101
    v_mul_f32 v28, v28, v96
    buffer_load_dwordx4 a[64:67], v1, s[4:7], s99 offen offset:0 sc1
    v_mfma_f32_32x32x16_bf16 v[144:159], v[212:215], v[72:75], v[144:159]
    ds_read_b128 v[64:67], v12 offset:11264
    v_exp_f32 v106, v26
    v_fma_f32 v104, v104, v14, v14
    v_rcp_f32 v102, v102
    v_mul_f32 v20, v20, v100
    s_waitcnt lgkmcnt(4)
    v_mfma_f32_32x32x16_bf16 v[144:159], v[216:219], v[76:79], v[144:159]
    ds_read_b128 v[68:71], v12 offset:12288
    v_mul_f32 v29, v29, v96
    v_exp_f32 v107, v27
    v_fma_f32 v105, v105, v14, v14
    v_rcp_f32 v103, v103
    buffer_load_dwordx4 a[68:71], v1, s[4:7], s99 offen offset:1024 sc1
    v_mfma_f32_32x32x16_bf16 v[144:159], v[220:223], v[80:83], v[144:159]
    ds_read_b128 v[72:75], v12 offset:13312
    buffer_load_dwordx4 v1, s[4:7], s55 offen offset:1024 sc1 lds
    s_add_u32 s55, s55, 8192
    v_mul_f32 v21, v21, v101
    v_mul_f32 v30, v30, v96
    v_exp_f32 v108, v28
    s_waitcnt lgkmcnt(4)
    v_mfma_f32_32x32x16_bf16 v[144:159], v[224:227], v[52:55], v[144:159]
    ds_read_b128 v[76:79], v12 offset:14336
    v_fma_f32 v106, v106, v14, v14
    v_rcp_f32 v104, v104
    v_mul_f32 v22, v22, v102
    v_mul_f32 v31, v31, v96
    buffer_load_dwordx4 a[72:75], v1, s[4:7], s99 offen offset:2048 sc1
    v_mfma_f32_32x32x16_bf16 v[144:159], v[228:231], v[56:59], v[144:159]
    ds_read_b128 v[80:83], v12 offset:15360
    v_exp_f32 v109, v29
    v_fma_f32 v107, v107, v14, v14
    v_rcp_f32 v105, v105
    v_mul_f32 v23, v23, v103
    s_waitcnt lgkmcnt(4)
    v_mfma_f32_32x32x16_bf16 v[144:159], v[232:235], v[60:63], v[144:159]
    s_waitcnt vmcnt(19)
    s_barrier
    ds_read_b128 v[52:55], v12 offset:16384
    v_cvt_pk_bf16_f32 v116, v20, v21
    v_mul_f32 v32, v32, v96
    v_exp_f32 v110, v30
    buffer_load_dwordx4 a[76:79], v1, s[4:7], s99 offen offset:3072 sc1
    s_add_u32 s99, s99, 4096
    v_mfma_f32_32x32x16_bf16 v[144:159], v[236:239], v[64:67], v[144:159]
    s_add_u32 m0, s92, 0
    ds_read_b128 v[56:59], v12 offset:17408
    buffer_load_dwordx4 v1, s[4:7], s55 offen offset:0 sc1 lds
    v_fma_f32 v108, v108, v14, v14
    v_rcp_f32 v106, v106
    v_mul_f32 v24, v24, v104
    s_waitcnt lgkmcnt(4)
    v_mfma_f32_32x32x16_bf16 v[144:159], v[240:243], v[68:71], v[144:159]
    ds_read_b128 v[60:63], v12 offset:18432
    v_mov_b32 v88, v93
    v_mul_f32 v33, v33, v96
    v_exp_f32 v111, v31
    v_fma_f32 v109, v109, v14, v14
    buffer_load_dwordx4 a[80:83], v1, s[4:7], s99 offen offset:0 sc1
    v_mfma_f32_32x32x16_bf16 v[144:159], v[244:247], v[72:75], v[144:159]
    ds_read_b128 v[64:67], v12 offset:19456
    v_rcp_f32 v107, v107
    v_mul_f32 v25, v25, v105
    v_cvt_pk_bf16_f32 v117, v22, v23
    v_mul_f32 v34, v34, v96
    s_waitcnt lgkmcnt(4)
    v_mfma_f32_32x32x16_bf16 v[144:159], v[248:251], v[76:79], v[144:159]
    ds_read_b128 v[68:71], v12 offset:20480
    v_exp_f32 v112, v32
    v_fma_f32 v110, v110, v14, v14
    v_mfma_f32_32x32x16_bf16 v[144:159], v[84:87], v[88:91], v[144:159]
    v_rcp_f32 v108, v108
    v_mul_f32 v26, v26, v106
    v_mul_f32 v35, v35, v96
    v_exp_f32 v113, v33
    v_fma_f32 v111, v111, v14, v14
    buffer_load_dwordx4 a[84:87], v1, s[4:7], s99 offen offset:1024 sc1
    v_mfma_f32_32x32x16_bf16 v[144:159], v[252:255], v[80:83], v[144:159]
    ds_read_b128 v[72:75], v12 offset:21504
    buffer_load_dwordx4 v1, s[4:7], s55 offen offset:1024 sc1 lds
    s_add_u32 s55, s55, 8192
    v_rcp_f32 v109, v109
    v_mul_f32 v27, v27, v107
    v_cvt_pk_bf16_f32 v118, v24, v25
    s_waitcnt lgkmcnt(4)
    v_mfma_f32_32x32x16_bf16 v[36:51], a[224:227], v[52:55], 0
    ds_read_b128 v[76:79], v12 offset:22528
    v_exp_f32 v114, v34
    v_fma_f32 v112, v112, v14, v14
    v_rcp_f32 v110, v110
    v_mul_f32 v28, v28, v108
    buffer_load_dwordx4 a[88:91], v1, s[4:7], s99 offen offset:2048 sc1
    v_mfma_f32_32x32x16_bf16 v[36:51], a[228:231], v[56:59], v[36:51]
    ds_read_b128 v[80:83], v12 offset:23552
    v_exp_f32 v115, v35
    v_fma_f32 v113, v113, v14, v14
    v_rcp_f32 v111, v111
    v_mul_f32 v29, v29, v109
    s_waitcnt lgkmcnt(4)
    v_mfma_f32_32x32x16_bf16 v[36:51], a[232:235], v[60:63], v[36:51]
    s_waitcnt vmcnt(19)
    s_barrier
    ds_read_b128 v[52:55], v12 offset:24576
    v_cvt_pk_bf16_f32 v119, v26, v27
    v_fma_f32 v114, v114, v14, v14
    v_rcp_f32 v112, v112
    buffer_load_dwordx4 a[92:95], v1, s[4:7], s99 offen offset:3072 sc1
    s_add_u32 s99, s99, 4096
    v_mfma_f32_32x32x16_bf16 v[36:51], a[236:239], v[64:67], v[36:51]
    s_add_u32 m0, s92, 8192
    ds_read_b128 v[56:59], v12 offset:25600
    buffer_load_dwordx4 v1, s[4:7], s55 offen offset:0 sc1 lds
    v_mul_f32 v30, v30, v110
    v_fma_f32 v115, v115, v14, v14
    v_rcp_f32 v113, v113
    s_waitcnt lgkmcnt(4)
    v_mfma_f32_32x32x16_bf16 v[36:51], a[240:243], v[68:71], v[36:51]
    ds_read_b128 v[60:63], v12 offset:26624
    v_mul_f32 v31, v31, v111
    v_cvt_pk_bf16_f32 v120, v28, v29
    v_rcp_f32 v114, v114
    v_mul_f32 v32, v32, v112
    buffer_load_dwordx4 a[96:99], v1, s[4:7], s99 offen offset:0 sc1
    v_mfma_f32_32x32x16_bf16 v[36:51], a[244:247], v[72:75], v[36:51]
    ds_read_b128 v[64:67], v12 offset:27648
    v_rcp_f32 v115, v115
    v_mul_f32 v33, v33, v113
    v_cvt_pk_bf16_f32 v121, v30, v31
    v_mul_f32 v34, v34, v114
    v_mul_f32 v35, v35, v115
    s_waitcnt lgkmcnt(4)
    v_mfma_f32_32x32x16_bf16 v[36:51], a[248:251], v[76:79], v[36:51]
    ds_read_b128 v[68:71], v12 offset:28672
    v_cvt_pk_bf16_f32 v122, v32, v33
    v_cvt_pk_bf16_f32 v123, v34, v35
    buffer_load_dwordx4 a[100:103], v1, s[4:7], s99 offen offset:1024 sc1
    v_mfma_f32_32x32x16_bf16 v[36:51], a[252:255], v[80:83], v[36:51]
    ds_read_b128 v[72:75], v12 offset:29696
    buffer_load_dwordx4 v1, s[4:7], s55 offen offset:1024 sc1 lds
    s_add_u32 s55, s55, 8192
    s_waitcnt lgkmcnt(4)
    v_mfma_f32_32x32x16_bf16 v[36:51], v[160:163], v[52:55], v[36:51]
    ds_read_b128 v[76:79], v12 offset:30720
    buffer_store_dwordx4 v[116:119], v1, s[4:7], s93 offen offset:0 sc1
    buffer_store_dwordx4 v[120:123], v1, s[4:7], s93 offen offset:1024 sc1
    s_add_u32 s93, s93, 114688
    v_mul_f32 v144, v144, v97
    buffer_load_dwordx4 a[104:107], v1, s[4:7], s99 offen offset:2048 sc1
    v_mfma_f32_32x32x16_bf16 v[36:51], v[164:167], v[56:59], v[36:51]
    ds_read_b128 v[80:83], v12 offset:31744
    v_mul_f32 v145, v145, v97
    v_mul_f32 v146, v146, v97
    v_exp_f32 v100, v144
    v_mul_f32 v147, v147, v97
    s_waitcnt lgkmcnt(4)
    v_mfma_f32_32x32x16_bf16 v[36:51], v[168:171], v[60:63], v[36:51]
    s_waitcnt vmcnt(21)
    s_barrier
    ds_read_b128 v[52:55], v12 offset:32768
    v_exp_f32 v101, v145
    v_mul_f32 v148, v148, v97
    buffer_load_dwordx4 a[108:111], v1, s[4:7], s99 offen offset:3072 sc1
    s_add_u32 s99, s99, 4096
    v_mfma_f32_32x32x16_bf16 v[36:51], v[172:175], v[64:67], v[36:51]
    s_add_u32 m0, s92, 16384
    ds_read_b128 v[56:59], v12 offset:33792
    buffer_load_dwordx4 v1, s[4:7], s55 offen offset:0 sc1 lds
    v_exp_f32 v102, v146
    v_fma_f32 v100, v100, v14, v14
    v_mul_f32 v149, v149, v97
    s_waitcnt lgkmcnt(4)
    v_mfma_f32_32x32x16_bf16 v[36:51], v[176:179], v[68:71], v[36:51]
    ds_read_b128 v[60:63], v12 offset:34816
    v_exp_f32 v103, v147
    v_fma_f32 v101, v101, v14, v14
    v_mul_f32 v150, v150, v97
    v_exp_f32 v104, v148
    buffer_load_dwordx4 a[112:115], v1, s[4:7], s99 offen offset:0 sc1
    v_mfma_f32_32x32x16_bf16 v[36:51], v[180:183], v[72:75], v[36:51]
    ds_read_b128 v[64:67], v12 offset:35840
    v_fma_f32 v102, v102, v14, v14
    v_rcp_f32 v100, v100
    v_mul_f32 v151, v151, v97
    v_exp_f32 v105, v149
    s_waitcnt lgkmcnt(4)
    v_mfma_f32_32x32x16_bf16 v[36:51], v[184:187], v[76:79], v[36:51]
    ds_read_b128 v[68:71], v12 offset:36864
    v_fma_f32 v103, v103, v14, v14
    v_rcp_f32 v101, v101
    v_mul_f32 v152, v152, v97
    v_exp_f32 v106, v150
    buffer_load_dwordx4 a[116:119], v1, s[4:7], s99 offen offset:1024 sc1
    v_mfma_f32_32x32x16_bf16 v[36:51], v[188:191], v[80:83], v[36:51]
    ds_read_b128 v[72:75], v12 offset:37888
    buffer_load_dwordx4 v1, s[4:7], s55 offen offset:1024 sc1 lds
    s_add_u32 s55, s55, 8192
    v_fma_f32 v104, v104, v14, v14
    v_rcp_f32 v102, v102
    v_mul_f32 v144, v144, v100
    s_waitcnt lgkmcnt(4)
    v_mfma_f32_32x32x16_bf16 v[36:51], v[192:195], v[52:55], v[36:51]
    ds_read_b128 v[76:79], v12 offset:38912
    v_mul_f32 v153, v153, v97
    v_exp_f32 v107, v151
    v_fma_f32 v105, v105, v14, v14
    v_rcp_f32 v103, v103
    buffer_load_dwordx4 a[120:123], v1, s[4:7], s99 offen offset:2048 sc1
    v_mfma_f32_32x32x16_bf16 v[36:51], v[196:199], v[56:59], v[36:51]
    ds_read_b128 v[80:83], v12 offset:39936
    v_mul_f32 v145, v145, v101
    v_mul_f32 v154, v154, v97
    v_exp_f32 v108, v152
    v_fma_f32 v106, v106, v14, v14
    s_waitcnt lgkmcnt(4)
    v_mfma_f32_32x32x16_bf16 v[36:51], v[200:203], v[60:63], v[36:51]
    s_waitcnt vmcnt(21)
    s_barrier
    ds_read_b128 v[52:55], v12 offset:40960
    v_rcp_f32 v104, v104
    v_mul_f32 v146, v146, v102
    v_mul_f32 v155, v155, v97
    buffer_load_dwordx4 a[124:127], v1, s[4:7], s99 offen offset:3072 sc1
    s_add_u32 s99, s99, 4096
    v_mfma_f32_32x32x16_bf16 v[36:51], v[204:207], v[64:67], v[36:51]
    s_add_u32 m0, s92, 24576
    ds_read_b128 v[56:59], v12 offset:41984
    buffer_load_dwordx4 v1, s[4:7], s55 offen offset:0 sc1 lds
    v_exp_f32 v109, v153
    v_fma_f32 v107, v107, v14, v14
    s_waitcnt lgkmcnt(4)
    v_mfma_f32_32x32x16_bf16 v[36:51], v[208:211], v[68:71], v[36:51]
    ds_read_b128 v[60:63], v12 offset:43008
    v_rcp_f32 v105, v105
    v_mul_f32 v147, v147, v103
    v_cvt_pk_bf16_f32 v116, v144, v145
    v_mul_f32 v156, v156, v97
    buffer_load_dwordx4 a[128:131], v1, s[4:7], s99 offen offset:0 sc1
    v_mfma_f32_32x32x16_bf16 v[36:51], v[212:215], v[72:75], v[36:51]
    ds_read_b128 v[64:67], v12 offset:44032
    v_exp_f32 v110, v154
    v_fma_f32 v108, v108, v14, v14
    v_rcp_f32 v106, v106
    v_mul_f32 v148, v148, v104
    s_waitcnt lgkmcnt(4)
    v_mfma_f32_32x32x16_bf16 v[36:51], v[216:219], v[76:79], v[36:51]
    ds_read_b128 v[68:71], v12 offset:45056
    v_mul_f32 v157, v157, v97
    v_exp_f32 v111, v155
    v_fma_f32 v109, v109, v14, v14
    v_rcp_f32 v107, v107
    buffer_load_dwordx4 a[132:135], v1, s[4:7], s99 offen offset:1024 sc1
    v_mfma_f32_32x32x16_bf16 v[36:51], v[220:223], v[80:83], v[36:51]
    ds_read_b128 v[72:75], v12 offset:46080
    buffer_load_dwordx4 v1, s[4:7], s55 offen offset:1024 sc1 lds
    s_add_u32 s55, s55, 8192
    v_mul_f32 v149, v149, v105
    v_cvt_pk_bf16_f32 v117, v146, v147
    v_mul_f32 v158, v158, v97
    s_waitcnt lgkmcnt(4)
    v_mfma_f32_32x32x16_bf16 v[36:51], v[224:227], v[52:55], v[36:51]
    ds_read_b128 v[76:79], v12 offset:47104
    v_exp_f32 v112, v156
    v_fma_f32 v110, v110, v14, v14
    v_rcp_f32 v108, v108
    v_mul_f32 v150, v150, v106
    buffer_load_dwordx4 a[136:139], v1, s[4:7], s99 offen offset:2048 sc1
    v_mfma_f32_32x32x16_bf16 v[36:51], v[228:231], v[56:59], v[36:51]
    ds_read_b128 v[80:83], v12 offset:48128
    v_mul_f32 v159, v159, v97
    v_exp_f32 v113, v157
    v_fma_f32 v111, v111, v14, v14
    v_rcp_f32 v109, v109
    s_waitcnt lgkmcnt(4)
    v_mfma_f32_32x32x16_bf16 v[36:51], v[232:235], v[60:63], v[36:51]
    s_waitcnt vmcnt(21)
    s_barrier
    ds_read_b128 v[52:55], v12 offset:0
    v_mul_f32 v151, v151, v107
    v_cvt_pk_bf16_f32 v118, v148, v149
    v_exp_f32 v114, v158
    buffer_load_dwordx4 a[140:143], v1, s[4:7], s99 offen offset:3072 sc1
    s_add_u32 s99, s99, 4096
    v_mfma_f32_32x32x16_bf16 v[36:51], v[236:239], v[64:67], v[36:51]
    ds_read_b128 v[56:59], v12 offset:1024
    v_fma_f32 v112, v112, v14, v14
    v_rcp_f32 v110, v110
    v_mul_f32 v152, v152, v108
    v_exp_f32 v115, v159
    buffer_load_dwordx4 a[144:147], v1, s[4:7], s99 offen offset:0 sc1
    s_waitcnt lgkmcnt(4)
    v_mfma_f32_32x32x16_bf16 v[36:51], v[240:243], v[68:71], v[36:51]
    ds_read_b128 v[60:63], v12 offset:2048
    v_mov_b32 v88, v94
    v_fma_f32 v113, v113, v14, v14
    v_rcp_f32 v111, v111
    v_mul_f32 v153, v153, v109
    v_cvt_pk_bf16_f32 v119, v150, v151
    buffer_load_dwordx4 a[148:151], v1, s[4:7], s99 offen offset:1024 sc1
    v_mfma_f32_32x32x16_bf16 v[36:51], v[244:247], v[72:75], v[36:51]
    ds_read_b128 v[64:67], v12 offset:3072
    v_fma_f32 v114, v114, v14, v14
    v_rcp_f32 v112, v112
    v_mul_f32 v154, v154, v110
    v_fma_f32 v115, v115, v14, v14
    buffer_load_dwordx4 a[152:155], v1, s[4:7], s99 offen offset:2048 sc1
    s_waitcnt lgkmcnt(4)
    v_mfma_f32_32x32x16_bf16 v[36:51], v[248:251], v[76:79], v[36:51]
    ds_read_b128 v[68:71], v12 offset:4096
    v_rcp_f32 v113, v113
    v_mul_f32 v155, v155, v111
    v_cvt_pk_bf16_f32 v120, v152, v153
    v_mfma_f32_32x32x16_bf16 v[36:51], v[84:87], v[88:91], v[36:51]
    v_rcp_f32 v114, v114
    v_mul_f32 v156, v156, v112
    v_rcp_f32 v115, v115
    v_mul_f32 v157, v157, v113
    v_cvt_pk_bf16_f32 v121, v154, v155
    buffer_load_dwordx4 a[156:159], v1, s[4:7], s99 offen offset:3072 sc1
    s_add_u32 s99, s99, 4096
    v_mfma_f32_32x32x16_bf16 v[36:51], v[252:255], v[80:83], v[36:51]
    ds_read_b128 v[72:75], v12 offset:5120
    v_mul_f32 v158, v158, v114
    v_mul_f32 v159, v159, v115
    v_cvt_pk_bf16_f32 v122, v156, v157
    v_cvt_pk_bf16_f32 v123, v158, v159
    buffer_load_dwordx4 a[160:163], v1, s[4:7], s99 offen offset:0 sc1
    s_waitcnt lgkmcnt(4)
    v_mfma_f32_32x32x16_bf16 v[20:35], a[224:227], v[52:55], 0
    ds_read_b128 v[76:79], v12 offset:6144
    buffer_store_dwordx4 v[116:119], v1, s[4:7], s93 offen offset:0 sc1
    buffer_store_dwordx4 v[120:123], v1, s[4:7], s93 offen offset:1024 sc1
    s_add_u32 s93, s93, 114688
    buffer_load_dwordx4 a[164:167], v1, s[4:7], s99 offen offset:1024 sc1
    v_mfma_f32_32x32x16_bf16 v[20:35], a[228:231], v[56:59], v[20:35]
    ds_read_b128 v[80:83], v12 offset:7168
    buffer_load_dwordx4 a[168:171], v1, s[4:7], s99 offen offset:2048 sc1
    s_waitcnt lgkmcnt(4)
    v_mfma_f32_32x32x16_bf16 v[20:35], a[232:235], v[60:63], v[20:35]
    s_waitcnt vmcnt(25)
    s_barrier
    ds_read_b128 v[52:55], v12 offset:8192
    v_mul_f32 v36, v36, v98
    v_mul_f32 v37, v37, v98
    v_mul_f32 v38, v38, v98
    buffer_load_dwordx4 a[172:175], v1, s[4:7], s99 offen offset:3072 sc1
    s_add_u32 s99, s99, 4096
    v_mfma_f32_32x32x16_bf16 v[20:35], a[236:239], v[64:67], v[20:35]
    ds_read_b128 v[56:59], v12 offset:9216
    v_exp_f32 v100, v36
    v_mul_f32 v39, v39, v98
    v_exp_f32 v101, v37
    buffer_load_dwordx4 a[176:179], v1, s[4:7], s99 offen offset:0 sc1
    s_waitcnt lgkmcnt(4)
    v_mfma_f32_32x32x16_bf16 v[20:35], a[240:243], v[68:71], v[20:35]
    ds_read_b128 v[60:63], v12 offset:10240
    v_mul_f32 v40, v40, v98
    v_exp_f32 v102, v38
    v_fma_f32 v100, v100, v14, v14
    v_mul_f32 v41, v41, v98
    buffer_load_dwordx4 a[180:183], v1, s[4:7], s99 offen offset:1024 sc1
    v_mfma_f32_32x32x16_bf16 v[20:35], a[244:247], v[72:75], v[20:35]
    ds_read_b128 v[64:67], v12 offset:11264
    v_exp_f32 v103, v39
    v_fma_f32 v101, v101, v14, v14
    v_mul_f32 v42, v42, v98
    buffer_load_dwordx4 a[184:187], v1, s[4:7], s99 offen offset:2048 sc1
    s_waitcnt lgkmcnt(4)
    v_mfma_f32_32x32x16_bf16 v[20:35], a[248:251], v[76:79], v[20:35]
    ds_read_b128 v[68:71], v12 offset:12288
    v_exp_f32 v104, v40
    v_fma_f32 v102, v102, v14, v14
    v_rcp_f32 v100, v100
    buffer_load_dwordx4 a[188:191], v1, s[4:7], s99 offen offset:3072 sc1
    s_add_u32 s99, s99, 4096
    v_mfma_f32_32x32x16_bf16 v[20:35], a[252:255], v[80:83], v[20:35]
    ds_read_b128 v[72:75], v12 offset:13312
    v_mul_f32 v43, v43, v98
    v_exp_f32 v105, v41
    v_fma_f32 v103, v103, v14, v14
    buffer_load_dwordx4 a[192:195], v1, s[4:7], s99 offen offset:0 sc1
    s_waitcnt lgkmcnt(4)
    v_mfma_f32_32x32x16_bf16 v[20:35], v[160:163], v[52:55], v[20:35]
    ds_read_b128 v[76:79], v12 offset:14336
    v_rcp_f32 v101, v101
    v_mul_f32 v44, v44, v98
    v_exp_f32 v106, v42
    buffer_load_dwordx4 a[196:199], v1, s[4:7], s99 offen offset:1024 sc1
    v_mfma_f32_32x32x16_bf16 v[20:35], v[164:167], v[56:59], v[20:35]
    ds_read_b128 v[80:83], v12 offset:15360
    v_fma_f32 v104, v104, v14, v14
    v_rcp_f32 v102, v102
    v_mul_f32 v36, v36, v100
    v_mul_f32 v45, v45, v98
    buffer_load_dwordx4 a[200:203], v1, s[4:7], s99 offen offset:2048 sc1
    s_waitcnt lgkmcnt(4)
    v_mfma_f32_32x32x16_bf16 v[20:35], v[168:171], v[60:63], v[20:35]
    s_waitcnt vmcnt(25)
    s_barrier
    ds_read_b128 v[52:55], v12 offset:16384
    v_exp_f32 v107, v43
    v_fma_f32 v105, v105, v14, v14
    buffer_load_dwordx4 a[204:207], v1, s[4:7], s99 offen offset:3072 sc1
    s_add_u32 s99, s99, 4096
    v_mfma_f32_32x32x16_bf16 v[20:35], v[172:175], v[64:67], v[20:35]
    ds_read_b128 v[56:59], v12 offset:17408
    v_rcp_f32 v103, v103
    v_mul_f32 v37, v37, v101
    v_mul_f32 v46, v46, v98
    buffer_load_dwordx4 a[208:211], v1, s[4:7], s99 offen offset:0 sc1
    s_waitcnt lgkmcnt(4)
    v_mfma_f32_32x32x16_bf16 v[20:35], v[176:179], v[68:71], v[20:35]
    ds_read_b128 v[60:63], v12 offset:18432
    v_exp_f32 v108, v44
    v_fma_f32 v106, v106, v14, v14
    v_rcp_f32 v104, v104
    buffer_load_dwordx4 a[212:215], v1, s[4:7], s99 offen offset:1024 sc1
    v_mfma_f32_32x32x16_bf16 v[20:35], v[180:183], v[72:75], v[20:35]
    ds_read_b128 v[64:67], v12 offset:19456
    v_mul_f32 v38, v38, v102
    v_mul_f32 v47, v47, v98
    v_exp_f32 v109, v45
    v_fma_f32 v107, v107, v14, v14
    buffer_load_dwordx4 a[216:219], v1, s[4:7], s99 offen offset:2048 sc1
    s_waitcnt lgkmcnt(4)
    v_mfma_f32_32x32x16_bf16 v[20:35], v[184:187], v[76:79], v[20:35]
    ds_read_b128 v[68:71], v12 offset:20480
    v_rcp_f32 v105, v105
    v_mul_f32 v39, v39, v103
    v_cvt_pk_bf16_f32 v116, v36, v37
    v_mul_f32 v48, v48, v98
    buffer_load_dwordx4 a[220:223], v1, s[4:7], s99 offen offset:3072 sc1
    s_add_u32 s99, s99, 4096
    v_mfma_f32_32x32x16_bf16 v[20:35], v[188:191], v[80:83], v[20:35]
    ds_read_b128 v[72:75], v12 offset:21504
    s_waitcnt vmcnt(15)
    s_cmp_eq_u32 s39, 0
    s_cbranch_scc1 Lslow_60
    buffer_store_dword v17, v19, s[4:7], s94 offen offset:1536
Ldual_60:
    v_exp_f32 v110, v46
    v_fma_f32 v108, v108, v14, v14
    v_rcp_f32 v106, v106
    s_lshl_b32 s46, s37, 6
    s_add_u32 s46, s46, s52
    s_lshl_b32 s46, s46, 12
    s_add_u32 s46, s46, 20971520
    v_mov_b32 v124, -1
    v_mov_b32 v125, -1
    v_mov_b32 v126, -1
    v_mov_b32 v127, -1
    s_waitcnt lgkmcnt(4)
    v_mfma_f32_32x32x16_bf16 v[20:35], v[192:195], v[52:55], v[20:35]
    ds_read_b128 v[76:79], v12 offset:22528
    v_mul_f32 v40, v40, v104
    v_mul_f32 v49, v49, v98
    v_exp_f32 v111, v47
    v_fma_f32 v109, v109, v14, v14
    buffer_store_dwordx4 v[124:127], v1, s[4:7], s46 offen offset:0 sc1
    v_mfma_f32_32x32x16_bf16 v[20:35], v[196:199], v[56:59], v[20:35]
    ds_read_b128 v[80:83], v12 offset:23552
    v_rcp_f32 v107, v107
    v_mul_f32 v41, v41, v105
    v_cvt_pk_bf16_f32 v117, v38, v39
    v_mul_f32 v50, v50, v98
    buffer_store_dwordx4 v[124:127], v1, s[4:7], s46 offen offset:1024 sc1
    s_waitcnt lgkmcnt(4)
    v_mfma_f32_32x32x16_bf16 v[20:35], v[200:203], v[60:63], v[20:35]
    s_barrier
    ds_read_b128 v[52:55], v12 offset:24576
    v_exp_f32 v112, v48
    v_fma_f32 v110, v110, v14, v14
    buffer_store_dwordx4 v[124:127], v1, s[4:7], s46 offen offset:2048 sc1
    v_mfma_f32_32x32x16_bf16 v[20:35], v[204:207], v[64:67], v[20:35]
    ds_read_b128 v[56:59], v12 offset:25600
    v_rcp_f32 v108, v108
    v_mul_f32 v42, v42, v106
    v_mul_f32 v51, v51, v98
    buffer_store_dwordx4 v[124:127], v1, s[4:7], s46 offen offset:3072 sc1
    s_waitcnt lgkmcnt(4)
    v_mfma_f32_32x32x16_bf16 v[20:35], v[208:211], v[68:71], v[20:35]
    ds_read_b128 v[60:63], v12 offset:26624
    v_exp_f32 v113, v49
    v_fma_f32 v111, v111, v14, v14
    v_rcp_f32 v109, v109
    v_mfma_f32_32x32x16_bf16 v[20:35], v[212:215], v[72:75], v[20:35]
    ds_read_b128 v[64:67], v12 offset:27648
    v_mul_f32 v43, v43, v107
    v_cvt_pk_bf16_f32 v118, v40, v41
    v_exp_f32 v114, v50
    v_fma_f32 v112, v112, v14, v14
    s_waitcnt lgkmcnt(4)
    v_mfma_f32_32x32x16_bf16 v[20:35], v[216:219], v[76:79], v[20:35]
    ds_read_b128 v[68:71], v12 offset:28672
    v_rcp_f32 v110, v110
    v_mul_f32 v44, v44, v108
    v_exp_f32 v115, v51
    v_mfma_f32_32x32x16_bf16 v[20:35], v[220:223], v[80:83], v[20:35]
    ds_read_b128 v[72:75], v12 offset:29696
    buffer_load_dword v18, v16, s[4:7], s0 offen sc1
    v_fma_f32 v113, v113, v14, v14
    v_rcp_f32 v111, v111
    v_mul_f32 v45, v45, v109
    v_cvt_pk_bf16_f32 v119, v42, v43
    s_waitcnt lgkmcnt(4)
    v_mfma_f32_32x32x16_bf16 v[20:35], v[224:227], v[52:55], v[20:35]
    ds_read_b128 v[76:79], v12 offset:30720
    v_fma_f32 v114, v114, v14, v14
    v_rcp_f32 v112, v112
    v_mul_f32 v46, v46, v110
    v_fma_f32 v115, v115, v14, v14
    v_mfma_f32_32x32x16_bf16 v[20:35], v[228:231], v[56:59], v[20:35]
    ds_read_b128 v[80:83], v12 offset:31744
    v_rcp_f32 v113, v113
    v_mul_f32 v47, v47, v111
    v_cvt_pk_bf16_f32 v120, v44, v45
    s_waitcnt lgkmcnt(4)
    v_mfma_f32_32x32x16_bf16 v[20:35], v[232:235], v[60:63], v[20:35]
    v_rcp_f32 v114, v114
    v_mul_f32 v48, v48, v112
    v_rcp_f32 v115, v115
    v_mul_f32 v49, v49, v113
    v_mfma_f32_32x32x16_bf16 v[20:35], v[236:239], v[64:67], v[20:35]
    v_cvt_pk_bf16_f32 v121, v46, v47
    v_mul_f32 v50, v50, v114
    v_mul_f32 v51, v51, v115
    v_cvt_pk_bf16_f32 v122, v48, v49
    v_cvt_pk_bf16_f32 v123, v50, v51
    s_waitcnt lgkmcnt(2)
    v_mfma_f32_32x32x16_bf16 v[20:35], v[240:243], v[68:71], v[20:35]
    v_mov_b32 v88, v95
    buffer_store_dwordx4 v[116:119], v1, s[4:7], s93 offen offset:0 sc1
    buffer_store_dwordx4 v[120:123], v1, s[4:7], s93 offen offset:1024 sc1
    s_add_u32 s93, s93, 114688
    v_mfma_f32_32x32x16_bf16 v[20:35], v[244:247], v[72:75], v[20:35]
    s_waitcnt lgkmcnt(0)
    v_mfma_f32_32x32x16_bf16 v[20:35], v[248:251], v[76:79], v[20:35]
    v_mfma_f32_32x32x16_bf16 v[20:35], v[84:87], v[88:91], v[20:35]
    v_mfma_f32_32x32x16_bf16 v[20:35], v[252:255], v[80:83], v[20:35]
    s_waitcnt vmcnt(2)
    v_cmp_gt_u32 vcc, 1, v18
    s_cbranch_vccnz Lspin_23
Lback_24:
    s_nop 8
    v_mul_f32 v20, v20, v99
    v_mul_f32 v21, v21, v99
    v_mul_f32 v22, v22, v99
    v_exp_f32 v100, v20
    v_mul_f32 v23, v23, v99
    v_exp_f32 v101, v21
    v_mul_f32 v24, v24, v99
    buffer_load_dwordx4 v[132:135], v1, s[4:7], s57 offen offset:0 sc1
    v_exp_f32 v102, v22
    v_fma_f32 v100, v100, v14, v14
    v_mul_f32 v25, v25, v99
    v_exp_f32 v103, v23
    v_fma_f32 v101, v101, v14, v14
    v_mul_f32 v26, v26, v99
    v_exp_f32 v104, v24
    buffer_load_dwordx4 v[136:139], v1, s[4:7], s57 offen offset:1024 sc1
    v_fma_f32 v102, v102, v14, v14
    v_rcp_f32 v100, v100
    v_mul_f32 v27, v27, v99
    v_exp_f32 v105, v25
    v_fma_f32 v103, v103, v14, v14
    v_rcp_f32 v101, v101
    v_mul_f32 v28, v28, v99
    buffer_load_dwordx4 v[140:143], v1, s[4:7], s57 offen offset:2048 sc1
    v_exp_f32 v106, v26
    v_fma_f32 v104, v104, v14, v14
    v_rcp_f32 v102, v102
    v_mul_f32 v20, v20, v100
    v_mul_f32 v29, v29, v99
    v_exp_f32 v107, v27
    v_fma_f32 v105, v105, v14, v14
    buffer_load_dwordx4 v[128:131], v1, s[4:7], s57 offen offset:3072 sc1
    s_add_u32 s57, s57, 4096
    v_rcp_f32 v103, v103
    v_mul_f32 v21, v21, v101
    v_mul_f32 v30, v30, v99
    v_exp_f32 v108, v28
    v_fma_f32 v106, v106, v14, v14
    v_rcp_f32 v104, v104
    v_mul_f32 v22, v22, v102
    buffer_load_dwordx4 v[144:147], v1, s[4:7], s57 offen offset:0 sc1
    v_mul_f32 v31, v31, v99
    v_exp_f32 v109, v29
    v_fma_f32 v107, v107, v14, v14
    v_rcp_f32 v105, v105
    v_mul_f32 v23, v23, v103
    v_cvt_pk_bf16_f32 v116, v20, v21
    v_mul_f32 v32, v32, v99
    buffer_load_dwordx4 v[148:151], v1, s[4:7], s57 offen offset:1024 sc1
    v_exp_f32 v110, v30
    v_fma_f32 v108, v108, v14, v14
    v_rcp_f32 v106, v106
    v_mul_f32 v24, v24, v104
    v_mul_f32 v33, v33, v99
    v_exp_f32 v111, v31
    v_fma_f32 v109, v109, v14, v14
    buffer_load_dwordx4 v[152:155], v1, s[4:7], s57 offen offset:2048 sc1
    v_rcp_f32 v107, v107
    v_mul_f32 v25, v25, v105
    v_cvt_pk_bf16_f32 v117, v22, v23
    v_mul_f32 v34, v34, v99
    v_exp_f32 v112, v32
    v_fma_f32 v110, v110, v14, v14
    v_rcp_f32 v108, v108
    buffer_load_dwordx4 v[156:159], v1, s[4:7], s57 offen offset:3072 sc1
    s_add_u32 s57, s57, 4096
    v_mul_f32 v26, v26, v106
    v_mul_f32 v35, v35, v99
    v_exp_f32 v113, v33
    v_fma_f32 v111, v111, v14, v14
    v_rcp_f32 v109, v109
    v_mul_f32 v27, v27, v107
    v_cvt_pk_bf16_f32 v118, v24, v25
    buffer_load_dwordx4 v[36:39], v1, s[4:7], s57 offen offset:0 sc1
    v_exp_f32 v114, v34
    v_fma_f32 v112, v112, v14, v14
    v_rcp_f32 v110, v110
    v_mul_f32 v28, v28, v108
    v_exp_f32 v115, v35
    v_fma_f32 v113, v113, v14, v14
    buffer_load_dwordx4 v[40:43], v1, s[4:7], s57 offen offset:1024 sc1
    s_waitcnt vmcnt(9)
    v_mfma_f32_32x32x16_bf16 v[52:67], a[0:3], v[132:135], 0
    v_rcp_f32 v111, v111
    v_mul_f32 v29, v29, v109
    v_cvt_pk_bf16_f32 v119, v26, v27
    v_fma_f32 v114, v114, v14, v14
    v_rcp_f32 v112, v112
    v_mul_f32 v30, v30, v110
    v_fma_f32 v115, v115, v14, v14
    v_rcp_f32 v113, v113
    v_mul_f32 v31, v31, v111
    v_cvt_pk_bf16_f32 v120, v28, v29
    v_rcp_f32 v114, v114
    v_mul_f32 v32, v32, v112
    buffer_load_dwordx4 v[44:47], v1, s[4:7], s57 offen offset:2048 sc1
    v_mfma_f32_32x32x16_bf16 v[68:83], a[4:7], v[132:135], 0
    v_rcp_f32 v115, v115
    v_mul_f32 v33, v33, v113
    v_cvt_pk_bf16_f32 v121, v30, v31
    v_mul_f32 v34, v34, v114
    v_mul_f32 v35, v35, v115
    v_cvt_pk_bf16_f32 v122, v32, v33
    v_cvt_pk_bf16_f32 v123, v34, v35
    buffer_store_dwordx4 v[116:119], v1, s[4:7], s93 offen offset:0 sc1
    buffer_store_dwordx4 v[120:123], v1, s[4:7], s93 offen offset:1024 sc1
    s_add_u32 s93, s93, 114688
    s_xor_b32 s49, s38, 1
    s_mul_i32 s49, s49, 6144
    s_add_u32 s49, s49, 98304
    buffer_load_dwordx4 v[48:51], v1, s[4:7], s57 offen offset:3072 sc1
    s_add_u32 s57, s57, 4096
    s_waitcnt vmcnt(12)
    v_mfma_f32_32x32x16_bf16 v[52:67], a[8:11], v[136:139], v[52:67]
    v_add_u32 v12, s49, v1
    s_xor_b32 s49, s38, 2
    s_mul_i32 s49, s49, 6144
    s_add_u32 s49, s49, 100352
    v_add_u32 v13, s49, v1
    v_mfma_f32_32x32x16_bf16 v[68:83], a[12:15], v[136:139], v[68:83]
    s_xor_b32 s49, s38, 3
    s_mul_i32 s49, s49, 6144
    s_add_u32 s49, s49, 102400
    v_add_u32 v14, s49, v1
    s_mul_i32 s49, s38, 6144
    buffer_load_dwordx4 v[124:127], v1, s[4:7], s57 offen offset:0 sc1
    s_waitcnt vmcnt(12)
    v_mfma_f32_32x32x16_bf16 v[52:67], a[16:19], v[140:143], v[52:67]
    s_add_u32 s49, s49, 98304
    v_add_u32 v15, s49, v1
    v_mfma_f32_32x32x16_bf16 v[68:83], a[20:23], v[140:143], v[68:83]
    buffer_load_dwordx4 v[20:23], v1, s[4:7], s57 offen offset:1024 sc1
    s_waitcnt vmcnt(12)
    v_mfma_f32_32x32x16_bf16 v[52:67], a[24:27], v[128:131], v[52:67]
    v_mfma_f32_32x32x16_bf16 v[68:83], a[28:31], v[128:131], v[68:83]
    buffer_load_dwordx4 v[24:27], v1, s[4:7], s57 offen offset:2048 sc1
    s_waitcnt vmcnt(12)
    v_mfma_f32_32x32x16_bf16 v[52:67], a[32:35], v[144:147], v[52:67]
    v_mfma_f32_32x32x16_bf16 v[68:83], a[36:39], v[144:147], v[68:83]
    buffer_load_dwordx4 v[28:31], v1, s[4:7], s57 offen offset:3072 sc1
    s_add_u32 s57, s57, 4096
    s_waitcnt vmcnt(12)
    v_mfma_f32_32x32x16_bf16 v[52:67], a[40:43], v[148:151], v[52:67]
    v_mfma_f32_32x32x16_bf16 v[68:83], a[44:47], v[148:151], v[68:83]
    buffer_load_dwordx4 v[32:35], v1, s[4:7], s57 offen offset:0 sc1
    s_waitcnt vmcnt(12)
    v_mfma_f32_32x32x16_bf16 v[52:67], a[48:51], v[152:155], v[52:67]
    v_mfma_f32_32x32x16_bf16 v[68:83], a[52:55], v[152:155], v[68:83]
    buffer_load_dwordx4 v[132:135], v1, s[4:7], s57 offen offset:1024 sc1
    s_waitcnt vmcnt(12)
    v_mfma_f32_32x32x16_bf16 v[52:67], a[56:59], v[156:159], v[52:67]
    v_mfma_f32_32x32x16_bf16 v[68:83], a[60:63], v[156:159], v[68:83]
    buffer_load_dwordx4 v[136:139], v1, s[4:7], s57 offen offset:2048 sc1
    s_waitcnt vmcnt(12)
    v_mfma_f32_32x32x16_bf16 v[52:67], a[64:67], v[36:39], v[52:67]
    v_mfma_f32_32x32x16_bf16 v[68:83], a[68:71], v[36:39], v[68:83]
    buffer_load_dwordx4 v[140:143], v1, s[4:7], s57 offen offset:3072 sc1
    s_add_u32 s57, s57, 4096
    s_waitcnt vmcnt(12)
    v_mfma_f32_32x32x16_bf16 v[52:67], a[72:75], v[40:43], v[52:67]
    s_waitcnt vmcnt(9)
    s_cmp_eq_u32 s39, 0
    s_cbranch_scc1 Lslow_61
    buffer_store_dword v17, v19, s[4:7], s94 offen offset:2048
Ldual_61:
    v_mfma_f32_32x32x16_bf16 v[68:83], a[76:79], v[40:43], v[68:83]
    buffer_load_dwordx4 v[128:131], v1, s[4:7], s57 offen offset:0 sc1
    v_mfma_f32_32x32x16_bf16 v[52:67], a[80:83], v[44:47], v[52:67]
    v_mfma_f32_32x32x16_bf16 v[68:83], a[84:87], v[44:47], v[68:83]
    buffer_load_dwordx4 v[144:147], v1, s[4:7], s57 offen offset:1024 sc1
    s_waitcnt vmcnt(11)
    v_mfma_f32_32x32x16_bf16 v[52:67], a[88:91], v[48:51], v[52:67]
    v_mfma_f32_32x32x16_bf16 v[68:83], a[92:95], v[48:51], v[68:83]
    buffer_load_dwordx4 v[148:151], v1, s[4:7], s57 offen offset:2048 sc1
    s_waitcnt vmcnt(11)
    v_mfma_f32_32x32x16_bf16 v[52:67], a[96:99], v[124:127], v[52:67]
    v_mfma_f32_32x32x16_bf16 v[68:83], a[100:103], v[124:127], v[68:83]
    buffer_load_dwordx4 v[152:155], v1, s[4:7], s57 offen offset:3072 sc1
    s_add_u32 s57, s57, 4096
    s_waitcnt vmcnt(11)
    v_mfma_f32_32x32x16_bf16 v[52:67], a[104:107], v[20:23], v[52:67]
    v_mfma_f32_32x32x16_bf16 v[68:83], a[108:111], v[20:23], v[68:83]
    buffer_load_dwordx4 v[156:159], v1, s[4:7], s57 offen offset:0 sc1
    s_waitcnt vmcnt(11)
    v_mfma_f32_32x32x16_bf16 v[52:67], a[112:115], v[24:27], v[52:67]
    s_add_u32 s0, s0, 512
    buffer_load_dword v18, v16, s[4:7], s0 offen sc1
    v_mfma_f32_32x32x16_bf16 v[68:83], a[116:119], v[24:27], v[68:83]
    buffer_load_dwordx4 v[36:39], v1, s[4:7], s57 offen offset:1024 sc1
    s_waitcnt vmcnt(12)
    v_mfma_f32_32x32x16_bf16 v[52:67], a[120:123], v[28:31], v[52:67]
    v_mfma_f32_32x32x16_bf16 v[68:83], a[124:127], v[28:31], v[68:83]
    buffer_load_dwordx4 v[40:43], v1, s[4:7], s57 offen offset:2048 sc1
    s_waitcnt vmcnt(12)
    v_mfma_f32_32x32x16_bf16 v[52:67], a[128:131], v[32:35], v[52:67]
    v_mfma_f32_32x32x16_bf16 v[68:83], a[132:135], v[32:35], v[68:83]
    buffer_load_dwordx4 v[44:47], v1, s[4:7], s57 offen offset:3072 sc1
    s_add_u32 s57, s57, 4096
    s_waitcnt vmcnt(12)
    v_mfma_f32_32x32x16_bf16 v[52:67], a[136:139], v[132:135], v[52:67]
    v_mfma_f32_32x32x16_bf16 v[68:83], a[140:143], v[132:135], v[68:83]
    s_waitcnt vmcnt(11)
    v_mfma_f32_32x32x16_bf16 v[52:67], a[144:147], v[136:139], v[52:67]
    v_mfma_f32_32x32x16_bf16 v[68:83], a[148:151], v[136:139], v[68:83]
    s_waitcnt vmcnt(10)
    v_mfma_f32_32x32x16_bf16 v[52:67], a[152:155], v[140:143], v[52:67]
    s_waitcnt vmcnt(3)
    v_cmp_gt_u32 vcc, 1, v18
    s_cbranch_vccnz Lspin_25
Lback_26:
    buffer_load_dwordx4 v[48:51], v1, s[4:7], s58 offen offset:0 sc1
    v_mfma_f32_32x32x16_bf16 v[68:83], a[156:159], v[140:143], v[68:83]
    s_barrier
    v_mfma_f32_32x32x16_bf16 v[52:67], a[160:163], v[128:131], v[52:67]
    buffer_load_dwordx4 v[124:127], v1, s[4:7], s58 offen offset:1024 sc1
    v_mfma_f32_32x32x16_bf16 v[68:83], a[164:167], v[128:131], v[68:83]
    v_mfma_f32_32x32x16_bf16 v[52:67], a[168:171], v[144:147], v[52:67]
    buffer_load_dwordx4 v[20:23], v1, s[4:7], s58 offen offset:2048 sc1
    v_mfma_f32_32x32x16_bf16 v[68:83], a[172:175], v[144:147], v[68:83]
    v_mfma_f32_32x32x16_bf16 v[52:67], a[176:179], v[148:151], v[52:67]
    buffer_load_dwordx4 v[24:27], v1, s[4:7], s58 offen offset:3072 sc1
    s_add_u32 s58, s58, 4096
    v_mfma_f32_32x32x16_bf16 v[68:83], a[180:183], v[148:151], v[68:83]
    v_mfma_f32_32x32x16_bf16 v[52:67], a[184:187], v[152:155], v[52:67]
    buffer_load_dwordx4 v[28:31], v1, s[4:7], s58 offen offset:0 sc1
    v_mfma_f32_32x32x16_bf16 v[68:83], a[188:191], v[152:155], v[68:83]
    v_mfma_f32_32x32x16_bf16 v[52:67], a[192:195], v[156:159], v[52:67]
    buffer_load_dwordx4 v[32:35], v1, s[4:7], s58 offen offset:1024 sc1
    v_mfma_f32_32x32x16_bf16 v[68:83], a[196:199], v[156:159], v[68:83]
    s_waitcnt vmcnt(8)
    v_mfma_f32_32x32x16_bf16 v[52:67], a[200:203], v[36:39], v[52:67]
    buffer_load_dwordx4 v[132:135], v1, s[4:7], s58 offen offset:2048 sc1
    v_mfma_f32_32x32x16_bf16 v[68:83], a[204:207], v[36:39], v[68:83]
    s_waitcnt vmcnt(8)
    v_mfma_f32_32x32x16_bf16 v[52:67], a[208:211], v[40:43], v[52:67]
    buffer_load_dwordx4 v[136:139], v1, s[4:7], s58 offen offset:3072 sc1
    s_add_u32 s58, s58, 4096
    v_mfma_f32_32x32x16_bf16 v[68:83], a[212:215], v[40:43], v[68:83]
    s_waitcnt vmcnt(8)
    v_mfma_f32_32x32x16_bf16 v[52:67], a[216:219], v[44:47], v[52:67]
    buffer_load_dwordx4 v[140:143], v1, s[4:7], s58 offen offset:0 sc1
    v_mfma_f32_32x32x16_bf16 v[68:83], a[220:223], v[44:47], v[68:83]
    s_waitcnt vmcnt(8)
    v_mfma_f32_32x32x16_bf16 v[84:99], a[0:3], v[48:51], 0
    buffer_load_dwordx4 v[128:131], v1, s[4:7], s58 offen offset:1024 sc1
    v_mfma_f32_32x32x16_bf16 v[100:115], a[4:7], v[48:51], 0
    s_waitcnt vmcnt(8)
    v_mfma_f32_32x32x16_bf16 v[84:99], a[8:11], v[124:127], v[84:99]
    buffer_load_dwordx4 v[144:147], v1, s[4:7], s58 offen offset:2048 sc1
    v_mfma_f32_32x32x16_bf16 v[100:115], a[12:15], v[124:127], v[100:115]
    s_waitcnt vmcnt(8)
    v_mfma_f32_32x32x16_bf16 v[84:99], a[16:19], v[20:23], v[84:99]
    v_lshlrev_b32 v116, 16, v4
    v_and_b32 v117, 0xffff0000, v4
    v_lshlrev_b32 v118, 16, v5
    v_and_b32 v119, 0xffff0000, v5
    v_lshlrev_b32 v120, 16, v6
    buffer_load_dwordx4 v[148:151], v1, s[4:7], s58 offen offset:3072 sc1
    s_add_u32 s58, s58, 4096
    v_mfma_f32_32x32x16_bf16 v[100:115], a[20:23], v[20:23], v[100:115]
    v_and_b32 v121, 0xffff0000, v6
    v_lshlrev_b32 v122, 16, v7
    v_and_b32 v123, 0xffff0000, v7
    s_waitcnt vmcnt(8)
    v_mfma_f32_32x32x16_bf16 v[84:99], a[24:27], v[24:27], v[84:99]
    ds_write_b128 v12, v[60:63] offset:24576
    buffer_load_dwordx4 v[152:155], v1, s[4:7], s58 offen offset:0 sc1
    v_mfma_f32_32x32x16_bf16 v[100:115], a[28:31], v[24:27], v[100:115]
    s_waitcnt vmcnt(8)
    v_mfma_f32_32x32x16_bf16 v[84:99], a[32:35], v[28:31], v[84:99]
    ds_write_b128 v12, v[64:67] offset:25600
    buffer_load_dwordx4 v[156:159], v1, s[4:7], s58 offen offset:1024 sc1
    v_mfma_f32_32x32x16_bf16 v[100:115], a[36:39], v[28:31], v[100:115]
    s_waitcnt vmcnt(8)
    v_mfma_f32_32x32x16_bf16 v[84:99], a[40:43], v[32:35], v[84:99]
    ds_write_b128 v13, v[68:71] offset:24576
    buffer_load_dwordx4 v[36:39], v1, s[4:7], s58 offen offset:2048 sc1
    v_mfma_f32_32x32x16_bf16 v[100:115], a[44:47], v[32:35], v[100:115]
    s_waitcnt vmcnt(8)
    v_mfma_f32_32x32x16_bf16 v[84:99], a[48:51], v[132:135], v[84:99]
    ds_write_b128 v13, v[72:75] offset:25600
    buffer_load_dwordx4 v[40:43], v1, s[4:7], s58 offen offset:3072 sc1
    s_add_u32 s58, s58, 4096
    v_mfma_f32_32x32x16_bf16 v[100:115], a[52:55], v[132:135], v[100:115]
    s_waitcnt vmcnt(8)
    v_mfma_f32_32x32x16_bf16 v[84:99], a[56:59], v[136:139], v[84:99]
    ds_write_b128 v14, v[76:79] offset:24576
    buffer_load_dwordx4 v[44:47], v1, s[4:7], s58 offen offset:0 sc1
    v_mfma_f32_32x32x16_bf16 v[100:115], a[60:63], v[136:139], v[100:115]
    s_waitcnt vmcnt(8)
    v_mfma_f32_32x32x16_bf16 v[84:99], a[64:67], v[140:143], v[84:99]
    ds_write_b128 v14, v[80:83] offset:25600
    buffer_load_dwordx4 v[48:51], v1, s[4:7], s58 offen offset:1024 sc1
    v_mfma_f32_32x32x16_bf16 v[100:115], a[68:71], v[140:143], v[100:115]
    s_waitcnt vmcnt(8)
    v_mfma_f32_32x32x16_bf16 v[84:99], a[72:75], v[128:131], v[84:99]
    v_add_f32 v52, v52, v116
    v_add_f32 v53, v53, v117
    v_add_f32 v54, v54, v118
    v_add_f32 v55, v55, v119
    v_add_f32 v56, v56, v120
    buffer_load_dwordx4 v[124:127], v1, s[4:7], s58 offen offset:2048 sc1
    v_mfma_f32_32x32x16_bf16 v[100:115], a[76:79], v[128:131], v[100:115]
    v_add_f32 v57, v57, v121
    v_add_f32 v58, v58, v122
    v_add_f32 v59, v59, v123
    s_waitcnt lgkmcnt(0)
    s_barrier
    s_waitcnt vmcnt(8)
    v_mfma_f32_32x32x16_bf16 v[84:99], a[80:83], v[144:147], v[84:99]
    ds_read_b128 v[60:63], v15 offset:24576
    ds_read_b128 v[64:67], v15 offset:25600
    ds_read_b128 v[68:71], v15 offset:26624
    ds_read_b128 v[72:75], v15 offset:27648
    ds_read_b128 v[76:79], v15 offset:28672
    buffer_load_dwordx4 v[20:23], v1, s[4:7], s58 offen offset:3072 sc1
    s_add_u32 s58, s58, 4096
    v_mfma_f32_32x32x16_bf16 v[100:115], a[84:87], v[144:147], v[100:115]
    ds_read_b128 v[80:83], v15 offset:29696
    s_waitcnt vmcnt(8)
    v_mfma_f32_32x32x16_bf16 v[84:99], a[88:91], v[148:151], v[84:99]
    buffer_load_dwordx4 v[24:27], v1, s[4:7], s58 offen offset:0 sc1
    v_mfma_f32_32x32x16_bf16 v[100:115], a[92:95], v[148:151], v[100:115]
    s_waitcnt vmcnt(8)
    v_mfma_f32_32x32x16_bf16 v[84:99], a[96:99], v[152:155], v[84:99]
    buffer_load_dwordx4 v[28:31], v1, s[4:7], s58 offen offset:1024 sc1
    v_mfma_f32_32x32x16_bf16 v[100:115], a[100:103], v[152:155], v[100:115]
    s_waitcnt lgkmcnt(3)
    v_add_f32 v60, v60, v68
    v_add_f32 v61, v61, v69
    v_add_f32 v62, v62, v70
    v_add_f32 v63, v63, v71
    s_waitcnt lgkmcnt(2)
    v_add_f32 v64, v64, v72
    s_waitcnt vmcnt(8)
    v_mfma_f32_32x32x16_bf16 v[84:99], a[104:107], v[156:159], v[84:99]
    v_add_f32 v65, v65, v73
    v_add_f32 v66, v66, v74
    v_add_f32 v67, v67, v75
    s_waitcnt lgkmcnt(1)
    v_add_f32 v52, v52, v76
    v_add_f32 v53, v53, v77
    buffer_load_dwordx4 v[32:35], v1, s[4:7], s58 offen offset:2048 sc1
    v_mfma_f32_32x32x16_bf16 v[100:115], a[108:111], v[156:159], v[100:115]
    v_add_f32 v54, v54, v78
    v_add_f32 v55, v55, v79
    s_waitcnt lgkmcnt(0)
    v_add_f32 v56, v56, v80
    v_add_f32 v57, v57, v81
    v_add_f32 v58, v58, v82
    s_waitcnt vmcnt(8)
    v_mfma_f32_32x32x16_bf16 v[84:99], a[112:115], v[36:39], v[84:99]
    v_add_f32 v59, v59, v83
    v_add_f32 v52, v52, v60
    v_add_f32 v53, v53, v61
    v_add_f32 v54, v54, v62
    v_add_f32 v55, v55, v63
    buffer_load_dwordx4 v[132:135], v1, s[4:7], s58 offen offset:3072 sc1
    s_add_u32 s58, s58, 4096
    v_mfma_f32_32x32x16_bf16 v[100:115], a[116:119], v[36:39], v[100:115]
    v_add_f32 v56, v56, v64
    v_add_f32 v57, v57, v65
    v_add_f32 v58, v58, v66
    v_add_f32 v59, v59, v67
    v_cvt_pk_bf16_f32 v4, v52, v53
    s_waitcnt vmcnt(8)
    v_mfma_f32_32x32x16_bf16 v[84:99], a[120:123], v[40:43], v[84:99]
    v_cvt_pk_bf16_f32 v5, v54, v55
    v_cvt_pk_bf16_f32 v6, v56, v57
    v_cvt_pk_bf16_f32 v7, v58, v59
    s_cmp_eq_u32 s39, 0
    s_cbranch_scc1 Lslow_62
    buffer_store_dwordx4 v[4:7], v1, s[4:7], s54 offen
Ldual_62:
    v_mul_f32 v61, v52, v52
    buffer_load_dwordx4 v[136:139], v1, s[4:7], s58 offen offset:0 sc1
    v_mfma_f32_32x32x16_bf16 v[100:115], a[124:127], v[40:43], v[100:115]
    v_add_f32 v60, v52, v53
    v_fmac_f32 v61, v53, v53
    v_add_f32 v60, v60, v54
    v_fmac_f32 v61, v54, v54
    v_add_f32 v60, v60, v55
    s_waitcnt vmcnt(9)
    v_mfma_f32_32x32x16_bf16 v[84:99], a[128:131], v[44:47], v[84:99]
    v_fmac_f32 v61, v55, v55
    v_add_f32 v60, v60, v56
    v_fmac_f32 v61, v56, v56
    v_add_f32 v60, v60, v57
    v_fmac_f32 v61, v57, v57
    buffer_load_dwordx4 v[140:143], v1, s[4:7], s58 offen offset:1024 sc1
    v_mfma_f32_32x32x16_bf16 v[100:115], a[132:135], v[44:47], v[100:115]
    v_add_f32 v60, v60, v58
    v_fmac_f32 v61, v58, v58
    v_add_f32 v60, v60, v59
    v_fmac_f32 v61, v59, v59
    s_lshl_b32 s49, s38, 9
    s_waitcnt vmcnt(9)
    v_mfma_f32_32x32x16_bf16 v[84:99], a[136:139], v[48:51], v[84:99]
    s_add_u32 s49, s49, 156928
    v_lshl_add_u32 v62, v0, 3, s49
    ds_write_b64 v62, v[60:61]
    s_add_u32 s54, s54, 65536
    v_lshlrev_b32 v116, 16, v8
    buffer_load_dwordx4 v[128:131], v1, s[4:7], s58 offen offset:2048 sc1
    v_mfma_f32_32x32x16_bf16 v[100:115], a[140:143], v[48:51], v[100:115]
    v_and_b32 v117, 0xffff0000, v8
    v_lshlrev_b32 v118, 16, v9
    v_and_b32 v119, 0xffff0000, v9
    v_lshlrev_b32 v120, 16, v10
    v_and_b32 v121, 0xffff0000, v10
    s_waitcnt vmcnt(9)
    v_mfma_f32_32x32x16_bf16 v[84:99], a[144:147], v[124:127], v[84:99]
    v_lshlrev_b32 v122, 16, v11
    v_and_b32 v123, 0xffff0000, v11
    buffer_load_dwordx4 v[144:147], v1, s[4:7], s58 offen offset:3072 sc1
    s_add_u32 s58, s58, 4096
    v_mfma_f32_32x32x16_bf16 v[100:115], a[148:151], v[124:127], v[100:115]
    s_waitcnt vmcnt(9)
    v_mfma_f32_32x32x16_bf16 v[84:99], a[152:155], v[20:23], v[84:99]
    v_mfma_f32_32x32x16_bf16 v[100:115], a[156:159], v[20:23], v[100:115]
    s_waitcnt vmcnt(8)
    v_mfma_f32_32x32x16_bf16 v[84:99], a[160:163], v[24:27], v[84:99]
    v_mfma_f32_32x32x16_bf16 v[100:115], a[164:167], v[24:27], v[100:115]
    s_waitcnt vmcnt(7)
    v_mfma_f32_32x32x16_bf16 v[84:99], a[168:171], v[28:31], v[84:99]
    v_mfma_f32_32x32x16_bf16 v[100:115], a[172:175], v[28:31], v[100:115]
    s_waitcnt vmcnt(6)
    v_mfma_f32_32x32x16_bf16 v[84:99], a[176:179], v[32:35], v[84:99]
    v_mfma_f32_32x32x16_bf16 v[100:115], a[180:183], v[32:35], v[100:115]
    s_waitcnt vmcnt(5)
    v_mfma_f32_32x32x16_bf16 v[84:99], a[184:187], v[132:135], v[84:99]
    v_mfma_f32_32x32x16_bf16 v[100:115], a[188:191], v[132:135], v[100:115]
    s_waitcnt vmcnt(3)
    v_mfma_f32_32x32x16_bf16 v[84:99], a[192:195], v[136:139], v[84:99]
    v_mfma_f32_32x32x16_bf16 v[100:115], a[196:199], v[136:139], v[100:115]
    s_cmp_eq_u32 s39, 0
    s_cbranch_scc1 Lslow_63
    buffer_store_dword v17, v19, s[4:7], s56 offen offset:0
Ldual_63:
    s_waitcnt vmcnt(3)
    v_mfma_f32_32x32x16_bf16 v[84:99], a[200:203], v[140:143], v[84:99]
    v_mfma_f32_32x32x16_bf16 v[100:115], a[204:207], v[140:143], v[100:115]
    s_waitcnt vmcnt(2)
    v_mfma_f32_32x32x16_bf16 v[84:99], a[208:211], v[128:131], v[84:99]
    v_mfma_f32_32x32x16_bf16 v[100:115], a[212:215], v[128:131], v[100:115]
    s_waitcnt vmcnt(1)
    v_mfma_f32_32x32x16_bf16 v[84:99], a[216:219], v[144:147], v[84:99]
    v_mfma_f32_32x32x16_bf16 v[100:115], a[220:223], v[144:147], v[100:115]
    s_nop 10
    ds_write_b128 v12, v[92:95] offset:0
    ds_write_b128 v12, v[96:99] offset:1024
    ds_write_b128 v13, v[100:103] offset:0
    ds_write_b128 v13, v[104:107] offset:1024
    ds_write_b128 v14, v[108:111] offset:0
    ds_write_b128 v14, v[112:115] offset:1024
    v_pk_add_f32 v[84:85], v[84:85], v[116:117]
    v_pk_add_f32 v[86:87], v[86:87], v[118:119]
    v_pk_add_f32 v[88:89], v[88:89], v[120:121]
    v_pk_add_f32 v[90:91], v[90:91], v[122:123]
    s_waitcnt lgkmcnt(0)
    s_barrier
    ds_read_b128 v[92:95], v15 offset:0
    ds_read_b128 v[96:99], v15 offset:1024
    ds_read_b128 v[100:103], v15 offset:2048
    ds_read_b128 v[104:107], v15 offset:3072
    ds_read_b128 v[108:111], v15 offset:4096
    ds_read_b128 v[112:115], v15 offset:5120
    s_waitcnt lgkmcnt(3)
    v_pk_add_f32 v[92:93], v[92:93], v[100:101]
    v_pk_add_f32 v[94:95], v[94:95], v[102:103]
    s_waitcnt lgkmcnt(2)
    v_pk_add_f32 v[96:97], v[96:97], v[104:105]
    v_pk_add_f32 v[98:99], v[98:99], v[106:107]
    s_waitcnt lgkmcnt(1)
    v_pk_add_f32 v[84:85], v[84:85], v[108:109]
    v_pk_add_f32 v[86:87], v[86:87], v[110:111]
    s_waitcnt lgkmcnt(0)
    v_pk_add_f32 v[88:89], v[88:89], v[112:113]
    v_pk_add_f32 v[90:91], v[90:91], v[114:115]
    v_pk_add_f32 v[84:85], v[84:85], v[92:93]
    v_pk_add_f32 v[86:87], v[86:87], v[94:95]
    v_pk_add_f32 v[88:89], v[88:89], v[96:97]
    v_pk_add_f32 v[90:91], v[90:91], v[98:99]
    v_cvt_pk_bf16_f32 v8, v84, v85
    v_cvt_pk_bf16_f32 v9, v86, v87
    v_cvt_pk_bf16_f32 v10, v88, v89
    v_cvt_pk_bf16_f32 v11, v90, v91
    s_cmp_eq_u32 s39, 0
    s_cbranch_scc1 Lslow_64
    buffer_store_dwordx4 v[8:11], v1, s[4:7], s54 offen
Ldual_64:
    v_pk_mul_f32 v[94:95], v[84:85], v[84:85]
    v_pk_add_f32 v[92:93], v[84:85], v[86:87]
    v_pk_fma_f32 v[94:95], v[86:87], v[86:87], v[94:95]
    v_pk_fma_f32 v[94:95], v[88:89], v[88:89], v[94:95]
    v_pk_fma_f32 v[94:95], v[90:91], v[90:91], v[94:95]
    v_pk_add_f32 v[92:93], v[92:93], v[88:89]
    v_pk_add_f32 v[92:93], v[92:93], v[90:91]
    v_add_f32 v92, v92, v93
    v_add_f32 v93, v94, v95
    s_lshl_b32 s49, s38, 9
    s_add_u32 s49, s49, 158976
    v_lshl_add_u32 v94, v0, 3, s49
    ds_write_b64 v94, v[92:93]
    s_waitcnt lgkmcnt(0)
    s_barrier
    s_and_b32 s49, s38, 1
    s_lshl_b32 s48, s49, 11
    s_add_u32 s48, s48, 156928
    v_lshl_add_u32 v60, v0, 3, s48
    ds_read2st64_b64 v[52:55], v60 offset0:0 offset1:1
    ds_read2st64_b64 v[56:59], v60 offset0:2 offset1:3
    s_lshl1_add_u32 s48, s36, s49
    s_lshl1_add_u32 s48, s48, s40
    s_lshl3_add_u32 s48, s48, s41
    s_lshl_b32 s48, s48, 8
    s_add_u32 s48, s48, 393216
    s_cmp_lt_u32 s38, 2
    s_cselect_b32 s48, s48, 0x70000000
    v_and_b32 v61, 31, v0
    v_lshlrev_b32 v61, 3, v61
    s_waitcnt lgkmcnt(1)
    v_pk_add_f32 v[52:53], v[52:53], v[54:55]
    s_waitcnt lgkmcnt(0)
    v_pk_add_f32 v[56:57], v[56:57], v[58:59]
    v_pk_add_f32 v[52:53], v[52:53], v[56:57]
    v_mov_b32 v54, v52
    v_mov_b32 v55, v53
    s_nop 0
    v_permlane32_swap_b32 v54, v52
    v_permlane32_swap_b32 v55, v53
    v_pk_add_f32 v[52:53], v[52:53], v[54:55]
    s_cmp_eq_u32 s39, 0
    s_cbranch_scc1 Lslow_65
    buffer_store_dwordx2 v[52:53], v61, s[4:7], s48 offen
Ldual_65:
    s_waitcnt vmcnt(1)
    s_cmp_eq_u32 s39, 0
    s_cbranch_scc1 Lslow_66
    buffer_store_dword v17, v19, s[4:7], s56 offen offset:256
Ldual_66:
    v_mov_b32 v156, 2
    v_mov_b32 v157, 0
    v_and_b32 v17, 31, v0
    v_lshlrev_b32 v17, 2, v17
    s_lshl_b32 s42, s38, 7
    s_add_u32 s42, s42, s50
    s_add_u32 s42, s42, 768
    buffer_load_dword v18, v17, s[4:7], s42 offen sc1
    s_lshl_b32 s54, s52, 15
    s_add_u32 s54, s54, 4194304
    s_lshl_b32 s55, s1, 12
    v_add_u32 v16, 49152, v1
    ds_read_b128 v[136:139], v1 offset:1024
    ds_read_b128 v[140:143], v1 offset:2048
    ds_read_b128 v[132:135], v1 offset:0
    s_waitcnt vmcnt(0)
    v_cmp_gt_u32 vcc, 1, v18
    s_cbranch_vccnz Lspin_27
Lback_28:
    s_xor_b32 s56, s55, 0
    s_add_u32 s56, s56, s54
    buffer_load_dwordx4 v[20:23], v1, s[4:7], s56 offen offset:0 sc1
    buffer_load_dwordx4 v[24:27], v1, s[4:7], s56 offen offset:1024 sc1
    buffer_load_dwordx4 v[28:31], v1, s[4:7], s56 offen offset:2048 sc1
    buffer_load_dwordx4 v[32:35], v1, s[4:7], s56 offen offset:3072 sc1
    s_xor_b32 s56, s55, 4096
    s_add_u32 s56, s56, s54
    buffer_load_dwordx4 v[36:39], v1, s[4:7], s56 offen offset:0 sc1
    buffer_load_dwordx4 v[40:43], v1, s[4:7], s56 offen offset:1024 sc1
    s_cmp_eq_u32 s39, 0
    s_cbranch_scc1 Lslow_67
    buffer_store_dword v156, v157, s[4:7], s3 offen offset:2432
Ldual_67:
    s_waitcnt vmcnt(6) lgkmcnt(2)
    v_mfma_f32_32x32x16_bf16 v[100:115], v[136:139], v[20:23], 0
    ds_read_b128 v[148:151], v1 offset:4096
    buffer_load_dwordx4 v[44:47], v1, s[4:7], s56 offen offset:2048 sc1
    s_waitcnt lgkmcnt(2)
    v_mfma_f32_32x32x16_bf16 v[116:131], v[20:23], v[140:143], 0
    ds_read_b128 v[152:155], v1 offset:5120
    s_waitcnt lgkmcnt(2)
    v_mfma_f32_32x32x16_bf16 v[84:99], v[132:135], v[20:23], 0
    ds_read_b128 v[144:147], v1 offset:3072
    buffer_load_dwordx4 v[48:51], v1, s[4:7], s56 offen offset:3072 sc1
    s_waitcnt vmcnt(7) lgkmcnt(2)
    v_mfma_f32_32x32x16_bf16 v[100:115], v[148:151], v[24:27], v[100:115]
    ds_read_b128 v[136:139], v1 offset:7168
    s_xor_b32 s56, s55, 8192
    s_add_u32 s56, s56, s54
    buffer_load_dwordx4 v[52:55], v1, s[4:7], s56 offen offset:0 sc1
    s_waitcnt lgkmcnt(2)
    v_mfma_f32_32x32x16_bf16 v[116:131], v[24:27], v[152:155], v[116:131]
    ds_read_b128 v[140:143], v1 offset:8192
    s_waitcnt lgkmcnt(2)
    v_mfma_f32_32x32x16_bf16 v[84:99], v[144:147], v[24:27], v[84:99]
    ds_read_b128 v[132:135], v1 offset:6144
    buffer_load_dwordx4 v[56:59], v1, s[4:7], s56 offen offset:1024 sc1
    s_waitcnt vmcnt(8) lgkmcnt(2)
    v_mfma_f32_32x32x16_bf16 v[100:115], v[136:139], v[28:31], v[100:115]
    ds_read_b128 v[148:151], v1 offset:10240
    buffer_load_dwordx4 v[60:63], v1, s[4:7], s56 offen offset:2048 sc1
    s_waitcnt lgkmcnt(2)
    v_mfma_f32_32x32x16_bf16 v[116:131], v[28:31], v[140:143], v[116:131]
    ds_read_b128 v[152:155], v1 offset:11264
    s_waitcnt lgkmcnt(2)
    v_mfma_f32_32x32x16_bf16 v[84:99], v[132:135], v[28:31], v[84:99]
    ds_read_b128 v[144:147], v1 offset:9216
    buffer_load_dwordx4 v[64:67], v1, s[4:7], s56 offen offset:3072 sc1
    s_waitcnt vmcnt(9) lgkmcnt(2)
    v_mfma_f32_32x32x16_bf16 v[100:115], v[148:151], v[32:35], v[100:115]
    ds_read_b128 v[136:139], v1 offset:13312
    s_xor_b32 s56, s55, 12288
    s_add_u32 s56, s56, s54
    buffer_load_dwordx4 v[68:71], v1, s[4:7], s56 offen offset:0 sc1
    s_lshl_b32 s43, s37, 7
    s_lshl2_add_u32 s43, s38, s43
    s_add_u32 s43, s43, s50
    s_waitcnt lgkmcnt(2)
    v_mfma_f32_32x32x16_bf16 v[116:131], v[32:35], v[152:155], v[116:131]
    ds_read_b128 v[140:143], v1 offset:14336
    s_add_u32 s43, s43, 6160
    s_waitcnt lgkmcnt(2)
    v_mfma_f32_32x32x16_bf16 v[84:99], v[144:147], v[32:35], v[84:99]
    ds_read_b128 v[132:135], v1 offset:12288
    buffer_load_dwordx4 v[72:75], v1, s[4:7], s56 offen offset:1024 sc1
    s_waitcnt vmcnt(10) lgkmcnt(2)
    v_mfma_f32_32x32x16_bf16 v[100:115], v[136:139], v[36:39], v[100:115]
    ds_read_b128 v[148:151], v1 offset:16384
    buffer_load_dwordx4 v[76:79], v1, s[4:7], s56 offen offset:2048 sc1
    s_waitcnt lgkmcnt(2)
    v_mfma_f32_32x32x16_bf16 v[116:131], v[36:39], v[140:143], v[116:131]
    ds_read_b128 v[152:155], v1 offset:17408
    s_waitcnt lgkmcnt(2)
    v_mfma_f32_32x32x16_bf16 v[84:99], v[132:135], v[36:39], v[84:99]
    ds_read_b128 v[144:147], v1 offset:15360
    buffer_load_dwordx4 v[80:83], v1, s[4:7], s56 offen offset:3072 sc1
    s_waitcnt vmcnt(11) lgkmcnt(2)
    v_mfma_f32_32x32x16_bf16 v[100:115], v[148:151], v[40:43], v[100:115]
    ds_read_b128 v[136:139], v1 offset:19456
    s_xor_b32 s56, s55, 16384
    s_add_u32 s56, s56, s54
    buffer_load_dwordx4 v[20:23], v1, s[4:7], s56 offen offset:0 sc1
    s_waitcnt lgkmcnt(2)
    v_mfma_f32_32x32x16_bf16 v[116:131], v[40:43], v[152:155], v[116:131]
    ds_read_b128 v[140:143], v1 offset:20480
    s_waitcnt lgkmcnt(2)
    v_mfma_f32_32x32x16_bf16 v[84:99], v[144:147], v[40:43], v[84:99]
    ds_read_b128 v[132:135], v1 offset:18432
    buffer_load_dwordx4 v[24:27], v1, s[4:7], s56 offen offset:1024 sc1
    s_waitcnt vmcnt(11) lgkmcnt(2)
    v_mfma_f32_32x32x16_bf16 v[100:115], v[136:139], v[44:47], v[100:115]
    ds_read_b128 v[148:151], v1 offset:22528
    buffer_load_dwordx4 v[28:31], v1, s[4:7], s56 offen offset:2048 sc1
    s_waitcnt lgkmcnt(2)
    v_mfma_f32_32x32x16_bf16 v[116:131], v[44:47], v[140:143], v[116:131]
    ds_read_b128 v[152:155], v1 offset:23552
    s_waitcnt lgkmcnt(2)
    v_mfma_f32_32x32x16_bf16 v[84:99], v[132:135], v[44:47], v[84:99]
    ds_read_b128 v[144:147], v1 offset:21504
    buffer_load_dwordx4 v[32:35], v1, s[4:7], s56 offen offset:3072 sc1
    s_waitcnt vmcnt(12) lgkmcnt(2)
    v_mfma_f32_32x32x16_bf16 v[100:115], v[148:151], v[48:51], v[100:115]
    ds_read_b128 v[136:139], v1 offset:25600
    s_xor_b32 s56, s55, 20480
    s_add_u32 s56, s56, s54
    buffer_load_dwordx4 v[36:39], v1, s[4:7], s56 offen offset:0 sc1
    s_waitcnt lgkmcnt(2)
    v_mfma_f32_32x32x16_bf16 v[116:131], v[48:51], v[152:155], v[116:131]
    ds_read_b128 v[140:143], v1 offset:26624
    s_waitcnt lgkmcnt(2)
    v_mfma_f32_32x32x16_bf16 v[84:99], v[144:147], v[48:51], v[84:99]
    ds_read_b128 v[132:135], v1 offset:24576
    buffer_load_dwordx4 v[40:43], v1, s[4:7], s56 offen offset:1024 sc1
    s_waitcnt vmcnt(13) lgkmcnt(2)
    v_mfma_f32_32x32x16_bf16 v[100:115], v[136:139], v[52:55], v[100:115]
    ds_read_b128 v[148:151], v1 offset:28672
    buffer_load_dwordx4 v[44:47], v1, s[4:7], s56 offen offset:2048 sc1
    s_waitcnt lgkmcnt(2)
    v_mfma_f32_32x32x16_bf16 v[116:131], v[52:55], v[140:143], v[116:131]
    ds_read_b128 v[152:155], v1 offset:29696
    s_waitcnt lgkmcnt(2)
    v_mfma_f32_32x32x16_bf16 v[84:99], v[132:135], v[52:55], v[84:99]
    ds_read_b128 v[144:147], v1 offset:27648
    buffer_load_dwordx4 v[48:51], v1, s[4:7], s56 offen offset:3072 sc1
    s_waitcnt vmcnt(14) lgkmcnt(2)
    v_mfma_f32_32x32x16_bf16 v[100:115], v[148:151], v[56:59], v[100:115]
    ds_read_b128 v[136:139], v1 offset:31744
    s_xor_b32 s56, s55, 24576
    s_add_u32 s56, s56, s54
    buffer_load_dwordx4 v[52:55], v1, s[4:7], s56 offen offset:0 sc1
    s_waitcnt lgkmcnt(2)
    v_mfma_f32_32x32x16_bf16 v[116:131], v[56:59], v[152:155], v[116:131]
    ds_read_b128 v[140:143], v1 offset:32768
    s_waitcnt lgkmcnt(2)
    v_mfma_f32_32x32x16_bf16 v[84:99], v[144:147], v[56:59], v[84:99]
    ds_read_b128 v[132:135], v1 offset:30720
    buffer_load_dwordx4 v[56:59], v1, s[4:7], s56 offen offset:1024 sc1
    s_waitcnt vmcnt(15) lgkmcnt(2)
    v_mfma_f32_32x32x16_bf16 v[100:115], v[136:139], v[60:63], v[100:115]
    ds_read_b128 v[148:151], v1 offset:34816
    s_waitcnt lgkmcnt(2)
    v_mfma_f32_32x32x16_bf16 v[116:131], v[60:63], v[140:143], v[116:131]
    ds_read_b128 v[152:155], v1 offset:35840
    s_waitcnt lgkmcnt(2)
    v_mfma_f32_32x32x16_bf16 v[84:99], v[132:135], v[60:63], v[84:99]
    ds_read_b128 v[144:147], v1 offset:33792
    buffer_load_dwordx4 v[60:63], v1, s[4:7], s56 offen offset:2048 sc1
    s_waitcnt vmcnt(15) lgkmcnt(2)
    v_mfma_f32_32x32x16_bf16 v[100:115], v[148:151], v[64:67], v[100:115]
    ds_read_b128 v[136:139], v1 offset:37888
    v_and_b32 v17, 7, v0
    v_lshlrev_b32 v17, 2, v17
    s_lshl_b32 s96, s38, 5
    s_add_u32 s96, s96, s50
    s_waitcnt lgkmcnt(2)
    v_mfma_f32_32x32x16_bf16 v[116:131], v[64:67], v[152:155], v[116:131]
    ds_read_b128 v[140:143], v1 offset:38912
    s_add_u32 s96, s96, 2432
    buffer_load_dword v18, v17, s[4:7], s96 offen sc1
    v_lshrrev_b32 v19, 5, v0
    v_lshlrev_b32 v19, 10, v19
    s_waitcnt lgkmcnt(2)
    v_mfma_f32_32x32x16_bf16 v[84:99], v[144:147], v[64:67], v[84:99]
    ds_read_b128 v[132:135], v1 offset:36864
    buffer_load_dwordx4 v[64:67], v1, s[4:7], s56 offen offset:3072 sc1
    v_and_b32 v14, 31, v0
    v_lshl_add_u32 v19, v14, 3, v19
    s_lshl_b32 s59, s52, 11
    s_waitcnt vmcnt(16) lgkmcnt(2)
    v_mfma_f32_32x32x16_bf16 v[100:115], v[136:139], v[68:71], v[100:115]
    ds_read_b128 v[148:151], v1 offset:40960
    s_add_u32 s59, s59, 393216
    s_waitcnt lgkmcnt(2)
    v_mfma_f32_32x32x16_bf16 v[116:131], v[68:71], v[140:143], v[116:131]
    ds_read_b128 v[152:155], v1 offset:41984
    s_waitcnt lgkmcnt(2)
    v_mfma_f32_32x32x16_bf16 v[84:99], v[132:135], v[68:71], v[84:99]
    ds_read_b128 v[144:147], v1 offset:39936
    s_xor_b32 s56, s55, 28672
    s_add_u32 s56, s56, s54
    buffer_load_dwordx4 v[68:71], v1, s[4:7], s56 offen offset:0 sc1
    s_waitcnt vmcnt(16) lgkmcnt(2)
    v_mfma_f32_32x32x16_bf16 v[100:115], v[148:151], v[72:75], v[100:115]
    ds_read_b128 v[136:139], v1 offset:44032
    s_waitcnt lgkmcnt(2)
    v_mfma_f32_32x32x16_bf16 v[116:131], v[72:75], v[152:155], v[116:131]
    ds_read_b128 v[140:143], v1 offset:45056
    s_waitcnt lgkmcnt(2)
    v_mfma_f32_32x32x16_bf16 v[84:99], v[144:147], v[72:75], v[84:99]
    ds_read_b128 v[132:135], v1 offset:43008
    buffer_load_dwordx4 v[72:75], v1, s[4:7], s56 offen offset:1024 sc1
    s_waitcnt vmcnt(16) lgkmcnt(2)
    v_mfma_f32_32x32x16_bf16 v[100:115], v[136:139], v[76:79], v[100:115]
    ds_read_b128 v[148:151], v1 offset:47104
    s_waitcnt lgkmcnt(2)
    v_mfma_f32_32x32x16_bf16 v[116:131], v[76:79], v[140:143], v[116:131]
    ds_read_b128 v[152:155], v1 offset:48128
    s_waitcnt lgkmcnt(2)
    v_mfma_f32_32x32x16_bf16 v[84:99], v[132:135], v[76:79], v[84:99]
    ds_read_b128 v[144:147], v1 offset:46080
    buffer_load_dwordx4 v[76:79], v1, s[4:7], s56 offen offset:2048 sc1
    s_waitcnt vmcnt(16) lgkmcnt(2)
    v_mfma_f32_32x32x16_bf16 v[100:115], v[148:151], v[80:83], v[100:115]
    ds_read_b128 v[136:139], v16 offset:1024
    s_waitcnt lgkmcnt(2)
    v_mfma_f32_32x32x16_bf16 v[116:131], v[80:83], v[152:155], v[116:131]
    ds_read_b128 v[140:143], v16 offset:2048
    s_waitcnt lgkmcnt(2)
    v_mfma_f32_32x32x16_bf16 v[84:99], v[144:147], v[80:83], v[84:99]
    buffer_load_dwordx4 v[80:83], v1, s[4:7], s56 offen offset:3072 sc1
    s_waitcnt vmcnt(16) lgkmcnt(1)
    v_mfma_f32_32x32x16_bf16 v[100:115], v[136:139], v[20:23], v[100:115]
    ds_read_b128 v[148:151], v16 offset:4096
    s_waitcnt vmcnt(5)
    v_cmp_gt_u32 vcc, 2, v18
    s_cbranch_vccnz Lspin_29
Lback_30:
    buffer_load_dwordx2 v[132:133], v19, s[4:7], s59 offen offset:0 sc1
    buffer_load_dwordx2 v[134:135], v19, s[4:7], s59 offen offset:256 sc1
    buffer_load_dwordx2 v[144:145], v19, s[4:7], s59 offen offset:512 sc1
    s_waitcnt lgkmcnt(1)
    v_mfma_f32_32x32x16_bf16 v[116:131], v[20:23], v[140:143], v[116:131]
    ds_read_b128 v[152:155], v16 offset:5120
    buffer_load_dwordx2 v[146:147], v19, s[4:7], s59 offen offset:768 sc1
    s_waitcnt lgkmcnt(1)
    v_mfma_f32_32x32x16_bf16 v[100:115], v[148:151], v[24:27], v[100:115]
    ds_read_b128 v[136:139], v16 offset:7168
    buffer_store_dword v156, v157, s[4:7], s43 offen offset:0 sc1
    s_waitcnt lgkmcnt(1)
    v_mfma_f32_32x32x16_bf16 v[116:131], v[24:27], v[152:155], v[116:131]
    ds_read_b128 v[140:143], v16 offset:8192
    s_waitcnt lgkmcnt(1)
    v_mfma_f32_32x32x16_bf16 v[100:115], v[136:139], v[28:31], v[100:115]
    ds_read_b128 v[148:151], v16 offset:10240
    s_waitcnt lgkmcnt(1)
    v_mfma_f32_32x32x16_bf16 v[116:131], v[28:31], v[140:143], v[116:131]
    ds_read_b128 v[152:155], v16 offset:11264
    s_waitcnt lgkmcnt(1)
    v_mfma_f32_32x32x16_bf16 v[100:115], v[148:151], v[32:35], v[100:115]
    ds_read_b128 v[136:139], v16 offset:13312
    s_waitcnt lgkmcnt(1)
    v_mfma_f32_32x32x16_bf16 v[116:131], v[32:35], v[152:155], v[116:131]
    ds_read_b128 v[140:143], v16 offset:14336
    s_waitcnt lgkmcnt(1)
    v_mfma_f32_32x32x16_bf16 v[100:115], v[136:139], v[36:39], v[100:115]
    ds_read_b128 v[148:151], v16 offset:16384
    s_waitcnt lgkmcnt(1)
    v_mfma_f32_32x32x16_bf16 v[116:131], v[36:39], v[140:143], v[116:131]
    ds_read_b128 v[152:155], v16 offset:17408
    s_waitcnt lgkmcnt(1)
    v_mfma_f32_32x32x16_bf16 v[100:115], v[148:151], v[40:43], v[100:115]
    ds_read_b128 v[136:139], v16 offset:19456
    s_waitcnt vmcnt(2)
    v_add_f32 v132, v132, v144
    v_add_f32 v133, v133, v145
    s_waitcnt vmcnt(1)
    v_add_f32 v134, v134, v146
    v_add_f32 v135, v135, v147
    s_waitcnt lgkmcnt(1)
    v_mfma_f32_32x32x16_bf16 v[116:131], v[40:43], v[152:155], v[116:131]
    ds_read_b128 v[140:143], v16 offset:20480
    v_add_f32 v14, v132, v134
    v_add_f32 v15, v133, v135
    v_mov_b32 v17, v14
    v_mov_b32 v18, v15
    s_waitcnt lgkmcnt(1)
    v_mfma_f32_32x32x16_bf16 v[100:115], v[136:139], v[44:47], v[100:115]
    ds_read_b128 v[148:151], v16 offset:22528
    v_permlane32_swap_b32 v17, v14
    v_permlane32_swap_b32 v18, v15
    v_add_f32 v14, v14, v17
    v_add_f32 v15, v15, v18
    s_waitcnt lgkmcnt(1)
    v_mfma_f32_32x32x16_bf16 v[116:131], v[44:47], v[140:143], v[116:131]
    ds_read_b128 v[152:155], v16 offset:23552
    v_mul_f32 v12, 0xbb000000, v14
    v_mul_f32 v17, 0x3b000000, v15
    v_fma_f32 v17, -v12, v12, v17
    v_max_f32 v17, 0, v17
    s_waitcnt lgkmcnt(1)
    v_mfma_f32_32x32x16_bf16 v[100:115], v[148:151], v[48:51], v[100:115]
    ds_read_b128 v[136:139], v16 offset:25600
    v_add_f32 v17, 0x3727c5ac, v17
    v_rsq_f32 v13, v17
    v_cvt_pk_bf16_f32 v17, v12, v12
    s_waitcnt lgkmcnt(1)
    v_mfma_f32_32x32x16_bf16 v[116:131], v[48:51], v[152:155], v[116:131]
    ds_read_b128 v[140:143], v16 offset:26624
    v_and_b32 v17, 0xffff0000, v17
    v_sub_f32 v17, v12, v17
    v_cvt_pk_bf16_f32 v156, v12, v17
    v_mov_b32 v157, 0
    s_waitcnt lgkmcnt(1)
    v_mfma_f32_32x32x16_bf16 v[100:115], v[136:139], v[52:55], v[100:115]
    ds_read_b128 v[148:151], v16 offset:28672
    v_mov_b32 v158, 0
    v_mov_b32 v159, 0
    s_lshl_b32 s42, s38, 8
    s_add_u32 s42, s42, 149760
    s_waitcnt lgkmcnt(1)
    v_mfma_f32_32x32x16_bf16 v[116:131], v[52:55], v[140:143], v[116:131]
    ds_read_b128 v[152:155], v16 offset:29696
    v_and_b32 v17, 31, v0
    v_lshl_add_u32 v17, v17, 2, s42
    ds_write_b32 v17, v13
    v_lshrrev_b32 v18, 5, v0
    s_waitcnt lgkmcnt(2)
    v_mfma_f32_32x32x16_bf16 v[100:115], v[148:151], v[56:59], v[100:115]
    ds_read_b128 v[136:139], v16 offset:31744
    v_lshl_add_u32 v18, v18, 4, s42
    v_lshlrev_b32 v17, 2, v0
    v_add_u32 v17, 147712, v17
    s_waitcnt lgkmcnt(2)
    v_mfma_f32_32x32x16_bf16 v[116:131], v[56:59], v[152:155], v[116:131]
    ds_read_b128 v[140:143], v16 offset:32768
    s_waitcnt lgkmcnt(1)
    v_mfma_f32_32x32x16_bf16 v[100:115], v[136:139], v[60:63], v[100:115]
    ds_read_b128 v[148:151], v16 offset:34816
    s_waitcnt lgkmcnt(1)
    v_mfma_f32_32x32x16_bf16 v[116:131], v[60:63], v[140:143], v[116:131]
    ds_read_b128 v[152:155], v16 offset:35840
    s_waitcnt lgkmcnt(1)
    v_mfma_f32_32x32x16_bf16 v[100:115], v[148:151], v[64:67], v[100:115]
    ds_read_b128 v[136:139], v16 offset:37888
    s_waitcnt lgkmcnt(1)
    v_mfma_f32_32x32x16_bf16 v[116:131], v[64:67], v[152:155], v[116:131]
    ds_read_b128 v[140:143], v16 offset:38912
    v_mov_b32 v133, 0
    v_mov_b32 v145, 0
    v_mov_b32 v134, 0
    v_mov_b32 v146, 0
    v_mov_b32 v135, 0
    v_mov_b32 v147, 0
    ds_read_b32 v132, v17 offset:256
    ds_read_b32 v144, v17 offset:512
    ds_read_b32 v146, v17
    s_waitcnt lgkmcnt(4)
    v_mfma_f32_32x32x16_bf16 v[100:115], v[136:139], v[68:71], v[100:115]
    ds_read_b128 v[148:151], v16 offset:40960
    s_waitcnt lgkmcnt(4)
    v_mfma_f32_32x32x16_bf16 v[116:131], v[68:71], v[140:143], v[116:131]
    ds_read_b128 v[152:155], v16 offset:41984
    s_waitcnt lgkmcnt(1)
    v_mfma_f32_32x32x16_bf16 v[100:115], v[148:151], v[72:75], v[100:115]
    ds_read_b128 v[136:139], v16 offset:44032
    s_lshl_b32 s57, s37, 6
    s_add_u32 s57, s57, s52
    s_lshl_b32 s57, s57, 12
    s_add_u32 s57, s57, 20971520
    s_waitcnt lgkmcnt(1)
    v_mfma_f32_32x32x16_bf16 v[116:131], v[72:75], v[152:155], v[116:131]
    ds_read_b128 v[140:143], v16 offset:45056
    s_add_u32 s42, s38, 4
    s_mul_i32 s42, s42, 4112
    s_add_u32 s42, s42, 98304
    v_add_u32 v19, s42, v1
    v_mfma_f32_32x32x16_bf16 v[100:115], v[132:135], v[156:159], v[100:115]
    s_waitcnt lgkmcnt(1)
    v_mfma_f32_32x32x16_bf16 v[100:115], v[136:139], v[76:79], v[100:115]
    ds_read_b128 v[148:151], v16 offset:47104
    s_waitcnt lgkmcnt(1)
    v_mfma_f32_32x32x16_bf16 v[116:131], v[76:79], v[140:143], v[116:131]
    ds_read_b128 v[152:155], v16 offset:48128
    v_mfma_f32_32x32x16_bf16 v[116:131], v[156:159], v[144:147], v[116:131]
    s_waitcnt lgkmcnt(1)
    v_mfma_f32_32x32x16_bf16 v[84:99], v[146:149], v[156:159], v[84:99]
    v_mfma_f32_32x32x16_bf16 v[100:115], v[148:151], v[80:83], v[100:115]
    ds_read_b128 v[132:135], v16 offset:0
    s_waitcnt lgkmcnt(1)
    v_mfma_f32_32x32x16_bf16 v[116:131], v[80:83], v[152:155], v[116:131]
    ds_read_b128 v[144:147], v16 offset:3072
    s_waitcnt lgkmcnt(1)
    v_mfma_f32_32x32x16_bf16 v[84:99], v[132:135], v[20:23], v[84:99]
    ds_read_b128 v[136:139], v18 offset:0
    ds_read_b128 v[140:143], v18 offset:32
    ds_read_b128 v[148:151], v18 offset:64
    ds_read_b128 v[152:155], v18 offset:96
    v_min_u32 v158, 2, v0
    v_min_u32 v158, s36, v158
    v_lshlrev_b32 v158, 13, v158
    v_sub_u32 v158, s43, v158
    buffer_load_dword v159, v158, s[4:7], 0 offen sc1
    v_mul_f32 v100, v100, v13
    v_mul_f32 v101, v101, v13
    v_mul_f32 v102, v102, v13
    v_mul_f32 v103, v103, v13
    v_mul_f32 v104, v104, v13
    ds_read_b128 v[132:135], v16 offset:6144
    s_waitcnt lgkmcnt(5)
    v_mfma_f32_32x32x16_bf16 v[84:99], v[144:147], v[24:27], v[84:99]
    v_mul_f32 v105, v105, v13
    v_mul_f32 v106, v106, v13
    v_mul_f32 v107, v107, v13
    v_cvt_pk_bf16_f32 v100, v100, v101
    v_cvt_pk_bf16_f32 v101, v102, v103
    v_cvt_pk_bf16_f32 v102, v104, v105
    v_cvt_pk_bf16_f32 v103, v106, v107
    buffer_store_dwordx4 v[100:103], v1, s[4:7], s57 offen offset:0 sc1
    v_mul_f32 v108, v108, v13
    v_mul_f32 v109, v109, v13
    v_mul_f32 v110, v110, v13
    v_mul_f32 v111, v111, v13
    v_mul_f32 v112, v112, v13
    v_mul_f32 v113, v113, v13
    ds_read_b128 v[144:147], v16 offset:9216
    s_waitcnt lgkmcnt(1)
    v_mfma_f32_32x32x16_bf16 v[84:99], v[132:135], v[28:31], v[84:99]
    v_mul_f32 v114, v114, v13
    v_mul_f32 v115, v115, v13
    v_cvt_pk_bf16_f32 v104, v108, v109
    v_cvt_pk_bf16_f32 v105, v110, v111
    v_cvt_pk_bf16_f32 v106, v112, v113
    v_cvt_pk_bf16_f32 v107, v114, v115
    buffer_store_dwordx4 v[104:107], v1, s[4:7], s57 offen offset:1024 sc1
    v_mul_f32 v116, v116, v136
    v_mul_f32 v117, v117, v137
    v_mul_f32 v118, v118, v138
    v_mul_f32 v119, v119, v139
    v_mul_f32 v120, v120, v140
    v_mul_f32 v121, v121, v141
    v_mul_f32 v122, v122, v142
    ds_read_b128 v[132:135], v16 offset:12288
    s_waitcnt lgkmcnt(1)
    v_mfma_f32_32x32x16_bf16 v[84:99], v[144:147], v[32:35], v[84:99]
    v_mul_f32 v123, v123, v143
    v_cvt_pk_bf16_f32 v116, v116, v117
    v_cvt_pk_bf16_f32 v117, v118, v119
    v_cvt_pk_bf16_f32 v118, v120, v121
    v_cvt_pk_bf16_f32 v119, v122, v123
    buffer_store_dwordx4 v[116:119], v1, s[4:7], s57 offen offset:2048 sc1
    v_mul_f32 v124, v124, v148
    v_mul_f32 v125, v125, v149
    v_mul_f32 v126, v126, v150
    v_mul_f32 v127, v127, v151
    v_mul_f32 v128, v128, v152
    v_mul_f32 v129, v129, v153
    v_mul_f32 v130, v130, v154
    v_mul_f32 v131, v131, v155
    ds_read_b128 v[144:147], v16 offset:15360
    s_waitcnt lgkmcnt(1)
    v_mfma_f32_32x32x16_bf16 v[84:99], v[132:135], v[36:39], v[84:99]
    v_cvt_pk_bf16_f32 v120, v124, v125
    v_cvt_pk_bf16_f32 v121, v126, v127
    v_cvt_pk_bf16_f32 v122, v128, v129
    v_cvt_pk_bf16_f32 v123, v130, v131
    buffer_store_dwordx4 v[120:123], v1, s[4:7], s57 offen offset:3072 sc1
    ds_write_b128 v19, v[100:103] offset:0
    ds_write_b128 v19, v[104:107] offset:1024
    ds_write_b128 v19, v[116:119] offset:2048
    ds_write_b128 v19, v[120:123] offset:3072
    v_min_u32 v17, 11, v0
    ds_read_b128 v[132:135], v16 offset:18432
    s_waitcnt lgkmcnt(5)
    v_mfma_f32_32x32x16_bf16 v[84:99], v[144:147], v[40:43], v[84:99]
    v_lshrrev_b32 v15, 1, v17
    v_and_b32 v15, 6, v15
    v_bfe_u32 v15, 18, v15, 2
    v_mov_b32 v108, 0x3f803f80
    v_cmp_ge_u32 vcc, s36, v15
    ds_read_b128 v[144:147], v16 offset:21504
    s_waitcnt lgkmcnt(1)
    v_mfma_f32_32x32x16_bf16 v[84:99], v[132:135], v[44:47], v[84:99]
    v_mul_u32_u24 v17, 4112, v17
    v_add_u32 v17, 102400, v17
    v_cndmask_b32 v108, 0, v108, vcc
    v_mov_b32 v109, v108
    v_mov_b32 v110, v108
    ds_read_b128 v[132:135], v16 offset:24576
    s_waitcnt lgkmcnt(1)
    v_mfma_f32_32x32x16_bf16 v[84:99], v[144:147], v[48:51], v[84:99]
    v_mov_b32 v111, v108
    ds_write_b128 v17, v[108:111]
    s_lshl_b32 s42, s37, 7
    s_lshl2_add_u32 s42, s38, s42
    ds_read_b128 v[144:147], v16 offset:27648
    s_waitcnt lgkmcnt(2)
    v_mfma_f32_32x32x16_bf16 v[84:99], v[132:135], v[52:55], v[84:99]
    s_add_u32 s42, s42, s50
    s_add_u32 s42, s42, 4096
    s_add_u32 s43, s51, 512
    v_mov_b32 v14, s43
    v_mov_b32 v19, 0
    ds_read_b128 v[132:135], v16 offset:30720
    s_waitcnt lgkmcnt(1)
    v_mfma_f32_32x32x16_bf16 v[84:99], v[144:147], v[56:59], v[84:99]
    v_mul_f32 v12, 0x3eb8aa3b, v13
    s_sub_u32 s56, s42, 8192
    s_sub_u32 s58, s42, 16384
    s_sub_u32 s59, s57, 32768
    s_sub_u32 s57, s57, 16384
    ds_read_b128 v[144:147], v16 offset:33792
    s_waitcnt lgkmcnt(1)
    v_mfma_f32_32x32x16_bf16 v[84:99], v[132:135], v[60:63], v[84:99]
    s_cmp_lt_u32 s36, 1
    s_cselect_b32 s56, s42, s56
    s_cselect_b32 s57, 0x7ff00000, s57
    ds_read_b128 v[132:135], v16 offset:36864
    s_waitcnt lgkmcnt(1)
    v_mfma_f32_32x32x16_bf16 v[84:99], v[144:147], v[64:67], v[84:99]
    s_cmp_lt_u32 s36, 2
    s_cselect_b32 s58, s56, s58
    s_cselect_b32 s59, 0x7ff00000, s59
    s_mul_i32 s47, s38, 4112
    s_add_u32 s47, s47, 98304
    ds_read_b128 v[144:147], v16 offset:39936
    s_waitcnt lgkmcnt(1)
    v_mfma_f32_32x32x16_bf16 v[84:99], v[132:135], v[68:71], v[84:99]
    s_add_u32 s0, s47, 32896
    ds_read_b128 v[132:135], v16 offset:43008
    s_waitcnt lgkmcnt(1)
    v_mfma_f32_32x32x16_bf16 v[84:99], v[144:147], v[72:75], v[84:99]
    ds_read_b128 v[144:147], v16 offset:46080
    s_waitcnt lgkmcnt(1)
    v_mfma_f32_32x32x16_bf16 v[84:99], v[132:135], v[76:79], v[84:99]
    s_waitcnt lgkmcnt(0)
    v_mfma_f32_32x32x16_bf16 v[84:99], v[144:147], v[80:83], v[84:99]
    v_mov_b32 v112, v14
    s_mov_b32 s92, s42
    s_nop 9
    v_pk_mul_f32 v[84:85], v[84:85], v[12:13] op_sel_hi:[1,0]
    v_pk_mul_f32 v[86:87], v[86:87], v[12:13] op_sel_hi:[1,0]
    v_pk_mul_f32 v[88:89], v[88:89], v[12:13] op_sel_hi:[1,0]
    v_pk_mul_f32 v[90:91], v[90:91], v[12:13] op_sel_hi:[1,0]
    v_pk_mul_f32 v[92:93], v[92:93], v[12:13] op_sel_hi:[1,0]
    v_pk_mul_f32 v[94:95], v[94:95], v[12:13] op_sel_hi:[1,0]
    v_pk_mul_f32 v[96:97], v[96:97], v[12:13] op_sel_hi:[1,0]
    v_pk_mul_f32 v[98:99], v[98:99], v[12:13] op_sel_hi:[1,0]
    v_cvt_pk_bf16_f32 v20, v84, v85
    v_cvt_pk_bf16_f32 v21, v86, v87
    v_cvt_pk_bf16_f32 v22, v88, v89
    v_cvt_pk_bf16_f32 v23, v90, v91
    v_cvt_pk_bf16_f32 v24, v92, v93
    v_cvt_pk_bf16_f32 v25, v94, v95
    v_cvt_pk_bf16_f32 v26, v96, v97
    v_cvt_pk_bf16_f32 v27, v98, v99
    s_mul_i32 s54, s38, 4112
    v_add_u32 v18, 98304, v1
    v_add_u32 v12, s54, v18
    v_add_u32 v15, 154880, v1
    s_mul_i32 s55, s52, 114688
    s_lshl_b32 s43, s37, 11
    s_add_u32 s55, s55, s43
    s_add_u32 s55, s55, 8388608
    s_mov_b64 s[96:97], 0
    v_bfe_u32 v28, v0, 4, 1
    v_cmp_eq_u32 vcc, 0, v28
    v_sub_u32 v28, v18, v1
    v_add_u32 v29, 2048, v18
    v_add_u32 v28, 4096, v28
    v_cndmask_b32 v13, v28, v29, vcc
    v_bfe_u32 v28, v0, 4, 1
    v_cmp_eq_u32 vcc, 0, v28
    v_sub_u32 v28, v18, v1
    v_add_u32 v29, 3072, v18
    v_add_u32 v28, 4096, v28
    v_cndmask_b32 v14, v28, v29, vcc
    s_waitcnt vmcnt(4)
    v_cmp_gt_u32 vcc, 1, v159
    s_cbranch_vccnz Lspin_31
Lback_32:
    s_mov_b32 m0, s0
    s_nop 0
    buffer_load_dwordx4 v1, s[4:7], s57 offen offset:0 sc1 lds
    buffer_load_dwordx4 v1, s[4:7], s57 offen offset:1024 sc1 lds
    buffer_load_dwordx4 v1, s[4:7], s57 offen offset:2048 sc1 lds
    buffer_load_dwordx4 v1, s[4:7], s57 offen offset:3072 sc1 lds
    s_mov_b32 m0, s47
    s_nop 0
    buffer_load_dwordx4 v1, s[4:7], s59 offen offset:0 sc1 lds
    buffer_load_dwordx4 v1, s[4:7], s59 offen offset:1024 sc1 lds
    buffer_load_dwordx4 v1, s[4:7], s59 offen offset:2048 sc1 lds
    buffer_load_dwordx4 v1, s[4:7], s59 offen offset:3072 sc1 lds
    s_waitcnt vmcnt(8)
    buffer_store_dword v112, v19, s[4:7], s92 offen offset:0 sc1
    s_waitcnt vmcnt(5)
    ds_read_b128 v[44:47], v12 offset:32896
    ds_read_b128 v[48:51], v12 offset:33920
    ds_read_b128 v[52:55], v12 offset:34944
    ds_read_b128 v[56:59], v12 offset:35968
    s_waitcnt lgkmcnt(3)
    v_max3_u32 v44, v44, v45, v46
    s_waitcnt lgkmcnt(2)
    v_max3_u32 v47, v47, v48, v49
    s_waitcnt lgkmcnt(1)
    v_max3_u32 v50, v50, v51, v52
    v_max3_u32 v53, v53, v54, v55
    s_waitcnt lgkmcnt(0)
    v_max3_u32 v56, v56, v57, v58
    v_max3_u32 v44, v44, v47, v50
    v_max3_u32 v53, v53, v56, v59
    v_max_u32 v44, v44, v53
    v_cmp_eq_u32 vcc, -1, v44
    s_cbranch_vccnz Lhre_33
Lhok_34:
    s_waitcnt lgkmcnt(0)
    s_barrier
    ds_read_b128 v[68:71], v18 offset:32896
    ds_read_b128 v[72:75], v13 offset:32896
    s_waitcnt lgkmcnt(1)
    v_mfma_f32_32x32x16_bf16 v[28:43], v[68:71], v[20:23], 0
    ds_read_b128 v[68:71], v18 offset:37008
    s_nop 10
    v_exp_f32 v28, v28
    v_exp_f32 v29, v29
    ds_read_b128 v[76:79], v14 offset:32896
    v_exp_f32 v30, v30
    v_exp_f32 v31, v31
    v_cvt_pk_bf16_f32 v60, v28, v29
    v_exp_f32 v32, v32
    v_exp_f32 v33, v33
    s_add_u32 s49, s100, 4096
    buffer_load_dwordx4 v[112:115], v1, s[4:7], s49 offen offset:0 sc1
    v_cvt_pk_bf16_f32 v61, v30, v31
    s_waitcnt lgkmcnt(1)
    v_mfma_f32_32x32x16_bf16 v[44:59], v[68:71], v[20:23], 0
    ds_read_b128 v[68:71], v18 offset:41120
    v_exp_f32 v34, v34
    v_exp_f32 v35, v35
    v_cvt_pk_bf16_f32 v62, v32, v33
    v_exp_f32 v36, v36
    v_cvt_pk_bf16_f32 v63, v34, v35
    v_exp_f32 v37, v37
    v_exp_f32 v38, v38
    v_mfma_f32_32x32x16_bf16 v[80:95], v[72:75], v[60:63], 0
    ds_read_b128 v[72:75], v13 offset:37008
    v_exp_f32 v39, v39
    v_cvt_pk_bf16_f32 v64, v36, v37
    v_exp_f32 v40, v40
    v_exp_f32 v41, v41
    buffer_load_dwordx4 v[116:119], v1, s[4:7], s49 offen offset:1024 sc1
    v_cvt_pk_bf16_f32 v65, v38, v39
    v_exp_f32 v42, v42
    v_exp_f32 v43, v43
    v_cvt_pk_bf16_f32 v66, v40, v41
    buffer_load_dwordx4 v[120:123], v1, s[4:7], s49 offen offset:2048 sc1
    v_cvt_pk_bf16_f32 v67, v42, v43
    v_exp_f32 v44, v44
    v_exp_f32 v45, v45
    s_waitcnt lgkmcnt(2)
    v_mfma_f32_32x32x16_bf16 v[80:95], v[76:79], v[64:67], v[80:95]
    ds_read_b128 v[76:79], v14 offset:37008
    v_exp_f32 v46, v46
    v_exp_f32 v47, v47
    v_cvt_pk_bf16_f32 v60, v44, v45
    v_exp_f32 v48, v48
    v_exp_f32 v49, v49
    buffer_load_dwordx4 v[124:127], v1, s[4:7], s49 offen offset:3072 sc1
    s_add_u32 s49, s100, 8192
    v_cvt_pk_bf16_f32 v61, v46, v47
    s_waitcnt lgkmcnt(2)
    v_mfma_f32_32x32x16_bf16 v[28:43], v[68:71], v[20:23], 0
    ds_read_b128 v[68:71], v18 offset:45232
    v_exp_f32 v50, v50
    v_exp_f32 v51, v51
    v_cvt_pk_bf16_f32 v62, v48, v49
    v_exp_f32 v52, v52
    v_cvt_pk_bf16_f32 v63, v50, v51
    v_exp_f32 v53, v53
    v_exp_f32 v54, v54
    s_waitcnt lgkmcnt(2)
    v_mfma_f32_32x32x16_bf16 v[80:95], v[72:75], v[60:63], v[80:95]
    ds_read_b128 v[72:75], v13 offset:41120
    v_exp_f32 v55, v55
    v_cvt_pk_bf16_f32 v64, v52, v53
    v_exp_f32 v56, v56
    v_exp_f32 v57, v57
    buffer_load_dwordx4 v[128:131], v1, s[4:7], s49 offen offset:0 sc1
    v_cvt_pk_bf16_f32 v65, v54, v55
    v_exp_f32 v58, v58
    v_exp_f32 v59, v59
    v_cvt_pk_bf16_f32 v66, v56, v57
    buffer_load_dwordx4 v[132:135], v1, s[4:7], s49 offen offset:1024 sc1
    v_cvt_pk_bf16_f32 v67, v58, v59
    v_exp_f32 v28, v28
    v_exp_f32 v29, v29
    s_waitcnt lgkmcnt(2)
    v_mfma_f32_32x32x16_bf16 v[80:95], v[76:79], v[64:67], v[80:95]
    ds_read_b128 v[76:79], v14 offset:41120
    v_exp_f32 v30, v30
    v_exp_f32 v31, v31
    v_cvt_pk_bf16_f32 v60, v28, v29
    v_exp_f32 v32, v32
    v_exp_f32 v33, v33
    buffer_load_dwordx4 v[136:139], v1, s[4:7], s49 offen offset:2048 sc1
    v_cvt_pk_bf16_f32 v61, v30, v31
    s_waitcnt lgkmcnt(2)
    v_mfma_f32_32x32x16_bf16 v[44:59], v[68:71], v[20:23], 0
    ds_read_b128 v[68:71], v12 offset:16448
    v_exp_f32 v34, v34
    v_exp_f32 v35, v35
    v_cvt_pk_bf16_f32 v62, v32, v33
    v_exp_f32 v36, v36
    v_cvt_pk_bf16_f32 v63, v34, v35
    v_exp_f32 v37, v37
    v_exp_f32 v38, v38
    s_waitcnt lgkmcnt(2)
    v_mfma_f32_32x32x16_bf16 v[80:95], v[72:75], v[60:63], v[80:95]
    ds_read_b128 v[72:75], v13 offset:45232
    v_exp_f32 v39, v39
    v_cvt_pk_bf16_f32 v64, v36, v37
    v_exp_f32 v40, v40
    v_exp_f32 v41, v41
    buffer_load_dwordx4 v[140:143], v1, s[4:7], s49 offen offset:3072 sc1
    s_add_u32 s49, s100, 12288
    v_cvt_pk_bf16_f32 v65, v38, v39
    v_exp_f32 v42, v42
    v_exp_f32 v43, v43
    v_cvt_pk_bf16_f32 v66, v40, v41
    buffer_load_dwordx4 v[144:147], v1, s[4:7], s49 offen offset:0 sc1
    v_cvt_pk_bf16_f32 v67, v42, v43
    v_exp_f32 v44, v44
    v_exp_f32 v45, v45
    s_waitcnt lgkmcnt(2)
    v_mfma_f32_32x32x16_bf16 v[80:95], v[76:79], v[64:67], v[80:95]
    ds_read_b128 v[76:79], v14 offset:45232
    s_waitcnt vmcnt(10)
    ds_read_b128 v[96:99], v12 offset:0
    ds_read_b128 v[100:103], v12 offset:1024
    ds_read_b128 v[104:107], v12 offset:2048
    ds_read_b128 v[108:111], v12 offset:3072
    v_exp_f32 v46, v46
    v_exp_f32 v47, v47
    v_cvt_pk_bf16_f32 v60, v44, v45
    v_exp_f32 v48, v48
    v_exp_f32 v49, v49
    buffer_load_dwordx4 v[148:151], v1, s[4:7], s49 offen offset:1024 sc1
    v_cvt_pk_bf16_f32 v61, v46, v47
    s_waitcnt lgkmcnt(6)
    v_mfma_f32_32x32x16_bf16 v[28:43], v[68:71], v[20:23], 0
    s_waitcnt lgkmcnt(3)
    v_max3_u32 v96, v96, v97, v98
    s_waitcnt lgkmcnt(2)
    v_max3_u32 v99, v99, v100, v101
    s_waitcnt lgkmcnt(1)
    v_max3_u32 v102, v102, v103, v104
    v_max3_u32 v105, v105, v106, v107
    s_waitcnt lgkmcnt(0)
    v_max3_u32 v108, v108, v109, v110
    v_max3_u32 v96, v96, v99, v102
    v_max3_u32 v105, v105, v108, v111
    v_max_u32 v96, v96, v105
    v_cmp_eq_u32 vcc, -1, v96
    s_cbranch_vccnz Lhre_35
Lhok_36:
    s_barrier
    ds_read_b128 v[68:71], v12 offset:0
    v_exp_f32 v50, v50
    v_exp_f32 v51, v51
    v_cvt_pk_bf16_f32 v62, v48, v49
    v_exp_f32 v52, v52
    v_cvt_pk_bf16_f32 v63, v50, v51
    v_exp_f32 v53, v53
    v_exp_f32 v54, v54
    v_mfma_f32_32x32x16_bf16 v[80:95], v[72:75], v[60:63], v[80:95]
    v_add_u32 v13, s54, v13
    ds_read_b128 v[72:75], v13 offset:16448
    v_exp_f32 v55, v55
    v_cvt_pk_bf16_f32 v64, v52, v53
    v_exp_f32 v56, v56
    s_waitcnt lgkmcnt(1)
    v_mfma_f32_32x32x16_bf16 v[96:111], v[68:71], v[20:23], 0
    ds_read_b128 v[68:71], v12 offset:12336
    v_exp_f32 v57, v57
    buffer_load_dwordx4 v[152:155], v1, s[4:7], s49 offen offset:2048 sc1
    v_cvt_pk_bf16_f32 v65, v54, v55
    v_exp_f32 v58, v58
    v_exp_f32 v59, v59
    v_cvt_pk_bf16_f32 v66, v56, v57
    buffer_load_dwordx4 v[156:159], v1, s[4:7], s49 offen offset:3072 sc1
    v_cvt_pk_bf16_f32 v67, v58, v59
    s_nop 2
    v_cndmask_b32 v28, v96, v28, s[60:61]
    v_cndmask_b32 v29, v97, v29, s[62:63]
    v_mfma_f32_32x32x16_bf16 v[80:95], v[76:79], v[64:67], v[80:95]
    v_add_u32 v14, s54, v14
    ds_read_b128 v[76:79], v14 offset:16448
    v_cndmask_b32 v30, v98, v30, s[64:65]
    v_cndmask_b32 v31, v99, v31, s[66:67]
    v_cndmask_b32 v32, v100, v32, s[68:69]
    v_cndmask_b32 v33, v101, v33, s[70:71]
    v_cndmask_b32 v34, v102, v34, s[72:73]
    v_cndmask_b32 v35, v103, v35, s[74:75]
    v_cndmask_b32 v36, v104, v36, s[76:77]
    v_cndmask_b32 v37, v105, v37, s[78:79]
    v_cndmask_b32 v38, v106, v38, s[80:81]
    v_cndmask_b32 v39, v107, v39, s[82:83]
    v_cndmask_b32 v40, v108, v40, s[84:85]
    v_cndmask_b32 v41, v109, v41, s[86:87]
    v_cndmask_b32 v42, v110, v42, s[88:89]
    v_cndmask_b32 v43, v111, v43, s[90:91]
    ds_read_b128 v[96:99], v15
    ds_read_b128 v[100:103], v15 offset:1024
    ds_read_b128 v[104:107], v13 offset:0
    ds_read_b128 v[108:111], v14 offset:0
    s_waitcnt lgkmcnt(5)
    v_mfma_f32_32x32x16_bf16 v[44:59], v[68:71], v[20:23], 0
    ds_read_b128 v[68:71], v12 offset:8224
    v_exp_f32 v28, v28
    v_exp_f32 v29, v29
    v_exp_f32 v30, v30
    v_exp_f32 v31, v31
    v_cvt_pk_bf16_f32 v60, v28, v29
    v_exp_f32 v32, v32
    v_exp_f32 v33, v33
    v_cvt_pk_bf16_f32 v61, v30, v31
    v_exp_f32 v34, v34
    v_exp_f32 v35, v35
    v_cvt_pk_bf16_f32 v62, v32, v33
    v_exp_f32 v36, v36
    v_cvt_pk_bf16_f32 v63, v34, v35
    v_exp_f32 v37, v37
    s_waitcnt lgkmcnt(4)
    v_and_b32 v96, v96, v60
    v_and_b32 v97, v97, v61
    v_and_b32 v98, v98, v62
    v_and_b32 v99, v99, v63
    v_exp_f32 v38, v38
    v_exp_f32 v39, v39
    v_mfma_f32_32x32x16_bf16 v[80:95], v[72:75], v[96:99], v[80:95]
    ds_read_b128 v[72:75], v13 offset:12336
    v_xor_b32 v60, v96, v60
    v_xor_b32 v61, v97, v61
    v_xor_b32 v62, v98, v62
    v_xor_b32 v63, v99, v63
    v_cvt_pk_bf16_f32 v64, v36, v37
    v_exp_f32 v40, v40
    v_exp_f32 v41, v41
    s_waitcnt lgkmcnt(3)
    v_mfma_f32_32x32x16_bf16 v[80:95], v[104:107], v[60:63], v[80:95]
    v_cvt_pk_bf16_f32 v65, v38, v39
    v_exp_f32 v42, v42
    v_exp_f32 v43, v43
    v_cvt_pk_bf16_f32 v66, v40, v41
    v_cvt_pk_bf16_f32 v67, v42, v43
    v_and_b32 v100, v100, v64
    v_and_b32 v101, v101, v65
    v_and_b32 v102, v102, v66
    v_and_b32 v103, v103, v67
    v_xor_b32 v64, v100, v64
    v_xor_b32 v65, v101, v65
    v_mfma_f32_32x32x16_bf16 v[80:95], v[76:79], v[100:103], v[80:95]
    v_xor_b32 v66, v102, v66
    v_xor_b32 v67, v103, v67
    v_exp_f32 v44, v44
    v_exp_f32 v45, v45
    s_waitcnt lgkmcnt(2)
    v_mfma_f32_32x32x16_bf16 v[80:95], v[108:111], v[64:67], v[80:95]
    ds_read_b128 v[76:79], v14 offset:12336
    v_exp_f32 v46, v46
    v_exp_f32 v47, v47
    v_cvt_pk_bf16_f32 v60, v44, v45
    v_exp_f32 v48, v48
    v_exp_f32 v49, v49
    v_cvt_pk_bf16_f32 v61, v46, v47
    s_waitcnt lgkmcnt(2)
    v_mfma_f32_32x32x16_bf16 v[28:43], v[68:71], v[20:23], 0
    ds_read_b128 v[68:71], v12 offset:4112
    v_exp_f32 v50, v50
    v_exp_f32 v51, v51
    v_cvt_pk_bf16_f32 v62, v48, v49
    v_exp_f32 v52, v52
    v_cvt_pk_bf16_f32 v63, v50, v51
    v_exp_f32 v53, v53
    v_exp_f32 v54, v54
    s_waitcnt lgkmcnt(2)
    v_mfma_f32_32x32x16_bf16 v[80:95], v[72:75], v[60:63], v[80:95]
    ds_read_b128 v[72:75], v13 offset:8224
    v_exp_f32 v55, v55
    v_cvt_pk_bf16_f32 v64, v52, v53
    v_exp_f32 v56, v56
    v_exp_f32 v57, v57
    v_cvt_pk_bf16_f32 v65, v54, v55
    v_exp_f32 v58, v58
    v_exp_f32 v59, v59
    v_cvt_pk_bf16_f32 v66, v56, v57
    v_cvt_pk_bf16_f32 v67, v58, v59
    v_exp_f32 v28, v28
    v_exp_f32 v29, v29
    s_waitcnt lgkmcnt(2)
    v_mfma_f32_32x32x16_bf16 v[80:95], v[76:79], v[64:67], v[80:95]
    ds_read_b128 v[76:79], v14 offset:8224
    v_exp_f32 v30, v30
    v_exp_f32 v31, v31
    v_cvt_pk_bf16_f32 v60, v28, v29
    v_exp_f32 v32, v32
    v_exp_f32 v33, v33
    v_cvt_pk_bf16_f32 v61, v30, v31
    s_waitcnt lgkmcnt(2)
    v_mfma_f32_32x32x16_bf16 v[44:59], v[68:71], v[20:23], 0
    ds_read_b128 v[68:71], v12 offset:17472
    v_exp_f32 v34, v34
    v_exp_f32 v35, v35
    v_cvt_pk_bf16_f32 v62, v32, v33
    v_exp_f32 v36, v36
    v_cvt_pk_bf16_f32 v63, v34, v35
    v_exp_f32 v37, v37
    v_exp_f32 v38, v38
    s_waitcnt lgkmcnt(2)
    v_mfma_f32_32x32x16_bf16 v[80:95], v[72:75], v[60:63], v[80:95]
    ds_read_b128 v[72:75], v13 offset:4112
    v_exp_f32 v39, v39
    v_cvt_pk_bf16_f32 v64, v36, v37
    v_exp_f32 v40, v40
    v_exp_f32 v41, v41
    v_cvt_pk_bf16_f32 v65, v38, v39
    v_exp_f32 v42, v42
    v_exp_f32 v43, v43
    v_cvt_pk_bf16_f32 v66, v40, v41
    v_cvt_pk_bf16_f32 v67, v42, v43
    v_exp_f32 v44, v44
    v_exp_f32 v45, v45
    s_waitcnt lgkmcnt(2)
    v_mfma_f32_32x32x16_bf16 v[80:95], v[76:79], v[64:67], v[80:95]
    ds_read_b128 v[76:79], v14 offset:4112
    v_exp_f32 v46, v46
    v_exp_f32 v47, v47
    v_cvt_pk_bf16_f32 v60, v44, v45
    v_exp_f32 v48, v48
    v_exp_f32 v49, v49
    v_cvt_pk_bf16_f32 v61, v46, v47
    s_waitcnt lgkmcnt(2)
    v_mfma_f32_32x32x16_bf16 v[28:43], v[68:71], v[24:27], 0
    ds_read_b128 v[68:71], v12 offset:1024
    v_exp_f32 v50, v50
    v_exp_f32 v51, v51
    v_cvt_pk_bf16_f32 v62, v48, v49
    v_exp_f32 v52, v52
    v_cvt_pk_bf16_f32 v63, v50, v51
    v_exp_f32 v53, v53
    v_exp_f32 v54, v54
    s_waitcnt lgkmcnt(2)
    v_mfma_f32_32x32x16_bf16 v[80:95], v[72:75], v[60:63], v[80:95]
    v_bfe_u32 v16, v0, 4, 1
    v_cmp_eq_u32 vcc, 1, v16
    v_sub_u32 v16, v12, v1
    v_add_u32 v17, 2048, v12
    v_add_u32 v16, 4096, v16
    v_cndmask_b32 v13, v16, v17, vcc
    ds_read_b128 v[72:75], v13 offset:16448
    v_exp_f32 v55, v55
    v_cvt_pk_bf16_f32 v64, v52, v53
    v_exp_f32 v56, v56
    s_waitcnt lgkmcnt(1)
    v_mfma_f32_32x32x16_bf16 v[96:111], v[68:71], v[24:27], 0
    ds_read_b128 v[68:71], v12 offset:13360
    v_exp_f32 v57, v57
    v_cvt_pk_bf16_f32 v65, v54, v55
    v_exp_f32 v58, v58
    v_exp_f32 v59, v59
    v_cvt_pk_bf16_f32 v66, v56, v57
    v_cvt_pk_bf16_f32 v67, v58, v59
    s_nop 4
    v_cndmask_b32 v28, v96, v28, s[60:61]
    v_cndmask_b32 v29, v97, v29, s[62:63]
    v_mfma_f32_32x32x16_bf16 v[80:95], v[76:79], v[64:67], v[80:95]
    v_bfe_u32 v16, v0, 4, 1
    v_cmp_eq_u32 vcc, 1, v16
    v_sub_u32 v16, v12, v1
    v_add_u32 v17, 3072, v12
    v_add_u32 v16, 4096, v16
    v_cndmask_b32 v14, v16, v17, vcc
    ds_read_b128 v[76:79], v14 offset:16448
    v_cndmask_b32 v30, v98, v30, s[64:65]
    v_cndmask_b32 v31, v99, v31, s[66:67]
    v_cndmask_b32 v32, v100, v32, s[68:69]
    v_cndmask_b32 v33, v101, v33, s[70:71]
    v_cndmask_b32 v34, v102, v34, s[72:73]
    v_cndmask_b32 v35, v103, v35, s[74:75]
    v_cndmask_b32 v36, v104, v36, s[76:77]
    v_cndmask_b32 v37, v105, v37, s[78:79]
    v_cndmask_b32 v38, v106, v38, s[80:81]
    v_cndmask_b32 v39, v107, v39, s[82:83]
    v_cndmask_b32 v40, v108, v40, s[84:85]
    v_cndmask_b32 v41, v109, v41, s[86:87]
    v_cndmask_b32 v42, v110, v42, s[88:89]
    v_cndmask_b32 v43, v111, v43, s[90:91]
    ds_read_b128 v[96:99], v15
    ds_read_b128 v[100:103], v15 offset:1024
    ds_read_b128 v[104:107], v13 offset:0
    ds_read_b128 v[108:111], v14 offset:0
    s_waitcnt lgkmcnt(5)
    v_mfma_f32_32x32x16_bf16 v[44:59], v[68:71], v[24:27], 0
    ds_read_b128 v[68:71], v12 offset:9248
    v_rcp_f32 v16, v88
    v_subrev_u32 v92, 729808896, v88
    v_mul_f32 v80, v80, v16
    v_mul_f32 v81, v81, v16
    v_mul_f32 v82, v82, v16
    v_mul_f32 v83, v83, v16
    v_mul_f32 v84, v84, v16
    v_mul_f32 v85, v85, v16
    v_mul_f32 v86, v86, v16
    v_mul_f32 v87, v87, v16
    v_cmp_lt_u32 vcc, 671088640, v92
    v_cvt_pk_bf16_f32 v88, v80, v81
    v_cvt_pk_bf16_f32 v89, v82, v83
    v_cvt_pk_bf16_f32 v90, v84, v85
    v_cvt_pk_bf16_f32 v91, v86, v87
    s_or_b64 s[96:97], s[96:97], vcc
    s_cmp_eq_u32 s39, 0
    s_cbranch_scc1 Lslow_68
    buffer_store_dwordx4 v[88:91], v1, s[4:7], s55 offen offset:0
Ldual_68:
    v_exp_f32 v28, v28
    v_exp_f32 v29, v29
    v_exp_f32 v30, v30
    v_exp_f32 v31, v31
    v_cvt_pk_bf16_f32 v60, v28, v29
    v_exp_f32 v32, v32
    v_exp_f32 v33, v33
    v_cvt_pk_bf16_f32 v61, v30, v31
    v_exp_f32 v34, v34
    v_exp_f32 v35, v35
    v_cvt_pk_bf16_f32 v62, v32, v33
    v_exp_f32 v36, v36
    v_cvt_pk_bf16_f32 v63, v34, v35
    v_exp_f32 v37, v37
    s_waitcnt lgkmcnt(4)
    v_and_b32 v96, v96, v60
    v_and_b32 v97, v97, v61
    v_and_b32 v98, v98, v62
    v_and_b32 v99, v99, v63
    v_exp_f32 v38, v38
    v_exp_f32 v39, v39
    v_mfma_f32_32x32x16_bf16 v[80:95], v[72:75], v[96:99], 0
    ds_read_b128 v[72:75], v13 offset:12336
    v_xor_b32 v60, v96, v60
    v_xor_b32 v61, v97, v61
    v_xor_b32 v62, v98, v62
    v_xor_b32 v63, v99, v63
    v_cvt_pk_bf16_f32 v64, v36, v37
    v_exp_f32 v40, v40
    v_exp_f32 v41, v41
    s_waitcnt lgkmcnt(3)
    v_mfma_f32_32x32x16_bf16 v[80:95], v[104:107], v[60:63], v[80:95]
    v_cvt_pk_bf16_f32 v65, v38, v39
    v_exp_f32 v42, v42
    v_exp_f32 v43, v43
    v_cvt_pk_bf16_f32 v66, v40, v41
    v_cvt_pk_bf16_f32 v67, v42, v43
    v_and_b32 v100, v100, v64
    v_and_b32 v101, v101, v65
    v_and_b32 v102, v102, v66
    v_and_b32 v103, v103, v67
    v_xor_b32 v64, v100, v64
    v_xor_b32 v65, v101, v65
    v_mfma_f32_32x32x16_bf16 v[80:95], v[76:79], v[100:103], v[80:95]
    v_xor_b32 v66, v102, v66
    v_xor_b32 v67, v103, v67
    v_exp_f32 v44, v44
    v_exp_f32 v45, v45
    s_waitcnt lgkmcnt(2)
    v_mfma_f32_32x32x16_bf16 v[80:95], v[108:111], v[64:67], v[80:95]
    ds_read_b128 v[76:79], v14 offset:12336
    v_exp_f32 v46, v46
    v_exp_f32 v47, v47
    v_cvt_pk_bf16_f32 v60, v44, v45
    v_exp_f32 v48, v48
    v_exp_f32 v49, v49
    v_cvt_pk_bf16_f32 v61, v46, v47
    s_waitcnt lgkmcnt(2)
    v_mfma_f32_32x32x16_bf16 v[28:43], v[68:71], v[24:27], 0
    ds_read_b128 v[68:71], v12 offset:5136
    v_exp_f32 v50, v50
    v_exp_f32 v51, v51
    v_cvt_pk_bf16_f32 v62, v48, v49
    v_exp_f32 v52, v52
    v_cvt_pk_bf16_f32 v63, v50, v51
    v_exp_f32 v53, v53
    v_exp_f32 v54, v54
    s_waitcnt lgkmcnt(2)
    v_mfma_f32_32x32x16_bf16 v[80:95], v[72:75], v[60:63], v[80:95]
    ds_read_b128 v[72:75], v13 offset:8224
    v_exp_f32 v55, v55
    v_cvt_pk_bf16_f32 v64, v52, v53
    v_exp_f32 v56, v56
    v_exp_f32 v57, v57
    v_cvt_pk_bf16_f32 v65, v54, v55
    v_exp_f32 v58, v58
    v_exp_f32 v59, v59
    v_cvt_pk_bf16_f32 v66, v56, v57
    v_cvt_pk_bf16_f32 v67, v58, v59
    v_exp_f32 v28, v28
    v_exp_f32 v29, v29
    s_waitcnt lgkmcnt(2)
    v_mfma_f32_32x32x16_bf16 v[80:95], v[76:79], v[64:67], v[80:95]
    ds_read_b128 v[76:79], v14 offset:8224
    v_exp_f32 v30, v30
    v_exp_f32 v31, v31
    v_cvt_pk_bf16_f32 v60, v28, v29
    v_exp_f32 v32, v32
    v_exp_f32 v33, v33
    buffer_load_dwordx4 v[96:99], v1, s[4:7], s100 offen offset:0 sc1
    v_cvt_pk_bf16_f32 v61, v30, v31
    s_waitcnt lgkmcnt(2)
    v_mfma_f32_32x32x16_bf16 v[44:59], v[68:71], v[24:27], 0
    ds_read_b128 v[68:71], v18 offset:33920
    v_exp_f32 v34, v34
    v_exp_f32 v35, v35
    v_cvt_pk_bf16_f32 v62, v32, v33
    v_exp_f32 v36, v36
    v_cvt_pk_bf16_f32 v63, v34, v35
    v_exp_f32 v37, v37
    v_exp_f32 v38, v38
    s_waitcnt lgkmcnt(2)
    v_mfma_f32_32x32x16_bf16 v[80:95], v[72:75], v[60:63], v[80:95]
    ds_read_b128 v[72:75], v13 offset:4112
    v_exp_f32 v39, v39
    v_cvt_pk_bf16_f32 v64, v36, v37
    v_exp_f32 v40, v40
    v_exp_f32 v41, v41
    buffer_load_dwordx4 v[100:103], v1, s[4:7], s100 offen offset:1024 sc1
    v_cvt_pk_bf16_f32 v65, v38, v39
    v_exp_f32 v42, v42
    v_exp_f32 v43, v43
    v_cvt_pk_bf16_f32 v66, v40, v41
    buffer_load_dwordx4 v[104:107], v1, s[4:7], s100 offen offset:2048 sc1
    v_cvt_pk_bf16_f32 v67, v42, v43
    v_exp_f32 v44, v44
    v_exp_f32 v45, v45
    s_waitcnt lgkmcnt(2)
    v_mfma_f32_32x32x16_bf16 v[80:95], v[76:79], v[64:67], v[80:95]
    ds_read_b128 v[76:79], v14 offset:4112
    v_exp_f32 v46, v46
    v_exp_f32 v47, v47
    v_cvt_pk_bf16_f32 v60, v44, v45
    v_exp_f32 v48, v48
    v_exp_f32 v49, v49
    buffer_load_dwordx4 v[108:111], v1, s[4:7], s100 offen offset:3072 sc1
    v_cvt_pk_bf16_f32 v61, v46, v47
    s_waitcnt lgkmcnt(2)
    v_mfma_f32_32x32x16_bf16 v[28:43], v[68:71], v[24:27], 0
    ds_read_b128 v[68:71], v18 offset:38032
    v_exp_f32 v50, v50
    v_exp_f32 v51, v51
    v_cvt_pk_bf16_f32 v62, v48, v49
    v_exp_f32 v52, v52
    v_cvt_pk_bf16_f32 v63, v50, v51
    v_exp_f32 v53, v53
    v_exp_f32 v54, v54
    s_waitcnt lgkmcnt(2)
    v_mfma_f32_32x32x16_bf16 v[80:95], v[72:75], v[60:63], v[80:95]
    v_subrev_u32 v13, s54, v13
    ds_read_b128 v[72:75], v13 offset:32896
    v_exp_f32 v55, v55
    v_cvt_pk_bf16_f32 v64, v52, v53
    v_exp_f32 v56, v56
    v_exp_f32 v57, v57
    v_cvt_pk_bf16_f32 v65, v54, v55
    v_exp_f32 v58, v58
    v_exp_f32 v59, v59
    v_cvt_pk_bf16_f32 v66, v56, v57
    v_cvt_pk_bf16_f32 v67, v58, v59
    v_exp_f32 v28, v28
    v_exp_f32 v29, v29
    s_waitcnt lgkmcnt(2)
    v_mfma_f32_32x32x16_bf16 v[80:95], v[76:79], v[64:67], v[80:95]
    v_subrev_u32 v14, s54, v14
    ds_read_b128 v[76:79], v14 offset:32896
    v_exp_f32 v30, v30
    v_exp_f32 v31, v31
    v_cvt_pk_bf16_f32 v60, v28, v29
    v_exp_f32 v32, v32
    v_exp_f32 v33, v33
    v_cvt_pk_bf16_f32 v61, v30, v31
    s_waitcnt lgkmcnt(2)
    v_mfma_f32_32x32x16_bf16 v[44:59], v[68:71], v[24:27], 0
    ds_read_b128 v[68:71], v18 offset:42144
    v_exp_f32 v34, v34
    v_exp_f32 v35, v35
    v_cvt_pk_bf16_f32 v62, v32, v33
    v_exp_f32 v36, v36
    v_cvt_pk_bf16_f32 v63, v34, v35
    v_exp_f32 v37, v37
    v_exp_f32 v38, v38
    s_waitcnt lgkmcnt(2)
    v_mfma_f32_32x32x16_bf16 v[80:95], v[72:75], v[60:63], v[80:95]
    ds_read_b128 v[72:75], v13 offset:37008
    v_exp_f32 v39, v39
    v_cvt_pk_bf16_f32 v64, v36, v37
    v_exp_f32 v40, v40
    v_exp_f32 v41, v41
    v_cvt_pk_bf16_f32 v65, v38, v39
    v_exp_f32 v42, v42
    v_exp_f32 v43, v43
    v_cvt_pk_bf16_f32 v66, v40, v41
    v_cvt_pk_bf16_f32 v67, v42, v43
    v_exp_f32 v44, v44
    v_exp_f32 v45, v45
    s_waitcnt lgkmcnt(2)
    v_mfma_f32_32x32x16_bf16 v[80:95], v[76:79], v[64:67], v[80:95]
    ds_read_b128 v[76:79], v14 offset:37008
    v_exp_f32 v46, v46
    v_exp_f32 v47, v47
    v_cvt_pk_bf16_f32 v60, v44, v45
    v_exp_f32 v48, v48
    v_exp_f32 v49, v49
    v_cvt_pk_bf16_f32 v61, v46, v47
    s_waitcnt lgkmcnt(2)
    v_mfma_f32_32x32x16_bf16 v[28:43], v[68:71], v[24:27], 0
    ds_read_b128 v[68:71], v18 offset:46256
    v_exp_f32 v50, v50
    v_exp_f32 v51, v51
    v_cvt_pk_bf16_f32 v62, v48, v49
    v_exp_f32 v52, v52
    v_cvt_pk_bf16_f32 v63, v50, v51
    v_exp_f32 v53, v53
    v_exp_f32 v54, v54
    s_waitcnt lgkmcnt(2)
    v_mfma_f32_32x32x16_bf16 v[80:95], v[72:75], v[60:63], v[80:95]
    ds_read_b128 v[72:75], v13 offset:41120
    v_exp_f32 v55, v55
    v_cvt_pk_bf16_f32 v64, v52, v53
    v_exp_f32 v56, v56
    v_exp_f32 v57, v57
    v_cvt_pk_bf16_f32 v65, v54, v55
    v_exp_f32 v58, v58
    v_exp_f32 v59, v59
    v_cvt_pk_bf16_f32 v66, v56, v57
    v_cvt_pk_bf16_f32 v67, v58, v59
    v_exp_f32 v28, v28
    v_exp_f32 v29, v29
    s_waitcnt lgkmcnt(2)
    v_mfma_f32_32x32x16_bf16 v[80:95], v[76:79], v[64:67], v[80:95]
    ds_read_b128 v[76:79], v14 offset:41120
    v_exp_f32 v30, v30
    v_exp_f32 v31, v31
    v_cvt_pk_bf16_f32 v60, v28, v29
    v_exp_f32 v32, v32
    v_exp_f32 v33, v33
    v_cvt_pk_bf16_f32 v61, v30, v31
    s_waitcnt lgkmcnt(2)
    v_mfma_f32_32x32x16_bf16 v[44:59], v[68:71], v[24:27], 0
    v_exp_f32 v34, v34
    v_exp_f32 v35, v35
    v_cvt_pk_bf16_f32 v62, v32, v33
    v_exp_f32 v36, v36
    v_cvt_pk_bf16_f32 v63, v34, v35
    v_exp_f32 v37, v37
    v_exp_f32 v38, v38
    s_waitcnt lgkmcnt(1)
    v_mfma_f32_32x32x16_bf16 v[80:95], v[72:75], v[60:63], v[80:95]
    ds_read_b128 v[72:75], v13 offset:45232
    v_exp_f32 v39, v39
    v_cvt_pk_bf16_f32 v64, v36, v37
    v_exp_f32 v40, v40
    v_exp_f32 v41, v41
    v_cvt_pk_bf16_f32 v65, v38, v39
    v_exp_f32 v42, v42
    v_exp_f32 v43, v43
    v_cvt_pk_bf16_f32 v66, v40, v41
    v_cvt_pk_bf16_f32 v67, v42, v43
    v_exp_f32 v44, v44
    v_exp_f32 v45, v45
    s_waitcnt lgkmcnt(1)
    v_mfma_f32_32x32x16_bf16 v[80:95], v[76:79], v[64:67], v[80:95]
    ds_read_b128 v[76:79], v14 offset:45232
    v_exp_f32 v46, v46
    v_exp_f32 v47, v47
    v_cvt_pk_bf16_f32 v60, v44, v45
    v_exp_f32 v48, v48
    v_exp_f32 v49, v49
    v_cvt_pk_bf16_f32 v61, v46, v47
    v_exp_f32 v50, v50
    v_exp_f32 v51, v51
    v_cvt_pk_bf16_f32 v62, v48, v49
    v_exp_f32 v52, v52
    v_cvt_pk_bf16_f32 v63, v50, v51
    v_exp_f32 v53, v53
    v_exp_f32 v54, v54
    s_waitcnt lgkmcnt(1)
    v_mfma_f32_32x32x16_bf16 v[80:95], v[72:75], v[60:63], v[80:95]
    v_exp_f32 v55, v55
    v_cvt_pk_bf16_f32 v64, v52, v53
    v_exp_f32 v56, v56
    v_exp_f32 v57, v57
    v_cvt_pk_bf16_f32 v65, v54, v55
    v_exp_f32 v58, v58
    v_exp_f32 v59, v59
    v_cvt_pk_bf16_f32 v66, v56, v57
    v_cvt_pk_bf16_f32 v67, v58, v59
    s_waitcnt lgkmcnt(0)
    s_nop 0
    v_mfma_f32_32x32x16_bf16 v[80:95], v[76:79], v[64:67], v[80:95]
    s_lshl_b32 s42, s38, 6
    s_lshl2_add_u32 s42, s37, s42
    s_add_u32 s42, s42, s50
    s_nop 8
    v_rcp_f32 v16, v80
    v_subrev_u32 v84, 729808896, v80
    v_mul_f32 v88, v88, v16
    v_mul_f32 v89, v89, v16
    v_mul_f32 v90, v90, v16
    v_mul_f32 v91, v91, v16
    v_mul_f32 v92, v92, v16
    v_mul_f32 v93, v93, v16
    v_mul_f32 v94, v94, v16
    v_mul_f32 v95, v95, v16
    v_cmp_lt_u32 vcc, 671088640, v84
    v_cvt_pk_bf16_f32 v28, v88, v89
    v_cvt_pk_bf16_f32 v29, v90, v91
    v_cvt_pk_bf16_f32 v30, v92, v93
    v_cvt_pk_bf16_f32 v31, v94, v95
    s_or_b64 s[96:97], s[96:97], vcc
    s_cmp_eq_u32 s39, 0
    s_cbranch_scc1 Lslow_69
    buffer_store_dwordx4 v[28:31], v1, s[4:7], s55 offen offset:1024
Ldual_69:
    s_cmp_lg_u64 s[96:97], 0
    s_cbranch_scc1 Lsafe_37
Lsafeback_38:
    v_mov_b32 v17, 2
    v_mov_b32 v19, 0
    s_barrier
    v_bfe_u32 v16, v0, 2, 1
    v_lshlrev_b32 v16, 7, v16
    v_and_b32 v18, 3, v0
    v_lshl_add_u32 v16, v18, 2, v16
    s_lshl_b32 s59, s40, 6
    s_lshl_b32 s43, s38, 4
    s_add_u32 s59, s59, s43
    s_add_u32 s59, s59, s50
    s_lshl2_add_u32 s57, s36, s40
    s_mul_i32 s57, s57, 114688
    s_lshl_b32 s43, s38, 13
    s_add_u32 s57, s57, s43
    s_add_u32 s57, s57, 8388608
    s_add_u32 s58, s57, 229376
    s_add_u32 s46, s57, 4096
    s_add_u32 s47, s58, 4096
    s_xor_b32 s49, s38, 1
    s_mul_i32 s49, s49, 6144
    s_add_u32 s49, s49, 98304
    v_add_u32 v12, s49, v1
    s_xor_b32 s49, s38, 2
    s_mul_i32 s49, s49, 6144
    s_add_u32 s49, s49, 100352
    v_add_u32 v13, s49, v1
    s_xor_b32 s49, s38, 3
    s_mul_i32 s49, s49, 6144
    s_add_u32 s49, s49, 102400
    v_add_u32 v14, s49, v1
    s_mul_i32 s49, s38, 6144
    s_add_u32 s49, s49, 98304
    v_add_u32 v15, s49, v1
    s_lshl2_add_u32 s48, s36, s40
    s_lshl2_add_u32 s49, s41, s38
    s_lshl_b32 s54, s48, 5
    s_add_u32 s54, s54, s49
    s_lshl_b32 s54, s54, 10
    s_add_u32 s54, s54, 4194304
    s_lshl_b32 s56, s40, 5
    s_add_u32 s56, s56, s49
    s_lshl2_add_u32 s56, s56, s50
    s_add_u32 s56, s56, 256
    s_waitcnt vmcnt(0)
    s_cmp_eq_u32 s39, 0
    s_cbranch_scc1 Lslow_70
    buffer_store_dword v17, v19, s[4:7], s42 offen offset:0
Ldual_70:
    s_lshl_b32 s55, s36, 17
    s_lshl_b32 s44, s38, 11
    s_add_u32 s55, s55, s44
    s_add_u32 s55, s55, 4194304
    s_add_u32 s92, s44, 98304
    s_mul_i32 s93, s36, 458752
    s_lshl2_add_u32 s45, s37, s38
    s_lshl_b32 s44, s45, 11
    s_add_u32 s93, s93, s44
    s_add_u32 s93, s93, 8388608
    s_lshl2_add_u32 s94, s45, s50
    s_cmp_ge_u32 s37, 14
    s_cselect_b32 s55, 0x70000000, s55
    s_cselect_b32 s93, 0x70000000, s93
    s_lshl_b32 s95, s52, 11
    s_add_u32 s95, s95, 262144
    s_lshl_b32 s101, s38, 5
    s_add_u32 s101, s101, s50
    s_add_u32 s101, s101, 2304
    buffer_load_dword v92, v16, s[4:7], s59 offen sc1
    s_waitcnt vmcnt(0)
    v_cmp_gt_u32 vcc, 2, v92
    s_cbranch_vccnz Lspin_39
Lback_40:
    buffer_load_dwordx4 v[52:55], v1, s[4:7], s57 offen offset:0 sc1
    buffer_load_dwordx4 v[56:59], v1, s[4:7], s57 offen offset:1024 sc1
    buffer_load_dwordx4 v[60:63], v1, s[4:7], s57 offen offset:2048 sc1
    buffer_load_dwordx4 v[64:67], v1, s[4:7], s57 offen offset:3072 sc1
    buffer_load_dwordx4 v[68:71], v1, s[4:7], s46 offen offset:0 sc1
    buffer_load_dwordx4 v[72:75], v1, s[4:7], s46 offen offset:1024 sc1
    buffer_load_dwordx4 v[76:79], v1, s[4:7], s46 offen offset:2048 sc1
    buffer_load_dwordx4 v[80:83], v1, s[4:7], s46 offen offset:3072 sc1
    buffer_load_dwordx4 v[84:87], v1, s[4:7], s58 offen offset:0 sc1
    buffer_load_dwordx4 v[88:91], v1, s[4:7], s58 offen offset:1024 sc1
    buffer_load_dwordx4 v[92:95], v1, s[4:7], s58 offen offset:2048 sc1
    v_lshlrev_b32 v16, 2, v0
    s_add_u32 s59, s50, 256
    s_waitcnt vmcnt(10)
    v_mfma_f32_32x32x16_bf16 v[20:35], v[96:99], v[52:55], 0
    v_mfma_f32_32x32x16_bf16 v[36:51], v[100:103], v[52:55], 0
    buffer_load_dwordx4 v[52:55], v1, s[4:7], s58 offen offset:3072 sc1
    s_waitcnt vmcnt(10)
    v_mfma_f32_32x32x16_bf16 v[20:35], v[104:107], v[56:59], v[20:35]
    v_mfma_f32_32x32x16_bf16 v[36:51], v[108:111], v[56:59], v[36:51]
    buffer_load_dwordx4 v[56:59], v1, s[4:7], s47 offen offset:0 sc1
    s_waitcnt vmcnt(10)
    v_mfma_f32_32x32x16_bf16 v[20:35], v[112:115], v[60:63], v[20:35]
    v_mfma_f32_32x32x16_bf16 v[36:51], v[116:119], v[60:63], v[36:51]
    buffer_load_dwordx4 v[60:63], v1, s[4:7], s47 offen offset:1024 sc1
    s_waitcnt vmcnt(10)
    v_mfma_f32_32x32x16_bf16 v[20:35], v[120:123], v[64:67], v[20:35]
    v_mfma_f32_32x32x16_bf16 v[36:51], v[124:127], v[64:67], v[36:51]
    buffer_load_dwordx4 v[64:67], v1, s[4:7], s47 offen offset:2048 sc1
    s_waitcnt vmcnt(10)
    v_mfma_f32_32x32x16_bf16 v[20:35], v[128:131], v[68:71], v[20:35]
    v_mfma_f32_32x32x16_bf16 v[36:51], v[132:135], v[68:71], v[36:51]
    buffer_load_dwordx4 v[68:71], v1, s[4:7], s47 offen offset:3072 sc1
    s_waitcnt vmcnt(10)
    v_mfma_f32_32x32x16_bf16 v[20:35], v[136:139], v[72:75], v[20:35]
    v_mfma_f32_32x32x16_bf16 v[36:51], v[140:143], v[72:75], v[36:51]
    s_waitcnt vmcnt(9)
    v_mfma_f32_32x32x16_bf16 v[20:35], v[144:147], v[76:79], v[20:35]
    v_mfma_f32_32x32x16_bf16 v[36:51], v[148:151], v[76:79], v[36:51]
    s_waitcnt vmcnt(8)
    v_mfma_f32_32x32x16_bf16 v[20:35], v[152:155], v[80:83], v[20:35]
    v_mfma_f32_32x32x16_bf16 v[36:51], v[156:159], v[80:83], v[36:51]
    v_lshlrev_b32 v72, 16, v4
    v_and_b32 v73, 0xffff0000, v4
    v_lshlrev_b32 v74, 16, v5
    v_and_b32 v75, 0xffff0000, v5
    v_lshlrev_b32 v76, 16, v6
    v_and_b32 v77, 0xffff0000, v6
    v_lshlrev_b32 v78, 16, v7
    v_and_b32 v79, 0xffff0000, v7
    s_nop 2
    ds_write_b128 v12, v[28:31] offset:0
    ds_write_b128 v12, v[32:35] offset:1024
    ds_write_b128 v13, v[36:39] offset:0
    ds_write_b128 v13, v[40:43] offset:1024
    ds_write_b128 v14, v[44:47] offset:0
    ds_write_b128 v14, v[48:51] offset:1024
    v_pk_add_f32 v[72:73], v[72:73], v[20:21]
    v_pk_add_f32 v[74:75], v[74:75], v[22:23]
    v_pk_add_f32 v[76:77], v[76:77], v[24:25]
    v_pk_add_f32 v[78:79], v[78:79], v[26:27]
    s_waitcnt vmcnt(7)
    v_mfma_f32_32x32x16_bf16 v[20:35], v[96:99], v[84:87], 0
    v_mfma_f32_32x32x16_bf16 v[36:51], v[100:103], v[84:87], 0
    s_waitcnt vmcnt(6)
    v_mfma_f32_32x32x16_bf16 v[20:35], v[104:107], v[88:91], v[20:35]
    v_mfma_f32_32x32x16_bf16 v[36:51], v[108:111], v[88:91], v[36:51]
    s_waitcnt vmcnt(5)
    v_mfma_f32_32x32x16_bf16 v[20:35], v[112:115], v[92:95], v[20:35]
    v_mfma_f32_32x32x16_bf16 v[36:51], v[116:119], v[92:95], v[36:51]
    s_waitcnt lgkmcnt(0)
    s_barrier
    s_waitcnt vmcnt(4)
    v_mfma_f32_32x32x16_bf16 v[20:35], v[120:123], v[52:55], v[20:35]
    ds_read_b128 v[96:99], v15 offset:0
    ds_read_b128 v[100:103], v15 offset:1024
    ds_read_b128 v[104:107], v15 offset:2048
    ds_read_b128 v[108:111], v15 offset:3072
    ds_read_b128 v[112:115], v15 offset:4096
    ds_read_b128 v[116:119], v15 offset:5120
    v_mfma_f32_32x32x16_bf16 v[36:51], v[124:127], v[52:55], v[36:51]
    s_waitcnt lgkmcnt(3)
    v_add_f32 v96, v96, v104
    v_add_f32 v97, v97, v105
    v_add_f32 v98, v98, v106
    v_add_f32 v99, v99, v107
    s_waitcnt lgkmcnt(2)
    v_add_f32 v100, v100, v108
    v_add_f32 v101, v101, v109
    s_waitcnt vmcnt(3)
    v_mfma_f32_32x32x16_bf16 v[20:35], v[128:131], v[56:59], v[20:35]
    v_add_f32 v102, v102, v110
    v_add_f32 v103, v103, v111
    s_waitcnt lgkmcnt(1)
    v_add_f32 v72, v72, v112
    v_add_f32 v73, v73, v113
    v_add_f32 v74, v74, v114
    v_add_f32 v75, v75, v115
    v_mfma_f32_32x32x16_bf16 v[36:51], v[132:135], v[56:59], v[36:51]
    s_waitcnt lgkmcnt(0)
    v_add_f32 v76, v76, v116
    v_add_f32 v77, v77, v117
    v_add_f32 v78, v78, v118
    v_add_f32 v79, v79, v119
    v_add_f32 v72, v72, v96
    v_add_f32 v73, v73, v97
    s_waitcnt vmcnt(2)
    v_mfma_f32_32x32x16_bf16 v[20:35], v[136:139], v[60:63], v[20:35]
    v_add_f32 v74, v74, v98
    v_add_f32 v75, v75, v99
    v_add_f32 v76, v76, v100
    v_add_f32 v77, v77, v101
    v_add_f32 v78, v78, v102
    v_add_f32 v79, v79, v103
    v_mfma_f32_32x32x16_bf16 v[36:51], v[140:143], v[60:63], v[36:51]
    v_cvt_pk_bf16_f32 v4, v72, v73
    v_cvt_pk_bf16_f32 v5, v74, v75
    v_cvt_pk_bf16_f32 v6, v76, v77
    v_cvt_pk_bf16_f32 v7, v78, v79
    s_cmp_eq_u32 s39, 0
    s_cbranch_scc1 Lslow_71
    buffer_store_dwordx4 v[4:7], v1, s[4:7], s54 offen
Ldual_71:
    v_mul_f32 v97, v72, v72
    s_waitcnt vmcnt(2)
    v_mfma_f32_32x32x16_bf16 v[20:35], v[144:147], v[64:67], v[20:35]
    v_add_f32 v96, v72, v73
    v_fmac_f32 v97, v73, v73
    v_add_f32 v96, v96, v74
    v_fmac_f32 v97, v74, v74
    v_add_f32 v96, v96, v75
    v_fmac_f32 v97, v75, v75
    v_mfma_f32_32x32x16_bf16 v[36:51], v[148:151], v[64:67], v[36:51]
    v_add_f32 v96, v96, v76
    v_fmac_f32 v97, v76, v76
    v_add_f32 v96, v96, v77
    v_fmac_f32 v97, v77, v77
    v_add_f32 v96, v96, v78
    v_fmac_f32 v97, v78, v78
    s_waitcnt vmcnt(1)
    v_mfma_f32_32x32x16_bf16 v[20:35], v[152:155], v[68:71], v[20:35]
    v_add_f32 v96, v96, v79
    v_fmac_f32 v97, v79, v79
    s_lshl_b32 s49, s38, 9
    s_add_u32 s49, s49, 156928
    v_lshl_add_u32 v98, v0, 3, s49
    ds_write_b64 v98, v[96:97]
    v_mfma_f32_32x32x16_bf16 v[36:51], v[156:159], v[68:71], v[36:51]
    v_lshlrev_b32 v52, 16, v8
    v_and_b32 v53, 0xffff0000, v8
    v_lshlrev_b32 v54, 16, v9
    v_and_b32 v55, 0xffff0000, v9
    v_lshlrev_b32 v56, 16, v10
    v_and_b32 v57, 0xffff0000, v10
    v_lshlrev_b32 v58, 16, v11
    v_and_b32 v59, 0xffff0000, v11
    ds_write_b128 v12, v[28:31] offset:24576
    ds_write_b128 v12, v[32:35] offset:25600
    s_nop 1
    ds_write_b128 v13, v[36:39] offset:24576
    ds_write_b128 v13, v[40:43] offset:25600
    ds_write_b128 v14, v[44:47] offset:24576
    ds_write_b128 v14, v[48:51] offset:25600
    v_pk_add_f32 v[52:53], v[52:53], v[20:21]
    v_pk_add_f32 v[54:55], v[54:55], v[22:23]
    v_pk_add_f32 v[56:57], v[56:57], v[24:25]
    v_pk_add_f32 v[58:59], v[58:59], v[26:27]
    s_add_u32 s54, s54, 65536
    s_waitcnt vmcnt(0)
    s_cmp_eq_u32 s39, 0
    s_cbranch_scc1 Lslow_72
    buffer_store_dword v17, v19, s[4:7], s56 offen offset:0
Ldual_72:
    s_waitcnt lgkmcnt(0)
    s_barrier
    ds_read_b128 v[124:127], v15 offset:24576
    ds_read_b128 v[128:131], v15 offset:25600
    ds_read_b128 v[132:135], v15 offset:26624
    ds_read_b128 v[136:139], v15 offset:27648
    ds_read_b128 v[140:143], v15 offset:28672
    ds_read_b128 v[144:147], v15 offset:29696
    buffer_load_dword v18, v16, s[4:7], s59 offen sc1
    s_waitcnt lgkmcnt(3)
    v_pk_add_f32 v[124:125], v[124:125], v[132:133]
    v_pk_add_f32 v[126:127], v[126:127], v[134:135]
    s_waitcnt lgkmcnt(2)
    v_pk_add_f32 v[128:129], v[128:129], v[136:137]
    v_pk_add_f32 v[130:131], v[130:131], v[138:139]
    s_waitcnt lgkmcnt(1)
    v_pk_add_f32 v[52:53], v[52:53], v[140:141]
    v_pk_add_f32 v[54:55], v[54:55], v[142:143]
    s_waitcnt lgkmcnt(0)
    v_pk_add_f32 v[56:57], v[56:57], v[144:145]
    v_pk_add_f32 v[58:59], v[58:59], v[146:147]
    v_pk_add_f32 v[52:53], v[52:53], v[124:125]
    v_pk_add_f32 v[54:55], v[54:55], v[126:127]
    v_pk_add_f32 v[56:57], v[56:57], v[128:129]
    v_pk_add_f32 v[58:59], v[58:59], v[130:131]
    buffer_load_dword v150, v16, s[4:7], s59 offen sc1
    v_cvt_pk_bf16_f32 v8, v52, v53
    v_cvt_pk_bf16_f32 v9, v54, v55
    v_cvt_pk_bf16_f32 v10, v56, v57
    v_cvt_pk_bf16_f32 v11, v58, v59
    s_cmp_eq_u32 s39, 0
    s_cbranch_scc1 Lslow_73
    buffer_store_dwordx4 v[8:11], v1, s[4:7], s54 offen
Ldual_73:
    v_pk_mul_f32 v[126:127], v[52:53], v[52:53]
    v_pk_add_f32 v[124:125], v[52:53], v[54:55]
    v_pk_fma_f32 v[126:127], v[54:55], v[54:55], v[126:127]
    v_pk_fma_f32 v[126:127], v[56:57], v[56:57], v[126:127]
    v_pk_fma_f32 v[126:127], v[58:59], v[58:59], v[126:127]
    v_pk_add_f32 v[124:125], v[124:125], v[56:57]
    v_pk_add_f32 v[124:125], v[124:125], v[58:59]
    v_add_f32 v124, v124, v125
    v_add_f32 v125, v126, v127
    s_lshl_b32 s49, s38, 9
    s_add_u32 s49, s49, 158976
    v_lshl_add_u32 v126, v0, 3, s49
    ds_write_b64 v126, v[124:125]
    buffer_load_dword v151, v16, s[4:7], s59 offen sc1
    s_waitcnt vmcnt(3)
    v_cmp_gt_u32 vcc, 2, v18
    s_cbranch_vccnz Lspin_41
Lback_42:
    s_add_u32 m0, s92, 0
    s_nop 0
    buffer_load_dwordx4 v1, s[4:7], s55 offen offset:0 sc1 lds
    buffer_load_dwordx4 v1, s[4:7], s55 offen offset:1024 sc1 lds
    s_add_u32 s55, s55, 8192
    s_add_u32 m0, s92, 8192
    s_nop 0
    buffer_load_dwordx4 v1, s[4:7], s55 offen offset:0 sc1 lds
    buffer_load_dwordx4 v1, s[4:7], s55 offen offset:1024 sc1 lds
    s_add_u32 s55, s55, 8192
    s_add_u32 m0, s92, 16384
    s_nop 0
    buffer_load_dwordx4 v1, s[4:7], s55 offen offset:0 sc1 lds
    buffer_load_dwordx4 v1, s[4:7], s55 offen offset:1024 sc1 lds
    s_add_u32 s55, s55, 8192
    v_add_u32 v12, 98304, v1
    v_mov_b32 v14, 0xbfb8aa3b
    s_waitcnt lgkmcnt(0)
    s_barrier
    s_add_u32 m0, s92, 24576
    s_nop 0
    buffer_load_dwordx4 v1, s[4:7], s55 offen offset:0 sc1 lds
    buffer_load_dwordx4 v1, s[4:7], s55 offen offset:1024 sc1 lds
    s_add_u32 s55, s55, 8192
    s_and_b32 s49, s38, 1
    s_lshl_b32 s48, s49, 11
    s_add_u32 s48, s48, 156928
    v_lshl_add_u32 v108, v0, 3, s48
    ds_read2st64_b64 v[100:103], v108 offset0:0 offset1:1
    ds_read2st64_b64 v[104:107], v108 offset0:2 offset1:3
    s_lshl1_add_u32 s48, s36, s49
    s_lshl1_add_u32 s48, s48, s40
    s_lshl3_add_u32 s48, s48, s41
    s_lshl_b32 s48, s48, 8
    s_add_u32 s48, s48, 262144
    s_cmp_lt_u32 s38, 2
    s_cselect_b32 s48, s48, 0x70000000
    v_and_b32 v109, 31, v0
    v_lshlrev_b32 v109, 3, v109
    s_waitcnt lgkmcnt(1)
    v_pk_add_f32 v[100:101], v[100:101], v[102:103]
    s_waitcnt lgkmcnt(0)
    v_pk_add_f32 v[104:105], v[104:105], v[106:107]
    v_pk_add_f32 v[100:101], v[100:101], v[104:105]
    v_mov_b32 v102, v100
    v_mov_b32 v103, v101
    s_nop 0
    v_permlane32_swap_b32 v102, v100
    v_permlane32_swap_b32 v103, v101
    v_pk_add_f32 v[100:101], v[100:101], v[102:103]
    s_cmp_eq_u32 s39, 0
    s_cbranch_scc1 Lslow_74
    buffer_store_dwordx2 v[100:101], v109, s[4:7], s48 offen
Ldual_74:
    s_waitcnt vmcnt(10)
    s_cmp_eq_u32 s39, 0
    s_cbranch_scc1 Lslow_75
    buffer_store_dword v17, v19, s[4:7], s56 offen offset:256
Ldual_75:
    v_lshrrev_b32 v13, 5, v0
    v_lshlrev_b32 v13, 10, v13
    v_and_b32 v15, 31, v0
    v_lshl_add_u32 v13, v15, 3, v13
    v_and_b32 v15, 7, v0
    v_lshlrev_b32 v15, 2, v15
    v_mov_b32 v85, 0
    v_mov_b32 v86, 0
    v_mov_b32 v87, 0
    v_mov_b32 v89, 0
    v_mov_b32 v90, 0
    v_mov_b32 v91, 0
    s_lshl_b32 s49, s38, 8
    s_add_u32 s49, s49, 148736
    v_lshl_add_u32 v94, v0, 2, s49
    ds_read_b32 v84, v94
    s_waitcnt vmcnt(8)
    s_barrier
    ds_read_b128 v[52:55], v12 offset:0
    s_add_u32 m0, s92, 32768
    ds_read_b128 v[56:59], v12 offset:1024
    buffer_load_dwordx4 v1, s[4:7], s55 offen offset:0 sc1 lds
    ds_read_b128 v[60:63], v12 offset:2048
    ds_read_b128 v[64:67], v12 offset:3072
    ds_read_b128 v[68:71], v12 offset:4096
    ds_read_b128 v[72:75], v12 offset:5120
    buffer_load_dwordx4 v1, s[4:7], s55 offen offset:1024 sc1 lds
    s_add_u32 s55, s55, 8192
    s_add_u32 s59, s59, 256
    s_waitcnt lgkmcnt(4)
    v_mfma_f32_32x32x16_bf16 v[20:35], a[224:227], v[52:55], 0
    ds_read_b128 v[76:79], v12 offset:6144
    s_lshl2_add_u32 s57, s36, s40
    s_mul_i32 s57, s57, 114688
    s_mul_i32 s48, s38, 28672
    s_add_u32 s57, s57, s48
    s_add_u32 s57, s57, 8388608
    s_add_u32 s58, s57, 229376
    v_mfma_f32_32x32x16_bf16 v[20:35], a[228:231], v[56:59], v[20:35]
    ds_read_b128 v[80:83], v12 offset:7168
    s_mul_i32 s0, s38, 56
    s_add_u32 s0, s0, s50
    s_add_u32 s0, s0, 1536
    s_waitcnt lgkmcnt(4)
    v_mfma_f32_32x32x16_bf16 v[20:35], a[232:235], v[60:63], v[20:35]
    s_waitcnt vmcnt(8)
    s_barrier
    ds_read_b128 v[52:55], v12 offset:8192
    s_waitcnt vmcnt(3)
    s_cmp_eq_u32 s39, 0
    s_cbranch_scc1 Lslow_76
    buffer_store_dword v17, v19, s[4:7], s3 offen offset:2304
Ldual_76:
    v_mfma_f32_32x32x16_bf16 v[20:35], a[236:239], v[64:67], v[20:35]
    s_add_u32 m0, s92, 40960
    ds_read_b128 v[56:59], v12 offset:9216
    buffer_load_dwordx4 v1, s[4:7], s55 offen offset:0 sc1 lds
    s_waitcnt lgkmcnt(4)
    v_mfma_f32_32x32x16_bf16 v[20:35], a[240:243], v[68:71], v[20:35]
    ds_read_b128 v[60:63], v12 offset:10240
    v_mfma_f32_32x32x16_bf16 v[20:35], a[244:247], v[72:75], v[20:35]
    ds_read_b128 v[64:67], v12 offset:11264
    s_waitcnt lgkmcnt(4)
    v_mfma_f32_32x32x16_bf16 v[20:35], a[248:251], v[76:79], v[20:35]
    ds_read_b128 v[68:71], v12 offset:12288
    v_mfma_f32_32x32x16_bf16 v[20:35], a[252:255], v[80:83], v[20:35]
    ds_read_b128 v[72:75], v12 offset:13312
    buffer_load_dwordx4 v1, s[4:7], s55 offen offset:1024 sc1 lds
    s_add_u32 s55, s55, 8192
    s_waitcnt lgkmcnt(4)
    v_mfma_f32_32x32x16_bf16 v[20:35], v[160:163], v[52:55], v[20:35]
    ds_read_b128 v[76:79], v12 offset:14336
    v_mfma_f32_32x32x16_bf16 v[20:35], v[164:167], v[56:59], v[20:35]
    ds_read_b128 v[80:83], v12 offset:15360
    s_waitcnt lgkmcnt(4)
    v_mfma_f32_32x32x16_bf16 v[20:35], v[168:171], v[60:63], v[20:35]
    s_barrier
    ds_read_b128 v[52:55], v12 offset:16384
    v_mfma_f32_32x32x16_bf16 v[20:35], v[172:175], v[64:67], v[20:35]
    s_add_u32 m0, s92, 0
    ds_read_b128 v[56:59], v12 offset:17408
    buffer_load_dwordx4 v1, s[4:7], s55 offen offset:0 sc1 lds
    buffer_load_dword v18, v15, s[4:7], s101 offen sc1
    s_waitcnt lgkmcnt(4)
    v_mfma_f32_32x32x16_bf16 v[20:35], v[176:179], v[68:71], v[20:35]
    ds_read_b128 v[60:63], v12 offset:18432
    v_mfma_f32_32x32x16_bf16 v[20:35], v[180:183], v[72:75], v[20:35]
    ds_read_b128 v[64:67], v12 offset:19456
    s_waitcnt lgkmcnt(4)
    v_mfma_f32_32x32x16_bf16 v[20:35], v[184:187], v[76:79], v[20:35]
    ds_read_b128 v[68:71], v12 offset:20480
    buffer_load_dword v112, v16, s[4:7], s59 offen sc1
    v_mfma_f32_32x32x16_bf16 v[20:35], v[188:191], v[80:83], v[20:35]
    ds_read_b128 v[72:75], v12 offset:21504
    buffer_load_dwordx4 v1, s[4:7], s55 offen offset:1024 sc1 lds
    s_add_u32 s55, s55, 8192
    s_waitcnt lgkmcnt(4)
    v_mfma_f32_32x32x16_bf16 v[20:35], v[192:195], v[52:55], v[20:35]
    ds_read_b128 v[76:79], v12 offset:22528
    v_mfma_f32_32x32x16_bf16 v[20:35], v[196:199], v[56:59], v[20:35]
    ds_read_b128 v[80:83], v12 offset:23552
    s_waitcnt lgkmcnt(4)
    v_mfma_f32_32x32x16_bf16 v[20:35], v[200:203], v[60:63], v[20:35]
    s_barrier
    ds_read_b128 v[52:55], v12 offset:24576
    s_waitcnt vmcnt(2)
    v_cmp_gt_u32 vcc, 2, v18
    s_cbranch_vccnz Lspin_43
Lback_44:
    v_mfma_f32_32x32x16_bf16 v[20:35], v[204:207], v[64:67], v[20:35]
    s_add_u32 m0, s92, 8192
    ds_read_b128 v[56:59], v12 offset:25600
    buffer_load_dwordx4 v1, s[4:7], s55 offen offset:0 sc1 lds
    buffer_load_dwordx2 v[100:101], v13, s[4:7], s95 offen offset:0 sc1
    s_waitcnt lgkmcnt(4)
    v_mfma_f32_32x32x16_bf16 v[20:35], v[208:211], v[68:71], v[20:35]
    ds_read_b128 v[60:63], v12 offset:26624
    buffer_load_dwordx2 v[102:103], v13, s[4:7], s95 offen offset:256 sc1
    buffer_load_dwordx2 v[104:105], v13, s[4:7], s95 offen offset:512 sc1
    v_mfma_f32_32x32x16_bf16 v[20:35], v[212:215], v[72:75], v[20:35]
    ds_read_b128 v[64:67], v12 offset:27648
    buffer_load_dwordx2 v[106:107], v13, s[4:7], s95 offen offset:768 sc1
    s_lshl_b32 s42, s38, 8
    s_add_u32 s42, s42, 149760
    v_and_b32 v15, 31, v0
    s_waitcnt lgkmcnt(4)
    v_mfma_f32_32x32x16_bf16 v[20:35], v[216:219], v[76:79], v[20:35]
    ds_read_b128 v[68:71], v12 offset:28672
    v_lshlrev_b32 v15, 2, v15
    v_add_u32 v108, s42, v15
    v_add_u32 v15, 149760, v15
    v_mfma_f32_32x32x16_bf16 v[20:35], v[220:223], v[80:83], v[20:35]
    ds_read_b128 v[72:75], v12 offset:29696
    buffer_load_dwordx4 v1, s[4:7], s55 offen offset:1024 sc1 lds
    s_add_u32 s55, s55, 8192
    s_waitcnt lgkmcnt(4)
    v_mfma_f32_32x32x16_bf16 v[20:35], v[224:227], v[52:55], v[20:35]
    ds_read_b128 v[76:79], v12 offset:30720
    v_mfma_f32_32x32x16_bf16 v[20:35], v[228:231], v[56:59], v[20:35]
    ds_read_b128 v[80:83], v12 offset:31744
    s_waitcnt vmcnt(7)
    v_cmp_gt_u32 vcc, 2, v112
    s_cbranch_vccnz Lspin_45
Lback_46:
    s_waitcnt lgkmcnt(4)
    v_mfma_f32_32x32x16_bf16 v[20:35], v[232:235], v[60:63], v[20:35]
    s_barrier
    ds_read_b128 v[52:55], v12 offset:32768
    v_min_u32 v16, 13, v0
    v_lshlrev_b32 v16, 2, v16
    s_lshl2_add_u32 s54, s36, s40
    s_lshl_b32 s54, s54, 15
    v_mfma_f32_32x32x16_bf16 v[20:35], v[236:239], v[64:67], v[20:35]
    s_add_u32 m0, s92, 16384
    ds_read_b128 v[56:59], v12 offset:33792
    buffer_load_dwordx4 v1, s[4:7], s55 offen offset:0 sc1 lds
    s_lshl2_add_u32 s49, s41, s38
    s_lshl_b32 s49, s49, 5
    s_add_u32 s54, s54, s49
    s_waitcnt lgkmcnt(4)
    v_mfma_f32_32x32x16_bf16 v[20:35], v[240:243], v[68:71], v[20:35]
    ds_read_b128 v[60:63], v12 offset:34816
    v_mfma_f32_32x32x16_bf16 v[20:35], v[244:247], v[72:75], v[20:35]
    ds_read_b128 v[64:67], v12 offset:35840
    s_waitcnt lgkmcnt(4)
    v_mfma_f32_32x32x16_bf16 v[20:35], v[248:251], v[76:79], v[20:35]
    ds_read_b128 v[68:71], v12 offset:36864
    s_waitcnt vmcnt(3)
    v_add_f32 v100, v100, v104
    v_add_f32 v101, v101, v105
    s_waitcnt vmcnt(2)
    v_add_f32 v102, v102, v106
    v_add_f32 v103, v103, v107
    v_add_f32 v116, v100, v102
    v_add_f32 v117, v101, v103
    v_mfma_f32_32x32x16_bf16 v[20:35], v[252:255], v[80:83], v[20:35]
    ds_read_b128 v[72:75], v12 offset:37888
    buffer_load_dwordx4 v1, s[4:7], s55 offen offset:1024 sc1 lds
    s_add_u32 s55, s55, 8192
    v_mov_b32 v100, v116
    v_mov_b32 v101, v117
    s_nop 0
    v_permlane32_swap_b32 v100, v116
    v_permlane32_swap_b32 v101, v117
    s_waitcnt lgkmcnt(4)
    v_mfma_f32_32x32x16_bf16 v[144:159], a[224:227], v[52:55], 0
    ds_read_b128 v[76:79], v12 offset:38912
    v_add_f32 v116, v116, v100
    v_add_f32 v117, v117, v101
    v_mul_f32 v102, 0xbb000000, v116
    v_mul_f32 v100, 0x3b000000, v117
    v_fma_f32 v100, -v102, v102, v100
    v_max_f32 v100, 0, v100
    v_mfma_f32_32x32x16_bf16 v[144:159], a[228:231], v[56:59], v[144:159]
    ds_read_b128 v[80:83], v12 offset:39936
    v_add_f32 v100, 0x3727c5ac, v100
    v_rsq_f32 v103, v100
    v_cvt_pk_bf16_f32 v100, v102, v102
    v_and_b32 v100, 0xffff0000, v100
    v_sub_f32 v100, v102, v100
    s_waitcnt lgkmcnt(4)
    v_mfma_f32_32x32x16_bf16 v[144:159], a[232:235], v[60:63], v[144:159]
    s_barrier
    ds_read_b128 v[52:55], v12 offset:40960
    v_cvt_pk_bf16_f32 v102, v102, v100
    v_mul_f32 v103, v14, v103
    ds_write2_b32 v108, v102, v103 offset0:0 offset1:32
    v_mfma_f32_32x32x16_bf16 v[144:159], a[236:239], v[64:67], v[144:159]
    s_add_u32 m0, s92, 24576
    ds_read_b128 v[56:59], v12 offset:41984
    buffer_load_dwordx4 v1, s[4:7], s55 offen offset:0 sc1 lds
    s_waitcnt lgkmcnt(5)
    v_mfma_f32_32x32x16_bf16 v[144:159], a[240:243], v[68:71], v[144:159]
    ds_read_b128 v[60:63], v12 offset:43008
    v_mfma_f32_32x32x16_bf16 v[144:159], a[244:247], v[72:75], v[144:159]
    ds_read_b128 v[64:67], v12 offset:44032
    s_waitcnt lgkmcnt(5)
    v_mfma_f32_32x32x16_bf16 v[144:159], a[248:251], v[76:79], v[144:159]
    ds_read_b128 v[68:71], v12 offset:45056
    v_mfma_f32_32x32x16_bf16 v[144:159], a[252:255], v[80:83], v[144:159]
    ds_read_b128 v[72:75], v12 offset:46080
    buffer_load_dwordx4 v1, s[4:7], s55 offen offset:1024 sc1 lds
    s_add_u32 s55, s55, 8192
    s_waitcnt lgkmcnt(4)
    v_mfma_f32_32x32x16_bf16 v[144:159], v[160:163], v[52:55], v[144:159]
    ds_read_b128 v[76:79], v12 offset:47104
    v_mfma_f32_32x32x16_bf16 v[144:159], v[164:167], v[56:59], v[144:159]
    ds_read_b128 v[80:83], v12 offset:48128
    s_waitcnt lgkmcnt(0)
    v_mfma_f32_32x32x16_bf16 v[144:159], v[168:171], v[60:63], v[144:159]
    s_barrier
    ds_read_b128 v[52:55], v12 offset:0
    ds_read_b32 v88, v15
    ds_read2st64_b32 v[92:93], v15 offset0:0 offset1:1
    ds_read2st64_b32 v[94:95], v15 offset0:2 offset1:3
    ds_read2_b32 v[96:97], v15 offset0:32 offset1:96
    ds_read2_b32 v[98:99], v15 offset0:160 offset1:224
    v_mfma_f32_32x32x16_bf16 v[144:159], v[172:175], v[64:67], v[144:159]
    s_add_u32 m0, s92, 32768
    ds_read_b128 v[56:59], v12 offset:1024
    buffer_load_dwordx4 v1, s[4:7], s55 offen offset:0 sc1 lds
    v_mfma_f32_32x32x16_bf16 v[144:159], v[176:179], v[68:71], v[144:159]
    ds_read_b128 v[60:63], v12 offset:2048
    v_mfma_f32_32x32x16_bf16 v[144:159], v[180:183], v[72:75], v[144:159]
    ds_read_b128 v[64:67], v12 offset:3072
    s_waitcnt lgkmcnt(7)
    v_mfma_f32_32x32x16_bf16 v[20:35], v[84:87], v[88:91], v[20:35]
    v_mfma_f32_32x32x16_bf16 v[144:159], v[184:187], v[76:79], v[144:159]
    ds_read_b128 v[68:71], v12 offset:4096
    v_mfma_f32_32x32x16_bf16 v[144:159], v[188:191], v[80:83], v[144:159]
    ds_read_b128 v[72:75], v12 offset:5120
    buffer_load_dwordx4 v1, s[4:7], s55 offen offset:1024 sc1 lds
    s_add_u32 s55, s55, 8192
    s_waitcnt lgkmcnt(6)
    s_nop 4
    v_mul_f32 v20, v20, v96
    v_mul_f32 v21, v21, v96
    v_mul_f32 v22, v22, v96
    s_waitcnt lgkmcnt(4)
    v_mfma_f32_32x32x16_bf16 v[144:159], v[192:195], v[52:55], v[144:159]
    ds_read_b128 v[76:79], v12 offset:6144
    v_exp_f32 v100, v20
    v_mul_f32 v23, v23, v96
    v_exp_f32 v101, v21
    v_mul_f32 v24, v24, v96
    v_mfma_f32_32x32x16_bf16 v[144:159], v[196:199], v[56:59], v[144:159]
    ds_read_b128 v[80:83], v12 offset:7168
    v_exp_f32 v102, v22
    v_fma_f32 v100, v100, v14, v14
    v_mul_f32 v25, v25, v96
    v_exp_f32 v103, v23
    s_waitcnt lgkmcnt(4)
    v_mfma_f32_32x32x16_bf16 v[144:159], v[200:203], v[60:63], v[144:159]
    s_waitcnt vmcnt(6)
    s_barrier
    ds_read_b128 v[52:55], v12 offset:8192
    v_fma_f32 v101, v101, v14, v14
    v_mul_f32 v26, v26, v96
    v_exp_f32 v104, v24
    v_mfma_f32_32x32x16_bf16 v[144:159], v[204:207], v[64:67], v[144:159]
    s_add_u32 m0, s92, 40960
    ds_read_b128 v[56:59], v12 offset:9216
    buffer_load_dwordx4 v1, s[4:7], s55 offen offset:0 sc1 lds
    v_fma_f32 v102, v102, v14, v14
    v_rcp_f32 v100, v100
    v_mul_f32 v27, v27, v96
    s_waitcnt lgkmcnt(4)
    v_mfma_f32_32x32x16_bf16 v[144:159], v[208:211], v[68:71], v[144:159]
    ds_read_b128 v[60:63], v12 offset:10240
    v_exp_f32 v105, v25
    v_fma_f32 v103, v103, v14, v14
    v_rcp_f32 v101, v101
    v_mul_f32 v28, v28, v96
    v_mfma_f32_32x32x16_bf16 v[144:159], v[212:215], v[72:75], v[144:159]
    ds_read_b128 v[64:67], v12 offset:11264
    v_exp_f32 v106, v26
    v_fma_f32 v104, v104, v14, v14
    v_rcp_f32 v102, v102
    v_mul_f32 v20, v20, v100
    s_waitcnt lgkmcnt(4)
    v_mfma_f32_32x32x16_bf16 v[144:159], v[216:219], v[76:79], v[144:159]
    ds_read_b128 v[68:71], v12 offset:12288
    v_mul_f32 v29, v29, v96
    v_exp_f32 v107, v27
    v_fma_f32 v105, v105, v14, v14
    v_rcp_f32 v103, v103
    v_mfma_f32_32x32x16_bf16 v[144:159], v[220:223], v[80:83], v[144:159]
    ds_read_b128 v[72:75], v12 offset:13312
    buffer_load_dwordx4 v1, s[4:7], s55 offen offset:1024 sc1 lds
    s_add_u32 s55, s55, 8192
    v_mul_f32 v21, v21, v101
    v_mul_f32 v30, v30, v96
    v_exp_f32 v108, v28
    s_waitcnt lgkmcnt(4)
    v_mfma_f32_32x32x16_bf16 v[144:159], v[224:227], v[52:55], v[144:159]
    ds_read_b128 v[76:79], v12 offset:14336
    v_fma_f32 v106, v106, v14, v14
    v_rcp_f32 v104, v104
    v_mul_f32 v22, v22, v102
    v_mul_f32 v31, v31, v96
    v_mfma_f32_32x32x16_bf16 v[144:159], v[228:231], v[56:59], v[144:159]
    ds_read_b128 v[80:83], v12 offset:15360
    v_exp_f32 v109, v29
    v_fma_f32 v107, v107, v14, v14
    v_rcp_f32 v105, v105
    v_mul_f32 v23, v23, v103
    s_waitcnt lgkmcnt(4)
    v_mfma_f32_32x32x16_bf16 v[144:159], v[232:235], v[60:63], v[144:159]
    s_waitcnt vmcnt(6)
    s_barrier
    ds_read_b128 v[52:55], v12 offset:16384
    v_cvt_pk_bf16_f32 v116, v20, v21
    v_mul_f32 v32, v32, v96
    v_exp_f32 v110, v30
    v_mfma_f32_32x32x16_bf16 v[144:159], v[236:239], v[64:67], v[144:159]
    s_add_u32 m0, s92, 0
    ds_read_b128 v[56:59], v12 offset:17408
    buffer_load_dwordx4 v1, s[4:7], s55 offen offset:0 sc1 lds
    v_fma_f32 v108, v108, v14, v14
    v_rcp_f32 v106, v106
    v_mul_f32 v24, v24, v104
    s_waitcnt lgkmcnt(4)
    v_mfma_f32_32x32x16_bf16 v[144:159], v[240:243], v[68:71], v[144:159]
    ds_read_b128 v[60:63], v12 offset:18432
    v_mov_b32 v88, v93
    v_mul_f32 v33, v33, v96
    v_exp_f32 v111, v31
    v_fma_f32 v109, v109, v14, v14
    v_mfma_f32_32x32x16_bf16 v[144:159], v[244:247], v[72:75], v[144:159]
    ds_read_b128 v[64:67], v12 offset:19456
    v_rcp_f32 v107, v107
    v_mul_f32 v25, v25, v105
    v_cvt_pk_bf16_f32 v117, v22, v23
    v_mul_f32 v34, v34, v96
    s_waitcnt lgkmcnt(4)
    v_mfma_f32_32x32x16_bf16 v[144:159], v[248:251], v[76:79], v[144:159]
    ds_read_b128 v[68:71], v12 offset:20480
    v_exp_f32 v112, v32
    v_fma_f32 v110, v110, v14, v14
    v_mfma_f32_32x32x16_bf16 v[144:159], v[84:87], v[88:91], v[144:159]
    v_rcp_f32 v108, v108
    v_mul_f32 v26, v26, v106
    v_mul_f32 v35, v35, v96
    v_exp_f32 v113, v33
    v_fma_f32 v111, v111, v14, v14
    v_mfma_f32_32x32x16_bf16 v[144:159], v[252:255], v[80:83], v[144:159]
    ds_read_b128 v[72:75], v12 offset:21504
    buffer_load_dwordx4 v1, s[4:7], s55 offen offset:1024 sc1 lds
    s_add_u32 s55, s55, 8192
    v_rcp_f32 v109, v109
    v_mul_f32 v27, v27, v107
    v_cvt_pk_bf16_f32 v118, v24, v25
    s_waitcnt lgkmcnt(4)
    v_mfma_f32_32x32x16_bf16 v[36:51], a[224:227], v[52:55], 0
    ds_read_b128 v[76:79], v12 offset:22528
    v_exp_f32 v114, v34
    v_fma_f32 v112, v112, v14, v14
    v_rcp_f32 v110, v110
    v_mul_f32 v28, v28, v108
    v_mfma_f32_32x32x16_bf16 v[36:51], a[228:231], v[56:59], v[36:51]
    ds_read_b128 v[80:83], v12 offset:23552
    v_exp_f32 v115, v35
    v_fma_f32 v113, v113, v14, v14
    v_rcp_f32 v111, v111
    v_mul_f32 v29, v29, v109
    s_waitcnt lgkmcnt(4)
    v_mfma_f32_32x32x16_bf16 v[36:51], a[232:235], v[60:63], v[36:51]
    s_waitcnt vmcnt(6)
    s_barrier
    ds_read_b128 v[52:55], v12 offset:24576
    v_cvt_pk_bf16_f32 v119, v26, v27
    v_fma_f32 v114, v114, v14, v14
    v_rcp_f32 v112, v112
    v_mfma_f32_32x32x16_bf16 v[36:51], a[236:239], v[64:67], v[36:51]
    s_add_u32 m0, s92, 8192
    ds_read_b128 v[56:59], v12 offset:25600
    buffer_load_dwordx4 v1, s[4:7], s55 offen offset:0 sc1 lds
    v_mul_f32 v30, v30, v110
    v_fma_f32 v115, v115, v14, v14
    v_rcp_f32 v113, v113
    s_waitcnt lgkmcnt(4)
    v_mfma_f32_32x32x16_bf16 v[36:51], a[240:243], v[68:71], v[36:51]
    ds_read_b128 v[60:63], v12 offset:26624
    v_mul_f32 v31, v31, v111
    v_cvt_pk_bf16_f32 v120, v28, v29
    v_rcp_f32 v114, v114
    v_mul_f32 v32, v32, v112
    v_mfma_f32_32x32x16_bf16 v[36:51], a[244:247], v[72:75], v[36:51]
    ds_read_b128 v[64:67], v12 offset:27648
    v_rcp_f32 v115, v115
    v_mul_f32 v33, v33, v113
    v_cvt_pk_bf16_f32 v121, v30, v31
    v_mul_f32 v34, v34, v114
    v_mul_f32 v35, v35, v115
    s_waitcnt lgkmcnt(4)
    v_mfma_f32_32x32x16_bf16 v[36:51], a[248:251], v[76:79], v[36:51]
    ds_read_b128 v[68:71], v12 offset:28672
    v_cvt_pk_bf16_f32 v122, v32, v33
    v_cvt_pk_bf16_f32 v123, v34, v35
    v_mfma_f32_32x32x16_bf16 v[36:51], a[252:255], v[80:83], v[36:51]
    ds_read_b128 v[72:75], v12 offset:29696
    buffer_load_dwordx4 v1, s[4:7], s55 offen offset:1024 sc1 lds
    s_add_u32 s55, s55, 8192
    s_waitcnt lgkmcnt(4)
    v_mfma_f32_32x32x16_bf16 v[36:51], v[160:163], v[52:55], v[36:51]
    ds_read_b128 v[76:79], v12 offset:30720
    s_cmp_eq_u32 s39, 0
    s_cbranch_scc1 Lslow_77
    buffer_store_dwordx4 v[116:119], v1, s[4:7], s93 offen offset:0
    buffer_store_dwordx4 v[120:123], v1, s[4:7], s93 offen offset:1024
Ldual_77:
    s_add_u32 s93, s93, 114688
    v_mul_f32 v144, v144, v97
    v_mfma_f32_32x32x16_bf16 v[36:51], v[164:167], v[56:59], v[36:51]
    ds_read_b128 v[80:83], v12 offset:31744
    v_mul_f32 v145, v145, v97
    v_mul_f32 v146, v146, v97
    v_exp_f32 v100, v144
    v_mul_f32 v147, v147, v97
    s_waitcnt lgkmcnt(4)
    v_mfma_f32_32x32x16_bf16 v[36:51], v[168:171], v[60:63], v[36:51]
    s_waitcnt vmcnt(8)
    s_barrier
    ds_read_b128 v[52:55], v12 offset:32768
    v_exp_f32 v101, v145
    v_mul_f32 v148, v148, v97
    v_mfma_f32_32x32x16_bf16 v[36:51], v[172:175], v[64:67], v[36:51]
    s_add_u32 m0, s92, 16384
    ds_read_b128 v[56:59], v12 offset:33792
    buffer_load_dwordx4 v1, s[4:7], s55 offen offset:0 sc1 lds
    v_exp_f32 v102, v146
    v_fma_f32 v100, v100, v14, v14
    v_mul_f32 v149, v149, v97
    s_waitcnt lgkmcnt(4)
    v_mfma_f32_32x32x16_bf16 v[36:51], v[176:179], v[68:71], v[36:51]
    ds_read_b128 v[60:63], v12 offset:34816
    v_exp_f32 v103, v147
    v_fma_f32 v101, v101, v14, v14
    v_mul_f32 v150, v150, v97
    v_exp_f32 v104, v148
    v_mfma_f32_32x32x16_bf16 v[36:51], v[180:183], v[72:75], v[36:51]
    ds_read_b128 v[64:67], v12 offset:35840
    v_fma_f32 v102, v102, v14, v14
    v_rcp_f32 v100, v100
    v_mul_f32 v151, v151, v97
    v_exp_f32 v105, v149
    s_waitcnt lgkmcnt(4)
    v_mfma_f32_32x32x16_bf16 v[36:51], v[184:187], v[76:79], v[36:51]
    ds_read_b128 v[68:71], v12 offset:36864
    v_fma_f32 v103, v103, v14, v14
    v_rcp_f32 v101, v101
    v_mul_f32 v152, v152, v97
    v_exp_f32 v106, v150
    v_mfma_f32_32x32x16_bf16 v[36:51], v[188:191], v[80:83], v[36:51]
    ds_read_b128 v[72:75], v12 offset:37888
    buffer_load_dwordx4 v1, s[4:7], s55 offen offset:1024 sc1 lds
    s_add_u32 s55, s55, 8192
    v_fma_f32 v104, v104, v14, v14
    v_rcp_f32 v102, v102
    v_mul_f32 v144, v144, v100
    s_waitcnt lgkmcnt(4)
    v_mfma_f32_32x32x16_bf16 v[36:51], v[192:195], v[52:55], v[36:51]
    ds_read_b128 v[76:79], v12 offset:38912
    v_mul_f32 v153, v153, v97
    v_exp_f32 v107, v151
    v_fma_f32 v105, v105, v14, v14
    v_rcp_f32 v103, v103
    v_mfma_f32_32x32x16_bf16 v[36:51], v[196:199], v[56:59], v[36:51]
    ds_read_b128 v[80:83], v12 offset:39936
    v_mul_f32 v145, v145, v101
    v_mul_f32 v154, v154, v97
    v_exp_f32 v108, v152
    v_fma_f32 v106, v106, v14, v14
    s_waitcnt lgkmcnt(4)
    v_mfma_f32_32x32x16_bf16 v[36:51], v[200:203], v[60:63], v[36:51]
    s_waitcnt vmcnt(8)
    s_barrier
    ds_read_b128 v[52:55], v12 offset:40960
    v_rcp_f32 v104, v104
    v_mul_f32 v146, v146, v102
    v_mul_f32 v155, v155, v97
    v_mfma_f32_32x32x16_bf16 v[36:51], v[204:207], v[64:67], v[36:51]
    s_add_u32 m0, s92, 24576
    ds_read_b128 v[56:59], v12 offset:41984
    buffer_load_dwordx4 v1, s[4:7], s55 offen offset:0 sc1 lds
    v_exp_f32 v109, v153
    v_fma_f32 v107, v107, v14, v14
    s_waitcnt lgkmcnt(4)
    v_mfma_f32_32x32x16_bf16 v[36:51], v[208:211], v[68:71], v[36:51]
    ds_read_b128 v[60:63], v12 offset:43008
    v_rcp_f32 v105, v105
    v_mul_f32 v147, v147, v103
    v_cvt_pk_bf16_f32 v116, v144, v145
    v_mul_f32 v156, v156, v97
    v_mfma_f32_32x32x16_bf16 v[36:51], v[212:215], v[72:75], v[36:51]
    ds_read_b128 v[64:67], v12 offset:44032
    v_exp_f32 v110, v154
    v_fma_f32 v108, v108, v14, v14
    v_rcp_f32 v106, v106
    v_mul_f32 v148, v148, v104
    s_waitcnt lgkmcnt(4)
    v_mfma_f32_32x32x16_bf16 v[36:51], v[216:219], v[76:79], v[36:51]
    ds_read_b128 v[68:71], v12 offset:45056
    v_mul_f32 v157, v157, v97
    v_exp_f32 v111, v155
    v_fma_f32 v109, v109, v14, v14
    v_rcp_f32 v107, v107
    v_mfma_f32_32x32x16_bf16 v[36:51], v[220:223], v[80:83], v[36:51]
    ds_read_b128 v[72:75], v12 offset:46080
    buffer_load_dwordx4 v1, s[4:7], s55 offen offset:1024 sc1 lds
    s_add_u32 s55, s55, 8192
    v_mul_f32 v149, v149, v105
    v_cvt_pk_bf16_f32 v117, v146, v147
    v_mul_f32 v158, v158, v97
    s_waitcnt lgkmcnt(4)
    v_mfma_f32_32x32x16_bf16 v[36:51], v[224:227], v[52:55], v[36:51]
    ds_read_b128 v[76:79], v12 offset:47104
    v_exp_f32 v112, v156
    v_fma_f32 v110, v110, v14, v14
    v_rcp_f32 v108, v108
    v_mul_f32 v150, v150, v106
    v_mfma_f32_32x32x16_bf16 v[36:51], v[228:231], v[56:59], v[36:51]
    ds_read_b128 v[80:83], v12 offset:48128
    v_mul_f32 v159, v159, v97
    v_exp_f32 v113, v157
    v_fma_f32 v111, v111, v14, v14
    v_rcp_f32 v109, v109
    s_waitcnt lgkmcnt(4)
    v_mfma_f32_32x32x16_bf16 v[36:51], v[232:235], v[60:63], v[36:51]
    s_waitcnt vmcnt(8)
    s_barrier
    ds_read_b128 v[52:55], v12 offset:0
    v_mul_f32 v151, v151, v107
    v_cvt_pk_bf16_f32 v118, v148, v149
    v_exp_f32 v114, v158
    v_mfma_f32_32x32x16_bf16 v[36:51], v[236:239], v[64:67], v[36:51]
    ds_read_b128 v[56:59], v12 offset:1024
    v_fma_f32 v112, v112, v14, v14
    v_rcp_f32 v110, v110
    v_mul_f32 v152, v152, v108
    v_exp_f32 v115, v159
    s_waitcnt lgkmcnt(4)
    v_mfma_f32_32x32x16_bf16 v[36:51], v[240:243], v[68:71], v[36:51]
    ds_read_b128 v[60:63], v12 offset:2048
    v_mov_b32 v88, v94
    v_fma_f32 v113, v113, v14, v14
    v_rcp_f32 v111, v111
    v_mul_f32 v153, v153, v109
    v_cvt_pk_bf16_f32 v119, v150, v151
    v_mfma_f32_32x32x16_bf16 v[36:51], v[244:247], v[72:75], v[36:51]
    ds_read_b128 v[64:67], v12 offset:3072
    v_fma_f32 v114, v114, v14, v14
    v_rcp_f32 v112, v112
    v_mul_f32 v154, v154, v110
    v_fma_f32 v115, v115, v14, v14
    s_waitcnt lgkmcnt(4)
    v_mfma_f32_32x32x16_bf16 v[36:51], v[248:251], v[76:79], v[36:51]
    ds_read_b128 v[68:71], v12 offset:4096
    v_rcp_f32 v113, v113
    v_mul_f32 v155, v155, v111
    v_cvt_pk_bf16_f32 v120, v152, v153
    v_mfma_f32_32x32x16_bf16 v[36:51], v[84:87], v[88:91], v[36:51]
    v_rcp_f32 v114, v114
    v_mul_f32 v156, v156, v112
    v_rcp_f32 v115, v115
    v_mul_f32 v157, v157, v113
    v_cvt_pk_bf16_f32 v121, v154, v155
    v_mfma_f32_32x32x16_bf16 v[36:51], v[252:255], v[80:83], v[36:51]
    ds_read_b128 v[72:75], v12 offset:5120
    v_mul_f32 v158, v158, v114
    v_mul_f32 v159, v159, v115
    v_cvt_pk_bf16_f32 v122, v156, v157
    v_cvt_pk_bf16_f32 v123, v158, v159
    s_waitcnt lgkmcnt(4)
    v_mfma_f32_32x32x16_bf16 v[20:35], a[224:227], v[52:55], 0
    ds_read_b128 v[76:79], v12 offset:6144
    s_cmp_eq_u32 s39, 0
    s_cbranch_scc1 Lslow_78
    buffer_store_dwordx4 v[116:119], v1, s[4:7], s93 offen offset:0
    buffer_store_dwordx4 v[120:123], v1, s[4:7], s93 offen offset:1024
Ldual_78:
    s_add_u32 s93, s93, 114688
    v_mfma_f32_32x32x16_bf16 v[20:35], a[228:231], v[56:59], v[20:35]
    ds_read_b128 v[80:83], v12 offset:7168
    s_waitcnt lgkmcnt(4)
    v_mfma_f32_32x32x16_bf16 v[20:35], a[232:235], v[60:63], v[20:35]
    s_waitcnt vmcnt(8)
    s_barrier
    ds_read_b128 v[52:55], v12 offset:8192
    v_mul_f32 v36, v36, v98
    v_mul_f32 v37, v37, v98
    v_mul_f32 v38, v38, v98
    v_mfma_f32_32x32x16_bf16 v[20:35], a[236:239], v[64:67], v[20:35]
    ds_read_b128 v[56:59], v12 offset:9216
    v_exp_f32 v100, v36
    v_mul_f32 v39, v39, v98
    v_exp_f32 v101, v37
    s_waitcnt lgkmcnt(4)
    v_mfma_f32_32x32x16_bf16 v[20:35], a[240:243], v[68:71], v[20:35]
    ds_read_b128 v[60:63], v12 offset:10240
    v_mul_f32 v40, v40, v98
    v_exp_f32 v102, v38
    v_fma_f32 v100, v100, v14, v14
    v_mul_f32 v41, v41, v98
    v_mfma_f32_32x32x16_bf16 v[20:35], a[244:247], v[72:75], v[20:35]
    ds_read_b128 v[64:67], v12 offset:11264
    v_exp_f32 v103, v39
    v_fma_f32 v101, v101, v14, v14
    v_mul_f32 v42, v42, v98
    s_waitcnt lgkmcnt(4)
    v_mfma_f32_32x32x16_bf16 v[20:35], a[248:251], v[76:79], v[20:35]
    ds_read_b128 v[68:71], v12 offset:12288
    v_exp_f32 v104, v40
    v_fma_f32 v102, v102, v14, v14
    v_rcp_f32 v100, v100
    v_mfma_f32_32x32x16_bf16 v[20:35], a[252:255], v[80:83], v[20:35]
    ds_read_b128 v[72:75], v12 offset:13312
    v_mul_f32 v43, v43, v98
    v_exp_f32 v105, v41
    v_fma_f32 v103, v103, v14, v14
    s_waitcnt lgkmcnt(4)
    v_mfma_f32_32x32x16_bf16 v[20:35], v[160:163], v[52:55], v[20:35]
    ds_read_b128 v[76:79], v12 offset:14336
    v_rcp_f32 v101, v101
    v_mul_f32 v44, v44, v98
    v_exp_f32 v106, v42
    v_mfma_f32_32x32x16_bf16 v[20:35], v[164:167], v[56:59], v[20:35]
    ds_read_b128 v[80:83], v12 offset:15360
    s_waitcnt vmcnt(0)
    s_cmp_eq_u32 s39, 0
    s_cbranch_scc1 Lslow_79
    buffer_store_dword v17, v19, s[4:7], s94 offen offset:1536
Ldual_79:
    v_fma_f32 v104, v104, v14, v14
    v_rcp_f32 v102, v102
    v_mul_f32 v36, v36, v100
    v_mul_f32 v45, v45, v98
    s_waitcnt lgkmcnt(4)
    v_mfma_f32_32x32x16_bf16 v[20:35], v[168:171], v[60:63], v[20:35]
    s_barrier
    ds_read_b128 v[52:55], v12 offset:16384
    v_exp_f32 v107, v43
    v_fma_f32 v105, v105, v14, v14
    v_mfma_f32_32x32x16_bf16 v[20:35], v[172:175], v[64:67], v[20:35]
    ds_read_b128 v[56:59], v12 offset:17408
    v_rcp_f32 v103, v103
    v_mul_f32 v37, v37, v101
    v_mul_f32 v46, v46, v98
    s_waitcnt lgkmcnt(4)
    v_mfma_f32_32x32x16_bf16 v[20:35], v[176:179], v[68:71], v[20:35]
    ds_read_b128 v[60:63], v12 offset:18432
    v_exp_f32 v108, v44
    v_fma_f32 v106, v106, v14, v14
    v_rcp_f32 v104, v104
    v_mfma_f32_32x32x16_bf16 v[20:35], v[180:183], v[72:75], v[20:35]
    ds_read_b128 v[64:67], v12 offset:19456
    v_mul_f32 v38, v38, v102
    v_mul_f32 v47, v47, v98
    v_exp_f32 v109, v45
    v_fma_f32 v107, v107, v14, v14
    s_waitcnt lgkmcnt(4)
    v_mfma_f32_32x32x16_bf16 v[20:35], v[184:187], v[76:79], v[20:35]
    ds_read_b128 v[68:71], v12 offset:20480
    v_rcp_f32 v105, v105
    v_mul_f32 v39, v39, v103
    v_cvt_pk_bf16_f32 v116, v36, v37
    v_mul_f32 v48, v48, v98
    v_mfma_f32_32x32x16_bf16 v[20:35], v[188:191], v[80:83], v[20:35]
    ds_read_b128 v[72:75], v12 offset:21504
    v_exp_f32 v110, v46
    v_fma_f32 v108, v108, v14, v14
    v_rcp_f32 v106, v106
    s_waitcnt lgkmcnt(4)
    v_mfma_f32_32x32x16_bf16 v[20:35], v[192:195], v[52:55], v[20:35]
    ds_read_b128 v[76:79], v12 offset:22528
    v_mul_f32 v40, v40, v104
    v_mul_f32 v49, v49, v98
    v_exp_f32 v111, v47
    v_fma_f32 v109, v109, v14, v14
    v_mfma_f32_32x32x16_bf16 v[20:35], v[196:199], v[56:59], v[20:35]
    ds_read_b128 v[80:83], v12 offset:23552
    buffer_load_dword v18, v16, s[4:7], s0 offen sc1
    v_rcp_f32 v107, v107
    v_mul_f32 v41, v41, v105
    v_cvt_pk_bf16_f32 v117, v38, v39
    v_mul_f32 v50, v50, v98
    s_waitcnt lgkmcnt(4)
    v_mfma_f32_32x32x16_bf16 v[20:35], v[200:203], v[60:63], v[20:35]
    s_barrier
    ds_read_b128 v[52:55], v12 offset:24576
    v_exp_f32 v112, v48
    v_fma_f32 v110, v110, v14, v14
    v_mfma_f32_32x32x16_bf16 v[20:35], v[204:207], v[64:67], v[20:35]
    ds_read_b128 v[56:59], v12 offset:25600
    v_rcp_f32 v108, v108
    v_mul_f32 v42, v42, v106
    v_mul_f32 v51, v51, v98
    s_waitcnt lgkmcnt(4)
    v_mfma_f32_32x32x16_bf16 v[20:35], v[208:211], v[68:71], v[20:35]
    ds_read_b128 v[60:63], v12 offset:26624
    v_exp_f32 v113, v49
    v_fma_f32 v111, v111, v14, v14
    v_rcp_f32 v109, v109
    v_mfma_f32_32x32x16_bf16 v[20:35], v[212:215], v[72:75], v[20:35]
    ds_read_b128 v[64:67], v12 offset:27648
    v_mul_f32 v43, v43, v107
    v_cvt_pk_bf16_f32 v118, v40, v41
    v_exp_f32 v114, v50
    v_fma_f32 v112, v112, v14, v14
    s_waitcnt lgkmcnt(4)
    v_mfma_f32_32x32x16_bf16 v[20:35], v[216:219], v[76:79], v[20:35]
    ds_read_b128 v[68:71], v12 offset:28672
    v_rcp_f32 v110, v110
    v_mul_f32 v44, v44, v108
    v_exp_f32 v115, v51
    v_mfma_f32_32x32x16_bf16 v[20:35], v[220:223], v[80:83], v[20:35]
    ds_read_b128 v[72:75], v12 offset:29696
    v_fma_f32 v113, v113, v14, v14
    v_rcp_f32 v111, v111
    v_mul_f32 v45, v45, v109
    v_cvt_pk_bf16_f32 v119, v42, v43
    s_waitcnt lgkmcnt(4)
    v_mfma_f32_32x32x16_bf16 v[20:35], v[224:227], v[52:55], v[20:35]
    ds_read_b128 v[76:79], v12 offset:30720
    v_fma_f32 v114, v114, v14, v14
    v_rcp_f32 v112, v112
    v_mul_f32 v46, v46, v110
    v_fma_f32 v115, v115, v14, v14
    v_mfma_f32_32x32x16_bf16 v[20:35], v[228:231], v[56:59], v[20:35]
    ds_read_b128 v[80:83], v12 offset:31744
    s_waitcnt vmcnt(0)
    v_cmp_gt_u32 vcc, 2, v18
    s_cbranch_vccnz Lspin_47
Lback_48:
    v_rcp_f32 v113, v113
    v_mul_f32 v47, v47, v111
    v_cvt_pk_bf16_f32 v120, v44, v45
    s_waitcnt lgkmcnt(4)
    v_mfma_f32_32x32x16_bf16 v[20:35], v[232:235], v[60:63], v[20:35]
    v_rcp_f32 v114, v114
    v_mul_f32 v48, v48, v112
    v_rcp_f32 v115, v115
    v_mul_f32 v49, v49, v113
    buffer_load_dwordx4 v[132:135], v1, s[4:7], s57 offen offset:0 sc1
    v_mfma_f32_32x32x16_bf16 v[20:35], v[236:239], v[64:67], v[20:35]
    v_cvt_pk_bf16_f32 v121, v46, v47
    v_mul_f32 v50, v50, v114
    v_mul_f32 v51, v51, v115
    v_cvt_pk_bf16_f32 v122, v48, v49
    v_cvt_pk_bf16_f32 v123, v50, v51
    s_waitcnt lgkmcnt(2)
    v_mfma_f32_32x32x16_bf16 v[20:35], v[240:243], v[68:71], v[20:35]
    v_mov_b32 v88, v95
    s_cmp_eq_u32 s39, 0
    s_cbranch_scc1 Lslow_80
    buffer_store_dwordx4 v[116:119], v1, s[4:7], s93 offen offset:0
    buffer_store_dwordx4 v[120:123], v1, s[4:7], s93 offen offset:1024
Ldual_80:
    s_add_u32 s93, s93, 114688
    buffer_load_dwordx4 v[136:139], v1, s[4:7], s57 offen offset:1024 sc1
    v_mfma_f32_32x32x16_bf16 v[20:35], v[244:247], v[72:75], v[20:35]
    s_waitcnt lgkmcnt(0)
    v_mfma_f32_32x32x16_bf16 v[20:35], v[248:251], v[76:79], v[20:35]
    v_mfma_f32_32x32x16_bf16 v[20:35], v[84:87], v[88:91], v[20:35]
    buffer_load_dwordx4 v[140:143], v1, s[4:7], s57 offen offset:2048 sc1
    v_mfma_f32_32x32x16_bf16 v[20:35], v[252:255], v[80:83], v[20:35]
    s_nop 11
    v_mul_f32 v20, v20, v99
    v_mul_f32 v21, v21, v99
    v_mul_f32 v22, v22, v99
    v_exp_f32 v100, v20
    v_mul_f32 v23, v23, v99
    v_exp_f32 v101, v21
    v_mul_f32 v24, v24, v99
    buffer_load_dwordx4 v[128:131], v1, s[4:7], s57 offen offset:3072 sc1
    s_add_u32 s57, s57, 4096
    v_exp_f32 v102, v22
    v_fma_f32 v100, v100, v14, v14
    v_mul_f32 v25, v25, v99
    v_exp_f32 v103, v23
    v_fma_f32 v101, v101, v14, v14
    v_mul_f32 v26, v26, v99
    v_exp_f32 v104, v24
    buffer_load_dwordx4 v[124:127], v1, s[4:7], s57 offen offset:0 sc1
    v_fma_f32 v102, v102, v14, v14
    v_rcp_f32 v100, v100
    v_mul_f32 v27, v27, v99
    v_exp_f32 v105, v25
    v_fma_f32 v103, v103, v14, v14
    v_rcp_f32 v101, v101
    v_mul_f32 v28, v28, v99
    buffer_load_dwordx4 v[144:147], v1, s[4:7], s57 offen offset:1024 sc1
    v_exp_f32 v106, v26
    v_fma_f32 v104, v104, v14, v14
    v_rcp_f32 v102, v102
    v_mul_f32 v20, v20, v100
    v_mul_f32 v29, v29, v99
    v_exp_f32 v107, v27
    v_fma_f32 v105, v105, v14, v14
    buffer_load_dwordx4 v[148:151], v1, s[4:7], s57 offen offset:2048 sc1
    s_waitcnt vmcnt(8)
    v_mfma_f32_32x32x16_bf16 v[52:67], a[0:3], v[132:135], 0
    v_rcp_f32 v103, v103
    v_mul_f32 v21, v21, v101
    v_mul_f32 v30, v30, v99
    v_exp_f32 v108, v28
    v_fma_f32 v106, v106, v14, v14
    v_rcp_f32 v104, v104
    v_mul_f32 v22, v22, v102
    v_mul_f32 v31, v31, v99
    buffer_load_dwordx4 v[152:155], v1, s[4:7], s57 offen offset:3072 sc1
    s_add_u32 s57, s57, 4096
    v_mfma_f32_32x32x16_bf16 v[68:83], a[4:7], v[132:135], 0
    v_exp_f32 v109, v29
    v_fma_f32 v107, v107, v14, v14
    v_rcp_f32 v105, v105
    v_mul_f32 v23, v23, v103
    v_cvt_pk_bf16_f32 v116, v20, v21
    v_mul_f32 v32, v32, v99
    v_exp_f32 v110, v30
    v_fma_f32 v108, v108, v14, v14
    buffer_load_dwordx4 v[156:159], v1, s[4:7], s57 offen offset:0 sc1
    s_waitcnt vmcnt(7)
    v_mfma_f32_32x32x16_bf16 v[52:67], a[8:11], v[136:139], v[52:67]
    v_rcp_f32 v106, v106
    v_mul_f32 v24, v24, v104
    v_mul_f32 v33, v33, v99
    v_exp_f32 v111, v31
    v_fma_f32 v109, v109, v14, v14
    v_rcp_f32 v107, v107
    v_mul_f32 v25, v25, v105
    v_cvt_pk_bf16_f32 v117, v22, v23
    v_mul_f32 v34, v34, v99
    buffer_load_dwordx4 v[36:39], v1, s[4:7], s57 offen offset:1024 sc1
    v_mfma_f32_32x32x16_bf16 v[68:83], a[12:15], v[136:139], v[68:83]
    v_exp_f32 v112, v32
    v_fma_f32 v110, v110, v14, v14
    v_rcp_f32 v108, v108
    v_mul_f32 v26, v26, v106
    v_mul_f32 v35, v35, v99
    v_exp_f32 v113, v33
    v_fma_f32 v111, v111, v14, v14
    v_rcp_f32 v109, v109
    buffer_load_dwordx4 v[40:43], v1, s[4:7], s57 offen offset:2048 sc1
    s_waitcnt vmcnt(8)
    v_mfma_f32_32x32x16_bf16 v[52:67], a[16:19], v[140:143], v[52:67]
    v_mul_f32 v27, v27, v107
    v_cvt_pk_bf16_f32 v118, v24, v25
    v_exp_f32 v114, v34
    v_fma_f32 v112, v112, v14, v14
    v_rcp_f32 v110, v110
    v_mul_f32 v28, v28, v108
    v_exp_f32 v115, v35
    v_fma_f32 v113, v113, v14, v14
    buffer_load_dwordx4 v[44:47], v1, s[4:7], s57 offen offset:3072 sc1
    s_add_u32 s57, s57, 4096
    v_mfma_f32_32x32x16_bf16 v[68:83], a[20:23], v[140:143], v[68:83]
    v_rcp_f32 v111, v111
    v_mul_f32 v29, v29, v109
    v_cvt_pk_bf16_f32 v119, v26, v27
    v_fma_f32 v114, v114, v14, v14
    v_rcp_f32 v112, v112
    v_mul_f32 v30, v30, v110
    v_fma_f32 v115, v115, v14, v14
    v_rcp_f32 v113, v113
    v_mul_f32 v31, v31, v111
    buffer_load_dwordx4 v[48:51], v1, s[4:7], s57 offen offset:0 sc1
    s_waitcnt vmcnt(9)
    v_mfma_f32_32x32x16_bf16 v[52:67], a[24:27], v[128:131], v[52:67]
    v_cvt_pk_bf16_f32 v120, v28, v29
    v_rcp_f32 v114, v114
    v_mul_f32 v32, v32, v112
    v_rcp_f32 v115, v115
    v_mul_f32 v33, v33, v113
    v_cvt_pk_bf16_f32 v121, v30, v31
    v_mul_f32 v34, v34, v114
    v_mul_f32 v35, v35, v115
    v_cvt_pk_bf16_f32 v122, v32, v33
    v_cvt_pk_bf16_f32 v123, v34, v35
    buffer_load_dwordx4 v[132:135], v1, s[4:7], s57 offen offset:1024 sc1
    v_mfma_f32_32x32x16_bf16 v[68:83], a[28:31], v[128:131], v[68:83]
    s_cmp_eq_u32 s39, 0
    s_cbranch_scc1 Lslow_81
    buffer_store_dwordx4 v[116:119], v1, s[4:7], s93 offen offset:0
    buffer_store_dwordx4 v[120:123], v1, s[4:7], s93 offen offset:1024
Ldual_81:
    s_add_u32 s93, s93, 114688
    s_xor_b32 s49, s38, 1
    s_mul_i32 s49, s49, 6144
    s_add_u32 s49, s49, 98304
    v_add_u32 v12, s49, v1
    s_xor_b32 s49, s38, 2
    s_mul_i32 s49, s49, 6144
    s_add_u32 s49, s49, 100352
    buffer_load_dwordx4 v[136:139], v1, s[4:7], s57 offen offset:2048 sc1
    s_waitcnt vmcnt(12)
    v_mfma_f32_32x32x16_bf16 v[52:67], a[32:35], v[124:127], v[52:67]
    v_add_u32 v13, s49, v1
    s_xor_b32 s49, s38, 3
    s_mul_i32 s49, s49, 6144
    s_add_u32 s49, s49, 102400
    v_add_u32 v14, s49, v1
    v_mfma_f32_32x32x16_bf16 v[68:83], a[36:39], v[124:127], v[68:83]
    s_mul_i32 s49, s38, 6144
    s_add_u32 s49, s49, 98304
    v_add_u32 v15, s49, v1
    buffer_load_dwordx4 v[140:143], v1, s[4:7], s57 offen offset:3072 sc1
    s_add_u32 s57, s57, 4096
    s_waitcnt vmcnt(12)
    v_mfma_f32_32x32x16_bf16 v[52:67], a[40:43], v[144:147], v[52:67]
    v_mfma_f32_32x32x16_bf16 v[68:83], a[44:47], v[144:147], v[68:83]
    buffer_load_dwordx4 v[20:23], v1, s[4:7], s57 offen offset:0 sc1
    s_waitcnt vmcnt(12)
    v_mfma_f32_32x32x16_bf16 v[52:67], a[48:51], v[148:151], v[52:67]
    v_mfma_f32_32x32x16_bf16 v[68:83], a[52:55], v[148:151], v[68:83]
    buffer_load_dwordx4 v[24:27], v1, s[4:7], s57 offen offset:1024 sc1
    s_waitcnt vmcnt(12)
    v_mfma_f32_32x32x16_bf16 v[52:67], a[56:59], v[152:155], v[52:67]
    v_mfma_f32_32x32x16_bf16 v[68:83], a[60:63], v[152:155], v[68:83]
    buffer_load_dwordx4 v[28:31], v1, s[4:7], s57 offen offset:2048 sc1
    s_waitcnt vmcnt(12)
    v_mfma_f32_32x32x16_bf16 v[52:67], a[64:67], v[156:159], v[52:67]
    v_mfma_f32_32x32x16_bf16 v[68:83], a[68:71], v[156:159], v[68:83]
    s_waitcnt vmcnt(5)
    s_cmp_eq_u32 s39, 0
    s_cbranch_scc1 Lslow_82
    buffer_store_dword v17, v19, s[4:7], s94 offen offset:2048
Ldual_82:
    buffer_load_dwordx4 v[32:35], v1, s[4:7], s57 offen offset:3072 sc1
    s_add_u32 s57, s57, 4096
    v_mfma_f32_32x32x16_bf16 v[52:67], a[72:75], v[36:39], v[52:67]
    v_mfma_f32_32x32x16_bf16 v[68:83], a[76:79], v[36:39], v[68:83]
    buffer_load_dwordx4 v[128:131], v1, s[4:7], s57 offen offset:0 sc1
    v_mfma_f32_32x32x16_bf16 v[52:67], a[80:83], v[40:43], v[52:67]
    v_mfma_f32_32x32x16_bf16 v[68:83], a[84:87], v[40:43], v[68:83]
    buffer_load_dwordx4 v[124:127], v1, s[4:7], s57 offen offset:1024 sc1
    v_mfma_f32_32x32x16_bf16 v[52:67], a[88:91], v[44:47], v[52:67]
    v_mfma_f32_32x32x16_bf16 v[68:83], a[92:95], v[44:47], v[68:83]
    buffer_load_dwordx4 v[144:147], v1, s[4:7], s57 offen offset:2048 sc1
    v_mfma_f32_32x32x16_bf16 v[52:67], a[96:99], v[48:51], v[52:67]
    v_mfma_f32_32x32x16_bf16 v[68:83], a[100:103], v[48:51], v[68:83]
    buffer_load_dwordx4 v[148:151], v1, s[4:7], s57 offen offset:3072 sc1
    s_add_u32 s57, s57, 4096
    v_mfma_f32_32x32x16_bf16 v[52:67], a[104:107], v[132:135], v[52:67]
    v_mfma_f32_32x32x16_bf16 v[68:83], a[108:111], v[132:135], v[68:83]
    s_add_u32 s0, s0, 512
    buffer_load_dword v18, v16, s[4:7], s0 offen sc1
    buffer_load_dwordx4 v[152:155], v1, s[4:7], s57 offen offset:0 sc1
    s_waitcnt vmcnt(12)
    v_mfma_f32_32x32x16_bf16 v[52:67], a[112:115], v[136:139], v[52:67]
    v_mfma_f32_32x32x16_bf16 v[68:83], a[116:119], v[136:139], v[68:83]
    buffer_load_dwordx4 v[156:159], v1, s[4:7], s57 offen offset:1024 sc1
    s_waitcnt vmcnt(12)
    v_mfma_f32_32x32x16_bf16 v[52:67], a[120:123], v[140:143], v[52:67]
    v_mfma_f32_32x32x16_bf16 v[68:83], a[124:127], v[140:143], v[68:83]
    buffer_load_dwordx4 v[36:39], v1, s[4:7], s57 offen offset:2048 sc1
    s_waitcnt vmcnt(12)
    v_mfma_f32_32x32x16_bf16 v[52:67], a[128:131], v[20:23], v[52:67]
    v_mfma_f32_32x32x16_bf16 v[68:83], a[132:135], v[20:23], v[68:83]
    buffer_load_dwordx4 v[40:43], v1, s[4:7], s57 offen offset:3072 sc1
    s_add_u32 s57, s57, 4096
    s_waitcnt vmcnt(12)
    v_mfma_f32_32x32x16_bf16 v[52:67], a[136:139], v[24:27], v[52:67]
    v_mfma_f32_32x32x16_bf16 v[68:83], a[140:143], v[24:27], v[68:83]
    s_waitcnt vmcnt(11)
    v_mfma_f32_32x32x16_bf16 v[52:67], a[144:147], v[28:31], v[52:67]
    v_mfma_f32_32x32x16_bf16 v[68:83], a[148:151], v[28:31], v[68:83]
    s_waitcnt vmcnt(4)
    v_cmp_gt_u32 vcc, 2, v18
    s_cbranch_vccnz Lspin_49
Lback_50:
    buffer_load_dwordx4 v[44:47], v1, s[4:7], s58 offen offset:0 sc1
    v_mfma_f32_32x32x16_bf16 v[52:67], a[152:155], v[32:35], v[52:67]
    v_mfma_f32_32x32x16_bf16 v[68:83], a[156:159], v[32:35], v[68:83]
    buffer_load_dwordx4 v[48:51], v1, s[4:7], s58 offen offset:1024 sc1
    s_barrier
    v_mfma_f32_32x32x16_bf16 v[52:67], a[160:163], v[128:131], v[52:67]
    v_mfma_f32_32x32x16_bf16 v[68:83], a[164:167], v[128:131], v[68:83]
    buffer_load_dwordx4 v[132:135], v1, s[4:7], s58 offen offset:2048 sc1
    v_mfma_f32_32x32x16_bf16 v[52:67], a[168:171], v[124:127], v[52:67]
    v_mfma_f32_32x32x16_bf16 v[68:83], a[172:175], v[124:127], v[68:83]
    buffer_load_dwordx4 v[136:139], v1, s[4:7], s58 offen offset:3072 sc1
    s_add_u32 s58, s58, 4096
    v_mfma_f32_32x32x16_bf16 v[52:67], a[176:179], v[144:147], v[52:67]
    v_mfma_f32_32x32x16_bf16 v[68:83], a[180:183], v[144:147], v[68:83]
    buffer_load_dwordx4 v[140:143], v1, s[4:7], s58 offen offset:0 sc1
    v_mfma_f32_32x32x16_bf16 v[52:67], a[184:187], v[148:151], v[52:67]
    v_mfma_f32_32x32x16_bf16 v[68:83], a[188:191], v[148:151], v[68:83]
    buffer_load_dwordx4 v[20:23], v1, s[4:7], s58 offen offset:1024 sc1
    s_waitcnt vmcnt(9)
    v_mfma_f32_32x32x16_bf16 v[52:67], a[192:195], v[152:155], v[52:67]
    v_mfma_f32_32x32x16_bf16 v[68:83], a[196:199], v[152:155], v[68:83]
    buffer_load_dwordx4 v[24:27], v1, s[4:7], s58 offen offset:2048 sc1
    s_waitcnt vmcnt(9)
    v_mfma_f32_32x32x16_bf16 v[52:67], a[200:203], v[156:159], v[52:67]
    v_mfma_f32_32x32x16_bf16 v[68:83], a[204:207], v[156:159], v[68:83]
    buffer_load_dwordx4 v[28:31], v1, s[4:7], s58 offen offset:3072 sc1
    s_add_u32 s58, s58, 4096
    s_waitcnt vmcnt(9)
    v_mfma_f32_32x32x16_bf16 v[52:67], a[208:211], v[36:39], v[52:67]
    v_mfma_f32_32x32x16_bf16 v[68:83], a[212:215], v[36:39], v[68:83]
    buffer_load_dwordx4 v[32:35], v1, s[4:7], s58 offen offset:0 sc1
    s_waitcnt vmcnt(9)
    v_mfma_f32_32x32x16_bf16 v[52:67], a[216:219], v[40:43], v[52:67]
    v_mfma_f32_32x32x16_bf16 v[68:83], a[220:223], v[40:43], v[68:83]
    buffer_load_dwordx4 v[128:131], v1, s[4:7], s58 offen offset:1024 sc1
    s_waitcnt vmcnt(9)
    v_mfma_f32_32x32x16_bf16 v[84:99], a[0:3], v[44:47], 0
    v_mfma_f32_32x32x16_bf16 v[100:115], a[4:7], v[44:47], 0
    buffer_load_dwordx4 v[124:127], v1, s[4:7], s58 offen offset:2048 sc1
    s_waitcnt vmcnt(9)
    v_mfma_f32_32x32x16_bf16 v[84:99], a[8:11], v[48:51], v[84:99]
    v_mfma_f32_32x32x16_bf16 v[100:115], a[12:15], v[48:51], v[100:115]
    buffer_load_dwordx4 v[144:147], v1, s[4:7], s58 offen offset:3072 sc1
    s_add_u32 s58, s58, 4096
    s_waitcnt vmcnt(9)
    v_mfma_f32_32x32x16_bf16 v[84:99], a[16:19], v[132:135], v[84:99]
    v_and_b32 v16, 31, v0
    v_lshlrev_b32 v16, 10, v16
    v_lshrrev_b32 v18, 5, v0
    v_lshl_add_u32 v16, v18, 4, v16
    v_lshlrev_b32 v116, 16, v4
    v_mfma_f32_32x32x16_bf16 v[100:115], a[20:23], v[132:135], v[100:115]
    v_and_b32 v117, 0xffff0000, v4
    v_lshlrev_b32 v118, 16, v5
    v_and_b32 v119, 0xffff0000, v5
    v_lshlrev_b32 v120, 16, v6
    v_and_b32 v121, 0xffff0000, v6
    buffer_load_dwordx4 v[148:151], v1, s[4:7], s58 offen offset:0 sc1
    s_waitcnt vmcnt(9)
    v_mfma_f32_32x32x16_bf16 v[84:99], a[24:27], v[136:139], v[84:99]
    v_lshlrev_b32 v122, 16, v7
    v_and_b32 v123, 0xffff0000, v7
    v_mfma_f32_32x32x16_bf16 v[100:115], a[28:31], v[136:139], v[100:115]
    ds_write_b128 v12, v[60:63] offset:24576
    buffer_load_dwordx4 v[152:155], v1, s[4:7], s58 offen offset:1024 sc1
    s_waitcnt vmcnt(9)
    v_mfma_f32_32x32x16_bf16 v[84:99], a[32:35], v[140:143], v[84:99]
    v_mfma_f32_32x32x16_bf16 v[100:115], a[36:39], v[140:143], v[100:115]
    ds_write_b128 v12, v[64:67] offset:25600
    buffer_load_dwordx4 v[156:159], v1, s[4:7], s58 offen offset:2048 sc1
    s_waitcnt vmcnt(9)
    v_mfma_f32_32x32x16_bf16 v[84:99], a[40:43], v[20:23], v[84:99]
    v_mfma_f32_32x32x16_bf16 v[100:115], a[44:47], v[20:23], v[100:115]
    ds_write_b128 v13, v[68:71] offset:24576
    buffer_load_dwordx4 v[36:39], v1, s[4:7], s58 offen offset:3072 sc1
    s_add_u32 s58, s58, 4096
    s_waitcnt vmcnt(9)
    v_mfma_f32_32x32x16_bf16 v[84:99], a[48:51], v[24:27], v[84:99]
    v_mfma_f32_32x32x16_bf16 v[100:115], a[52:55], v[24:27], v[100:115]
    ds_write_b128 v13, v[72:75] offset:25600
    buffer_load_dwordx4 v[40:43], v1, s[4:7], s58 offen offset:0 sc1
    s_waitcnt vmcnt(9)
    v_mfma_f32_32x32x16_bf16 v[84:99], a[56:59], v[28:31], v[84:99]
    v_mfma_f32_32x32x16_bf16 v[100:115], a[60:63], v[28:31], v[100:115]
    ds_write_b128 v14, v[76:79] offset:24576
    buffer_load_dwordx4 v[44:47], v1, s[4:7], s58 offen offset:1024 sc1
    s_waitcnt vmcnt(9)
    v_mfma_f32_32x32x16_bf16 v[84:99], a[64:67], v[32:35], v[84:99]
    v_mfma_f32_32x32x16_bf16 v[100:115], a[68:71], v[32:35], v[100:115]
    ds_write_b128 v14, v[80:83] offset:25600
    buffer_load_dwordx4 v[48:51], v1, s[4:7], s58 offen offset:2048 sc1
    s_waitcnt vmcnt(9)
    v_mfma_f32_32x32x16_bf16 v[84:99], a[72:75], v[128:131], v[84:99]
    v_mfma_f32_32x32x16_bf16 v[100:115], a[76:79], v[128:131], v[100:115]
    v_add_f32 v52, v52, v116
    v_add_f32 v53, v53, v117
    v_add_f32 v54, v54, v118
    v_add_f32 v55, v55, v119
    v_add_f32 v56, v56, v120
    buffer_load_dwordx4 v[132:135], v1, s[4:7], s58 offen offset:3072 sc1
    s_add_u32 s58, s58, 4096
    s_waitcnt vmcnt(9)
    v_mfma_f32_32x32x16_bf16 v[84:99], a[80:83], v[124:127], v[84:99]
    v_add_f32 v57, v57, v121
    v_add_f32 v58, v58, v122
    v_add_f32 v59, v59, v123
    s_waitcnt lgkmcnt(0)
    s_barrier
    v_mfma_f32_32x32x16_bf16 v[100:115], a[84:87], v[124:127], v[100:115]
    ds_read_b128 v[60:63], v15 offset:24576
    ds_read_b128 v[64:67], v15 offset:25600
    ds_read_b128 v[68:71], v15 offset:26624
    ds_read_b128 v[72:75], v15 offset:27648
    ds_read_b128 v[76:79], v15 offset:28672
    buffer_load_dwordx4 v[136:139], v1, s[4:7], s58 offen offset:0 sc1
    s_waitcnt vmcnt(9)
    v_mfma_f32_32x32x16_bf16 v[84:99], a[88:91], v[144:147], v[84:99]
    ds_read_b128 v[80:83], v15 offset:29696
    v_mfma_f32_32x32x16_bf16 v[100:115], a[92:95], v[144:147], v[100:115]
    buffer_load_dwordx4 v[140:143], v1, s[4:7], s58 offen offset:1024 sc1
    s_waitcnt vmcnt(9)
    v_mfma_f32_32x32x16_bf16 v[84:99], a[96:99], v[148:151], v[84:99]
    v_mfma_f32_32x32x16_bf16 v[100:115], a[100:103], v[148:151], v[100:115]
    buffer_load_dwordx4 v[20:23], v1, s[4:7], s58 offen offset:2048 sc1
    s_waitcnt vmcnt(9)
    v_mfma_f32_32x32x16_bf16 v[84:99], a[104:107], v[152:155], v[84:99]
    s_waitcnt lgkmcnt(3)
    v_add_f32 v60, v60, v68
    v_add_f32 v61, v61, v69
    v_add_f32 v62, v62, v70
    v_add_f32 v63, v63, v71
    s_waitcnt lgkmcnt(2)
    v_add_f32 v64, v64, v72
    v_mfma_f32_32x32x16_bf16 v[100:115], a[108:111], v[152:155], v[100:115]
    v_add_f32 v65, v65, v73
    v_add_f32 v66, v66, v74
    v_add_f32 v67, v67, v75
    s_waitcnt lgkmcnt(1)
    v_add_f32 v52, v52, v76
    v_add_f32 v53, v53, v77
    buffer_load_dwordx4 v[24:27], v1, s[4:7], s58 offen offset:3072 sc1
    s_add_u32 s58, s58, 4096
    s_waitcnt vmcnt(9)
    v_mfma_f32_32x32x16_bf16 v[84:99], a[112:115], v[156:159], v[84:99]
    v_add_f32 v54, v54, v78
    v_add_f32 v55, v55, v79
    s_waitcnt lgkmcnt(0)
    v_add_f32 v56, v56, v80
    v_add_f32 v57, v57, v81
    v_add_f32 v58, v58, v82
    v_mfma_f32_32x32x16_bf16 v[100:115], a[116:119], v[156:159], v[100:115]
    v_add_f32 v59, v59, v83
    v_add_f32 v52, v52, v60
    v_add_f32 v53, v53, v61
    v_add_f32 v54, v54, v62
    v_add_f32 v55, v55, v63
    buffer_load_dwordx4 v[28:31], v1, s[4:7], s58 offen offset:0 sc1
    s_waitcnt vmcnt(9)
    v_mfma_f32_32x32x16_bf16 v[84:99], a[120:123], v[36:39], v[84:99]
    v_add_f32 v56, v56, v64
    v_add_f32 v57, v57, v65
    v_add_f32 v58, v58, v66
    v_add_f32 v59, v59, v67
    v_cvt_pk_bf16_f32 v4, v52, v53
    v_mfma_f32_32x32x16_bf16 v[100:115], a[124:127], v[36:39], v[100:115]
    v_cvt_pk_bf16_f32 v5, v54, v55
    v_cvt_pk_bf16_f32 v6, v56, v57
    v_cvt_pk_bf16_f32 v7, v58, v59
    buffer_store_dwordx4 v[4:7], v16, s[28:31], s54 offen
    s_add_u32 s54, s54, 65536
    buffer_load_dwordx4 v[32:35], v1, s[4:7], s58 offen offset:1024 sc1
    s_waitcnt vmcnt(10)
    v_mfma_f32_32x32x16_bf16 v[84:99], a[128:131], v[40:43], v[84:99]
    v_lshlrev_b32 v116, 16, v8
    v_and_b32 v117, 0xffff0000, v8
    v_lshlrev_b32 v118, 16, v9
    v_and_b32 v119, 0xffff0000, v9
    v_lshlrev_b32 v120, 16, v10
    v_mfma_f32_32x32x16_bf16 v[100:115], a[132:135], v[40:43], v[100:115]
    v_and_b32 v121, 0xffff0000, v10
    v_lshlrev_b32 v122, 16, v11
    v_and_b32 v123, 0xffff0000, v11
    buffer_load_dwordx4 v[128:131], v1, s[4:7], s58 offen offset:2048 sc1
    s_waitcnt vmcnt(10)
    v_mfma_f32_32x32x16_bf16 v[84:99], a[136:139], v[44:47], v[84:99]
    v_mfma_f32_32x32x16_bf16 v[100:115], a[140:143], v[44:47], v[100:115]
    buffer_load_dwordx4 v[124:127], v1, s[4:7], s58 offen offset:3072 sc1
    s_add_u32 s58, s58, 4096
    s_waitcnt vmcnt(10)
    v_mfma_f32_32x32x16_bf16 v[84:99], a[144:147], v[48:51], v[84:99]
    v_mfma_f32_32x32x16_bf16 v[100:115], a[148:151], v[48:51], v[100:115]
    s_waitcnt vmcnt(9)
    v_mfma_f32_32x32x16_bf16 v[84:99], a[152:155], v[132:135], v[84:99]
    v_mfma_f32_32x32x16_bf16 v[100:115], a[156:159], v[132:135], v[100:115]
    s_waitcnt vmcnt(8)
    v_mfma_f32_32x32x16_bf16 v[84:99], a[160:163], v[136:139], v[84:99]
    v_mfma_f32_32x32x16_bf16 v[100:115], a[164:167], v[136:139], v[100:115]
    s_waitcnt vmcnt(7)
    v_mfma_f32_32x32x16_bf16 v[84:99], a[168:171], v[140:143], v[84:99]
    v_mfma_f32_32x32x16_bf16 v[100:115], a[172:175], v[140:143], v[100:115]
    s_waitcnt vmcnt(6)
    v_mfma_f32_32x32x16_bf16 v[84:99], a[176:179], v[20:23], v[84:99]
    v_mfma_f32_32x32x16_bf16 v[100:115], a[180:183], v[20:23], v[100:115]
    s_waitcnt vmcnt(5)
    v_mfma_f32_32x32x16_bf16 v[84:99], a[184:187], v[24:27], v[84:99]
    v_mfma_f32_32x32x16_bf16 v[100:115], a[188:191], v[24:27], v[100:115]
    s_waitcnt vmcnt(4)
    v_mfma_f32_32x32x16_bf16 v[84:99], a[192:195], v[28:31], v[84:99]
    v_mfma_f32_32x32x16_bf16 v[100:115], a[196:199], v[28:31], v[100:115]
    s_waitcnt vmcnt(2)
    v_mfma_f32_32x32x16_bf16 v[84:99], a[200:203], v[32:35], v[84:99]
    v_mfma_f32_32x32x16_bf16 v[100:115], a[204:207], v[32:35], v[100:115]
    s_waitcnt vmcnt(1)
    v_mfma_f32_32x32x16_bf16 v[84:99], a[208:211], v[128:131], v[84:99]
    v_mfma_f32_32x32x16_bf16 v[100:115], a[212:215], v[128:131], v[100:115]
    s_waitcnt vmcnt(0)
    v_mfma_f32_32x32x16_bf16 v[84:99], a[216:219], v[124:127], v[84:99]
    v_mfma_f32_32x32x16_bf16 v[100:115], a[220:223], v[124:127], v[100:115]
    s_nop 10
    ds_write_b128 v12, v[92:95] offset:0
    ds_write_b128 v12, v[96:99] offset:1024
    ds_write_b128 v13, v[100:103] offset:0
    ds_write_b128 v13, v[104:107] offset:1024
    ds_write_b128 v14, v[108:111] offset:0
    ds_write_b128 v14, v[112:115] offset:1024
    v_pk_add_f32 v[84:85], v[84:85], v[116:117]
    v_pk_add_f32 v[86:87], v[86:87], v[118:119]
    v_pk_add_f32 v[88:89], v[88:89], v[120:121]
    v_pk_add_f32 v[90:91], v[90:91], v[122:123]
    s_waitcnt lgkmcnt(0)
    s_barrier
    ds_read_b128 v[92:95], v15 offset:0
    ds_read_b128 v[96:99], v15 offset:1024
    ds_read_b128 v[100:103], v15 offset:2048
    ds_read_b128 v[104:107], v15 offset:3072
    ds_read_b128 v[108:111], v15 offset:4096
    ds_read_b128 v[112:115], v15 offset:5120
    s_waitcnt lgkmcnt(3)
    v_pk_add_f32 v[92:93], v[92:93], v[100:101]
    v_pk_add_f32 v[94:95], v[94:95], v[102:103]
    s_waitcnt lgkmcnt(2)
    v_pk_add_f32 v[96:97], v[96:97], v[104:105]
    v_pk_add_f32 v[98:99], v[98:99], v[106:107]
    s_waitcnt lgkmcnt(1)
    v_pk_add_f32 v[84:85], v[84:85], v[108:109]
    v_pk_add_f32 v[86:87], v[86:87], v[110:111]
    s_waitcnt lgkmcnt(0)
    v_pk_add_f32 v[88:89], v[88:89], v[112:113]
    v_pk_add_f32 v[90:91], v[90:91], v[114:115]
    v_pk_add_f32 v[84:85], v[84:85], v[92:93]
    v_pk_add_f32 v[86:87], v[86:87], v[94:95]
    v_pk_add_f32 v[88:89], v[88:89], v[96:97]
    v_pk_add_f32 v[90:91], v[90:91], v[98:99]
    v_cvt_pk_bf16_f32 v8, v84, v85
    v_cvt_pk_bf16_f32 v9, v86, v87
    v_cvt_pk_bf16_f32 v10, v88, v89
    v_cvt_pk_bf16_f32 v11, v90, v91
    buffer_store_dwordx4 v[8:11], v16, s[28:31], s54 offen
L_end:
L_exit:
    s_endpgm
Lspin_5:
    s_mov_b32 s53, 0
Lspin_5_l:
    buffer_load_dword v235, v234, s[32:35], 0 offen sc1
    s_add_u32 s53, s53, 1
    s_cmp_gt_u32 s53, 0x40000
    s_cbranch_scc1 L_exit
    s_waitcnt vmcnt(0)
    v_cmp_gt_u32 vcc, 1, v235
    s_cbranch_vccz Lback_6
    s_sleep 2
    s_branch Lspin_5_l
Lspin_7:
    s_waitcnt vmcnt(0)
    v_cmp_gt_u32 vcc, 256, v45
    s_cbranch_vccz Lback_8
    s_mov_b32 s53, 0
Lspin_7_l:
    buffer_load_dword v44, v16, s[4:7], s58 offen sc1
    s_add_u32 s53, s53, 1
    s_cmp_gt_u32 s53, 0x40000
    s_cbranch_scc1 L_exit
    s_waitcnt vmcnt(0)
    v_cmp_gt_u32 vcc, 256, v44
    s_cbranch_vccz Lback_8
    s_branch Lspin_7_l
Lspin_9:
    s_mov_b32 s53, 0
Lspin_9_l:
    buffer_load_dword v239, v238, s[4:7], 0 offen sc1
    s_add_u32 s53, s53, 1
    s_cmp_gt_u32 s53, 0x40000
    s_cbranch_scc1 L_exit
    s_waitcnt vmcnt(0)
    v_cmp_gt_u32 vcc, 1, v239
    s_cbranch_vccz Lback_10
    s_sleep 2
    s_branch Lspin_9_l
Lspin_11:
    s_mov_b32 s53, 0
Lspin_11_l:
    buffer_load_dword v249, v248, s[4:7], s101 offen sc1
    s_add_u32 s53, s53, 1
    s_cmp_gt_u32 s53, 0x40000
    s_cbranch_scc1 L_exit
    s_waitcnt vmcnt(0)
    v_cmp_gt_u32 vcc, 256, v249
    s_cbranch_vccz Lback_12

    s_branch Lspin_11_l
Lsafe_13:
    s_waitcnt vmcnt(0) lgkmcnt(0)
    s_nop 15
    s_mov_b32 s43, 0
Lsafe_13_h:
    s_cmp_eq_u32 s43, 1
    s_cselect_b64 vcc, -1, 0
    v_cndmask_b32 v60, v20, v24, vcc
    v_cndmask_b32 v61, v21, v25, vcc
    v_cndmask_b32 v62, v22, v26, vcc
    v_cndmask_b32 v63, v23, v27, vcc
    v_mov_b32 v52, 0xff800000
    v_mov_b32 v80, 0
    v_mov_b32 v81, 0
    v_mov_b32 v82, 0
    v_mov_b32 v83, 0
    v_mov_b32 v84, 0
    v_mov_b32 v85, 0
    v_mov_b32 v86, 0
    v_mov_b32 v87, 0
    v_mov_b32 v88, 0
    v_mov_b32 v89, 0
    v_mov_b32 v90, 0
    v_mov_b32 v91, 0
    v_mov_b32 v92, 0
    v_mov_b32 v93, 0
    v_mov_b32 v94, 0
    v_mov_b32 v95, 0
    s_mov_b32 s53, 0
Lsafe_13_p:
    s_mov_b32 s44, 0
Lsafe_13_b:
    s_add_u32 s45, s44, s38
    s_add_u32 s46, s44, 3
    s_cmp_lt_u32 s44, 5
    s_cselect_b32 s45, s45, s46
    s_lshr_b32 s46, s45, 2
    s_mov_b32 s47, 0
    s_cmp_eq_u32 s46, 0
    s_cselect_b32 s47, 2, s47
    s_cmp_eq_u32 s46, 2
    s_cselect_b32 s47, 1, s47
    s_cmp_lt_u32 s36, s47
    s_cbranch_scc1 Lsafe_13_n
    s_mul_i32 s45, s45, 4112
    v_add_u32 v54, s45, v18
    s_lshl_b32 s46, s43, 10
    v_add_u32 v53, s46, v54
    ds_read_b128 v[64:67], v53
    v_bfe_u32 v53, v0, 4, 1
    v_cmp_eq_u32 vcc, s43, v53
    v_sub_u32 v53, v54, v1
    v_add_u32 v53, 4096, v53
    v_add_u32 v55, 2048, v54
    v_cndmask_b32 v55, v53, v55, vcc
    ds_read_b128 v[72:75], v55
    v_add_u32 v56, 3072, v54
    v_cndmask_b32 v56, v53, v56, vcc
    ds_read_b128 v[76:79], v56
    s_waitcnt lgkmcnt(2)
    v_mfma_f32_32x32x16_bf16 v[28:43], v[64:67], v[60:63], 0
    s_cmp_lg_u32 s44, 0
    s_cselect_b64 s[46:47], -1, 0
    s_cmp_lg_u32 s44, 4
    s_cselect_b64 s[48:49], -1, 0
    v_mov_b32 v53, 0xff800000
    s_and_b64 vcc, s[60:61], s[46:47]
    s_andn2_b64 s[96:97], s[48:49], s[60:61]
    s_or_b64 vcc, vcc, s[96:97]
    s_nop 3
    v_cndmask_b32 v28, v53, v28, vcc
    s_and_b64 vcc, s[62:63], s[46:47]
    s_andn2_b64 s[96:97], s[48:49], s[62:63]
    s_or_b64 vcc, vcc, s[96:97]
    v_cndmask_b32 v29, v53, v29, vcc
    s_and_b64 vcc, s[64:65], s[46:47]
    s_andn2_b64 s[96:97], s[48:49], s[64:65]
    s_or_b64 vcc, vcc, s[96:97]
    v_cndmask_b32 v30, v53, v30, vcc
    s_and_b64 vcc, s[66:67], s[46:47]
    s_andn2_b64 s[96:97], s[48:49], s[66:67]
    s_or_b64 vcc, vcc, s[96:97]
    v_cndmask_b32 v31, v53, v31, vcc
    s_and_b64 vcc, s[68:69], s[46:47]
    s_andn2_b64 s[96:97], s[48:49], s[68:69]
    s_or_b64 vcc, vcc, s[96:97]
    v_cndmask_b32 v32, v53, v32, vcc
    s_and_b64 vcc, s[70:71], s[46:47]
    s_andn2_b64 s[96:97], s[48:49], s[70:71]
    s_or_b64 vcc, vcc, s[96:97]
    v_cndmask_b32 v33, v53, v33, vcc
    s_and_b64 vcc, s[72:73], s[46:47]
    s_andn2_b64 s[96:97], s[48:49], s[72:73]
    s_or_b64 vcc, vcc, s[96:97]
    v_cndmask_b32 v34, v53, v34, vcc
    s_and_b64 vcc, s[74:75], s[46:47]
    s_andn2_b64 s[96:97], s[48:49], s[74:75]
    s_or_b64 vcc, vcc, s[96:97]
    v_cndmask_b32 v35, v53, v35, vcc
    s_and_b64 vcc, s[76:77], s[46:47]
    s_andn2_b64 s[96:97], s[48:49], s[76:77]
    s_or_b64 vcc, vcc, s[96:97]
    v_cndmask_b32 v36, v53, v36, vcc
    s_and_b64 vcc, s[78:79], s[46:47]
    s_andn2_b64 s[96:97], s[48:49], s[78:79]
    s_or_b64 vcc, vcc, s[96:97]
    v_cndmask_b32 v37, v53, v37, vcc
    s_and_b64 vcc, s[80:81], s[46:47]
    s_andn2_b64 s[96:97], s[48:49], s[80:81]
    s_or_b64 vcc, vcc, s[96:97]
    v_cndmask_b32 v38, v53, v38, vcc
    s_and_b64 vcc, s[82:83], s[46:47]
    s_andn2_b64 s[96:97], s[48:49], s[82:83]
    s_or_b64 vcc, vcc, s[96:97]
    v_cndmask_b32 v39, v53, v39, vcc
    s_and_b64 vcc, s[84:85], s[46:47]
    s_andn2_b64 s[96:97], s[48:49], s[84:85]
    s_or_b64 vcc, vcc, s[96:97]
    v_cndmask_b32 v40, v53, v40, vcc
    s_and_b64 vcc, s[86:87], s[46:47]
    s_andn2_b64 s[96:97], s[48:49], s[86:87]
    s_or_b64 vcc, vcc, s[96:97]
    v_cndmask_b32 v41, v53, v41, vcc
    s_and_b64 vcc, s[88:89], s[46:47]
    s_andn2_b64 s[96:97], s[48:49], s[88:89]
    s_or_b64 vcc, vcc, s[96:97]
    v_cndmask_b32 v42, v53, v42, vcc
    s_and_b64 vcc, s[90:91], s[46:47]
    s_andn2_b64 s[96:97], s[48:49], s[90:91]
    s_or_b64 vcc, vcc, s[96:97]
    v_cndmask_b32 v43, v53, v43, vcc
    s_cmp_eq_u32 s53, 1
    s_cbranch_scc1 Lsafe_13_2
    v_max3_f32 v52, v28, v29, v52
    v_max3_f32 v52, v30, v31, v52
    v_max3_f32 v52, v32, v33, v52
    v_max3_f32 v52, v34, v35, v52
    v_max3_f32 v52, v36, v37, v52
    v_max3_f32 v52, v38, v39, v52
    v_max3_f32 v52, v40, v41, v52
    v_max3_f32 v52, v42, v43, v52
    s_branch Lsafe_13_n
Lsafe_13_2:
    v_sub_f32 v28, v28, v52
    v_sub_f32 v29, v29, v52
    v_sub_f32 v30, v30, v52
    v_sub_f32 v31, v31, v52
    v_sub_f32 v32, v32, v52
    v_sub_f32 v33, v33, v52
    v_sub_f32 v34, v34, v52
    v_sub_f32 v35, v35, v52
    v_sub_f32 v36, v36, v52
    v_sub_f32 v37, v37, v52
    v_sub_f32 v38, v38, v52
    v_sub_f32 v39, v39, v52
    v_sub_f32 v40, v40, v52
    v_sub_f32 v41, v41, v52
    v_sub_f32 v42, v42, v52
    v_sub_f32 v43, v43, v52
    v_exp_f32 v28, v28
    v_exp_f32 v29, v29
    v_exp_f32 v30, v30
    v_exp_f32 v31, v31
    v_exp_f32 v32, v32
    v_exp_f32 v33, v33
    v_exp_f32 v34, v34
    v_exp_f32 v35, v35
    v_exp_f32 v36, v36
    v_exp_f32 v37, v37
    v_exp_f32 v38, v38
    v_exp_f32 v39, v39
    v_exp_f32 v40, v40
    v_exp_f32 v41, v41
    v_exp_f32 v42, v42
    v_exp_f32 v43, v43
    v_cvt_pk_bf16_f32 v44, v28, v29
    v_cvt_pk_bf16_f32 v45, v30, v31
    v_cvt_pk_bf16_f32 v46, v32, v33
    v_cvt_pk_bf16_f32 v47, v34, v35
    v_cvt_pk_bf16_f32 v48, v36, v37
    v_cvt_pk_bf16_f32 v49, v38, v39
    v_cvt_pk_bf16_f32 v50, v40, v41
    v_cvt_pk_bf16_f32 v51, v42, v43
    s_waitcnt lgkmcnt(1)
    v_mfma_f32_32x32x16_bf16 v[80:95], v[72:75], v[44:47], v[80:95]
    s_waitcnt lgkmcnt(0)
    v_mfma_f32_32x32x16_bf16 v[80:95], v[76:79], v[48:51], v[80:95]
Lsafe_13_n:
    s_waitcnt lgkmcnt(0)
    s_nop 15
    s_add_u32 s44, s44, 1
    s_cmp_lt_u32 s44, 9
    s_cbranch_scc1 Lsafe_13_b
    v_mov_b32 v53, v52
    s_nop 1
    v_permlane32_swap_b32 v53, v52
    v_max_f32 v52, v52, v53
    s_add_u32 s53, s53, 1
    s_cmp_lt_u32 s53, 2
    s_cbranch_scc1 Lsafe_13_p
    s_cmp_eq_u32 s43, 1
    s_cselect_b64 vcc, -1, 0
    v_cndmask_b32 v53, v88, v80, vcc
    v_rcp_f32 v53, v53
    v_cndmask_b32 v28, v80, v88, vcc
    v_cndmask_b32 v29, v81, v89, vcc
    v_cndmask_b32 v30, v82, v90, vcc
    v_cndmask_b32 v31, v83, v91, vcc
    v_cndmask_b32 v32, v84, v92, vcc
    v_cndmask_b32 v33, v85, v93, vcc
    v_cndmask_b32 v34, v86, v94, vcc
    v_cndmask_b32 v35, v87, v95, vcc
    v_mul_f32 v28, v28, v53
    v_mul_f32 v29, v29, v53
    v_mul_f32 v30, v30, v53
    v_mul_f32 v31, v31, v53
    v_mul_f32 v32, v32, v53
    v_mul_f32 v33, v33, v53
    v_mul_f32 v34, v34, v53
    v_mul_f32 v35, v35, v53
    v_cvt_pk_bf16_f32 v44, v28, v29
    v_cvt_pk_bf16_f32 v45, v30, v31
    v_cvt_pk_bf16_f32 v46, v32, v33
    v_cvt_pk_bf16_f32 v47, v34, v35
    s_lshl_b32 s46, s43, 10
    s_add_u32 s46, s46, s55
    buffer_store_dwordx4 v[44:47], v1, s[4:7], s46 offen sc1
    s_waitcnt vmcnt(0)
    s_add_u32 s43, s43, 1
    s_cmp_lt_u32 s43, 2
    s_cbranch_scc1 Lsafe_13_h
    s_branch Lsafeback_14
Lspin_15:
    s_mov_b32 s53, 0
Lspin_15_l:
    buffer_load_dword v92, v16, s[4:7], s59 offen sc1
    s_add_u32 s53, s53, 1
    s_cmp_gt_u32 s53, 0x40000
    s_cbranch_scc1 L_exit
    s_waitcnt vmcnt(0)
    v_cmp_gt_u32 vcc, 1, v92
    s_cbranch_vccz Lback_16

    s_branch Lspin_15_l
Lspin_17:
    s_waitcnt vmcnt(2)
    v_cmp_gt_u32 vcc, 1, v150
    s_cbranch_vccz Lback_18
    s_waitcnt vmcnt(0)
    v_cmp_gt_u32 vcc, 1, v151
    s_cbranch_vccz Lback_18
    s_mov_b32 s53, 0
Lspin_17_l:
    buffer_load_dword v18, v16, s[4:7], s59 offen sc1
    s_add_u32 s53, s53, 1
    s_cmp_gt_u32 s53, 0x40000
    s_cbranch_scc1 L_exit
    s_waitcnt vmcnt(0)
    v_cmp_gt_u32 vcc, 1, v18
    s_cbranch_vccz Lback_18
    s_branch Lspin_17_l
Lspin_19:
    s_mov_b32 s53, 0
Lspin_19_l:
    buffer_load_dword v18, v15, s[4:7], s101 offen sc1
    s_add_u32 s53, s53, 1
    s_cmp_gt_u32 s53, 0x40000
    s_cbranch_scc1 L_exit
    s_waitcnt vmcnt(0)
    v_cmp_gt_u32 vcc, 1, v18
    s_cbranch_vccz Lback_20

    s_branch Lspin_19_l
Lspin_21:
    s_mov_b32 s53, 0
Lspin_21_l:
    buffer_load_dword v112, v16, s[4:7], s59 offen sc1
    s_add_u32 s53, s53, 1
    s_cmp_gt_u32 s53, 0x40000
    s_cbranch_scc1 L_exit
    s_waitcnt vmcnt(0)
    v_cmp_gt_u32 vcc, 1, v112
    s_cbranch_vccz Lback_22

    s_branch Lspin_21_l
Lspin_23:
    s_mov_b32 s53, 0
Lspin_23_l:
    buffer_load_dword v18, v16, s[4:7], s0 offen sc1
    s_add_u32 s53, s53, 1
    s_cmp_gt_u32 s53, 0x40000
    s_cbranch_scc1 L_exit
    s_waitcnt vmcnt(0)
    v_cmp_gt_u32 vcc, 1, v18
    s_cbranch_vccz Lback_24

    s_branch Lspin_23_l
Lspin_25:
    s_mov_b32 s53, 0
Lspin_25_l:
    buffer_load_dword v18, v16, s[4:7], s0 offen sc1
    s_add_u32 s53, s53, 1
    s_cmp_gt_u32 s53, 0x40000
    s_cbranch_scc1 L_exit
    s_waitcnt vmcnt(0)
    v_cmp_gt_u32 vcc, 1, v18
    s_cbranch_vccz Lback_26

    s_branch Lspin_25_l
Lspin_27:
    s_mov_b32 s53, 0
Lspin_27_l:
    buffer_load_dword v18, v17, s[4:7], s42 offen sc1
    s_add_u32 s53, s53, 1
    s_cmp_gt_u32 s53, 0x40000
    s_cbranch_scc1 L_exit
    s_waitcnt vmcnt(0)
    v_cmp_gt_u32 vcc, 1, v18
    s_cbranch_vccz Lback_28

    s_branch Lspin_27_l
Lspin_29:
    s_mov_b32 s53, 0
Lspin_29_l:
    buffer_load_dword v18, v17, s[4:7], s96 offen sc1
    s_add_u32 s53, s53, 1
    s_cmp_gt_u32 s53, 0x40000
    s_cbranch_scc1 L_exit
    s_waitcnt vmcnt(0)
    v_cmp_gt_u32 vcc, 2, v18
    s_cbranch_vccz Lback_30

    s_branch Lspin_29_l
Lspin_31:
    s_mov_b32 s53, 0
Lspin_31_l:
    buffer_load_dword v159, v158, s[4:7], 0 offen sc1
    s_add_u32 s53, s53, 1
    s_cmp_gt_u32 s53, 0x40000
    s_cbranch_scc1 L_exit
    s_waitcnt vmcnt(0)
    v_cmp_gt_u32 vcc, 1, v159
    s_cbranch_vccz Lback_32
    s_sleep 2
    s_branch Lspin_31_l
Lhre_33:
    s_mov_b32 s53, 0
Lhre_33_l:
    v_mov_b32 v45, 0
    s_add_u32 s53, s53, 1
    s_cmp_gt_u32 s53, 0x20000
    s_cbranch_scc1 L_exit
    s_and_b32 s48, s53, 7
    s_cmp_lg_u32 s48, 0
    s_mov_b32 s48, 0
    s_cbranch_scc1 Lhre_33_d
    buffer_load_dword v44, v45, s[4:7], s56 offen sc1
    s_waitcnt vmcnt(0)
    v_readfirstlane_b32 s48, v44
Lhre_33_d:
    s_mov_b32 m0, s0
    s_nop 0
    buffer_load_dwordx4 v1, s[4:7], s57 offen offset:0 sc1 lds
    buffer_load_dwordx4 v1, s[4:7], s57 offen offset:1024 sc1 lds
    buffer_load_dwordx4 v1, s[4:7], s57 offen offset:2048 sc1 lds
    buffer_load_dwordx4 v1, s[4:7], s57 offen offset:3072 sc1 lds
    s_waitcnt vmcnt(0)
    s_cmp_ge_u32 s48, 512
    s_cbranch_scc1 Lhok_34
    ds_read_b128 v[44:47], v12 offset:32896
    ds_read_b128 v[48:51], v12 offset:33920
    ds_read_b128 v[52:55], v12 offset:34944
    ds_read_b128 v[56:59], v12 offset:35968
    s_waitcnt lgkmcnt(0)
    v_max3_u32 v44, v44, v45, v46
    v_max3_u32 v47, v47, v48, v49
    v_max3_u32 v50, v50, v51, v52
    v_max3_u32 v53, v53, v54, v55
    v_max3_u32 v56, v56, v57, v58
    v_max3_u32 v44, v44, v47, v50
    v_max3_u32 v53, v53, v56, v59
    v_max_u32 v44, v44, v53
    v_cmp_eq_u32 vcc, -1, v44
    s_cbranch_vccz Lhok_34
    s_branch Lhre_33_l
Lhre_35:
    s_mov_b32 s53, 0
Lhre_35_l:
    v_mov_b32 v97, 0
    s_add_u32 s53, s53, 1
    s_cmp_gt_u32 s53, 0x20000
    s_cbranch_scc1 L_exit
    s_and_b32 s48, s53, 7
    s_cmp_lg_u32 s48, 0
    s_mov_b32 s48, 0
    s_cbranch_scc1 Lhre_35_d
    buffer_load_dword v96, v97, s[4:7], s58 offen sc1
    s_waitcnt vmcnt(0)
    v_readfirstlane_b32 s48, v96
Lhre_35_d:
    s_mov_b32 m0, s47
    s_nop 0
    buffer_load_dwordx4 v1, s[4:7], s59 offen offset:0 sc1 lds
    buffer_load_dwordx4 v1, s[4:7], s59 offen offset:1024 sc1 lds
    buffer_load_dwordx4 v1, s[4:7], s59 offen offset:2048 sc1 lds
    buffer_load_dwordx4 v1, s[4:7], s59 offen offset:3072 sc1 lds
    s_waitcnt vmcnt(0)
    s_cmp_ge_u32 s48, 512
    s_cbranch_scc1 Lhok_36
    ds_read_b128 v[96:99], v12 offset:0
    ds_read_b128 v[100:103], v12 offset:1024
    ds_read_b128 v[104:107], v12 offset:2048
    ds_read_b128 v[108:111], v12 offset:3072
    s_waitcnt lgkmcnt(0)
    v_max3_u32 v96, v96, v97, v98
    v_max3_u32 v99, v99, v100, v101
    v_max3_u32 v102, v102, v103, v104
    v_max3_u32 v105, v105, v106, v107
    v_max3_u32 v108, v108, v109, v110
    v_max3_u32 v96, v96, v99, v102
    v_max3_u32 v105, v105, v108, v111
    v_max_u32 v96, v96, v105
    v_cmp_eq_u32 vcc, -1, v96
    s_cbranch_vccz Lhok_36
    s_branch Lhre_35_l
Lsafe_37:
    s_waitcnt vmcnt(0) lgkmcnt(0)
    s_nop 15
    s_mov_b32 s43, 0
Lsafe_37_h:
    s_cmp_eq_u32 s43, 1
    s_cselect_b64 vcc, -1, 0
    v_cndmask_b32 v60, v20, v24, vcc
    v_cndmask_b32 v61, v21, v25, vcc
    v_cndmask_b32 v62, v22, v26, vcc
    v_cndmask_b32 v63, v23, v27, vcc
    v_mov_b32 v52, 0xff800000
    v_mov_b32 v80, 0
    v_mov_b32 v81, 0
    v_mov_b32 v82, 0
    v_mov_b32 v83, 0
    v_mov_b32 v84, 0
    v_mov_b32 v85, 0
    v_mov_b32 v86, 0
    v_mov_b32 v87, 0
    v_mov_b32 v88, 0
    v_mov_b32 v89, 0
    v_mov_b32 v90, 0
    v_mov_b32 v91, 0
    v_mov_b32 v92, 0
    v_mov_b32 v93, 0
    v_mov_b32 v94, 0
    v_mov_b32 v95, 0
    s_mov_b32 s53, 0
Lsafe_37_p:
    s_mov_b32 s44, 0
Lsafe_37_b:
    s_add_u32 s45, s44, s38
    s_add_u32 s46, s44, 3
    s_cmp_lt_u32 s44, 5
    s_cselect_b32 s45, s45, s46
    s_lshr_b32 s46, s45, 2
    s_mov_b32 s47, 0
    s_cmp_eq_u32 s46, 0
    s_cselect_b32 s47, 2, s47
    s_cmp_eq_u32 s46, 2
    s_cselect_b32 s47, 1, s47
    s_cmp_lt_u32 s36, s47
    s_cbranch_scc1 Lsafe_37_n
    s_mul_i32 s45, s45, 4112
    v_add_u32 v54, s45, v18
    s_lshl_b32 s46, s43, 10
    v_add_u32 v53, s46, v54
    ds_read_b128 v[64:67], v53
    v_bfe_u32 v53, v0, 4, 1
    v_cmp_eq_u32 vcc, s43, v53
    v_sub_u32 v53, v54, v1
    v_add_u32 v53, 4096, v53
    v_add_u32 v55, 2048, v54
    v_cndmask_b32 v55, v53, v55, vcc
    ds_read_b128 v[72:75], v55
    v_add_u32 v56, 3072, v54
    v_cndmask_b32 v56, v53, v56, vcc
    ds_read_b128 v[76:79], v56
    s_waitcnt lgkmcnt(2)
    v_mfma_f32_32x32x16_bf16 v[28:43], v[64:67], v[60:63], 0
    s_cmp_lg_u32 s44, 0
    s_cselect_b64 s[46:47], -1, 0
    s_cmp_lg_u32 s44, 4
    s_cselect_b64 s[48:49], -1, 0
    v_mov_b32 v53, 0xff800000
    s_and_b64 vcc, s[60:61], s[46:47]
    s_andn2_b64 s[96:97], s[48:49], s[60:61]
    s_or_b64 vcc, vcc, s[96:97]
    s_nop 3
    v_cndmask_b32 v28, v53, v28, vcc
    s_and_b64 vcc, s[62:63], s[46:47]
    s_andn2_b64 s[96:97], s[48:49], s[62:63]
    s_or_b64 vcc, vcc, s[96:97]
    v_cndmask_b32 v29, v53, v29, vcc
    s_and_b64 vcc, s[64:65], s[46:47]
    s_andn2_b64 s[96:97], s[48:49], s[64:65]
    s_or_b64 vcc, vcc, s[96:97]
    v_cndmask_b32 v30, v53, v30, vcc
    s_and_b64 vcc, s[66:67], s[46:47]
    s_andn2_b64 s[96:97], s[48:49], s[66:67]
    s_or_b64 vcc, vcc, s[96:97]
    v_cndmask_b32 v31, v53, v31, vcc
    s_and_b64 vcc, s[68:69], s[46:47]
    s_andn2_b64 s[96:97], s[48:49], s[68:69]
    s_or_b64 vcc, vcc, s[96:97]
    v_cndmask_b32 v32, v53, v32, vcc
    s_and_b64 vcc, s[70:71], s[46:47]
    s_andn2_b64 s[96:97], s[48:49], s[70:71]
    s_or_b64 vcc, vcc, s[96:97]
    v_cndmask_b32 v33, v53, v33, vcc
    s_and_b64 vcc, s[72:73], s[46:47]
    s_andn2_b64 s[96:97], s[48:49], s[72:73]
    s_or_b64 vcc, vcc, s[96:97]
    v_cndmask_b32 v34, v53, v34, vcc
    s_and_b64 vcc, s[74:75], s[46:47]
    s_andn2_b64 s[96:97], s[48:49], s[74:75]
    s_or_b64 vcc, vcc, s[96:97]
    v_cndmask_b32 v35, v53, v35, vcc
    s_and_b64 vcc, s[76:77], s[46:47]
    s_andn2_b64 s[96:97], s[48:49], s[76:77]
    s_or_b64 vcc, vcc, s[96:97]
    v_cndmask_b32 v36, v53, v36, vcc
    s_and_b64 vcc, s[78:79], s[46:47]
    s_andn2_b64 s[96:97], s[48:49], s[78:79]
    s_or_b64 vcc, vcc, s[96:97]
    v_cndmask_b32 v37, v53, v37, vcc
    s_and_b64 vcc, s[80:81], s[46:47]
    s_andn2_b64 s[96:97], s[48:49], s[80:81]
    s_or_b64 vcc, vcc, s[96:97]
    v_cndmask_b32 v38, v53, v38, vcc
    s_and_b64 vcc, s[82:83], s[46:47]
    s_andn2_b64 s[96:97], s[48:49], s[82:83]
    s_or_b64 vcc, vcc, s[96:97]
    v_cndmask_b32 v39, v53, v39, vcc
    s_and_b64 vcc, s[84:85], s[46:47]
    s_andn2_b64 s[96:97], s[48:49], s[84:85]
    s_or_b64 vcc, vcc, s[96:97]
    v_cndmask_b32 v40, v53, v40, vcc
    s_and_b64 vcc, s[86:87], s[46:47]
    s_andn2_b64 s[96:97], s[48:49], s[86:87]
    s_or_b64 vcc, vcc, s[96:97]
    v_cndmask_b32 v41, v53, v41, vcc
    s_and_b64 vcc, s[88:89], s[46:47]
    s_andn2_b64 s[96:97], s[48:49], s[88:89]
    s_or_b64 vcc, vcc, s[96:97]
    v_cndmask_b32 v42, v53, v42, vcc
    s_and_b64 vcc, s[90:91], s[46:47]
    s_andn2_b64 s[96:97], s[48:49], s[90:91]
    s_or_b64 vcc, vcc, s[96:97]
    v_cndmask_b32 v43, v53, v43, vcc
    s_cmp_eq_u32 s53, 1
    s_cbranch_scc1 Lsafe_37_2
    v_max3_f32 v52, v28, v29, v52
    v_max3_f32 v52, v30, v31, v52
    v_max3_f32 v52, v32, v33, v52
    v_max3_f32 v52, v34, v35, v52
    v_max3_f32 v52, v36, v37, v52
    v_max3_f32 v52, v38, v39, v52
    v_max3_f32 v52, v40, v41, v52
    v_max3_f32 v52, v42, v43, v52
    s_branch Lsafe_37_n
Lsafe_37_2:
    v_sub_f32 v28, v28, v52
    v_sub_f32 v29, v29, v52
    v_sub_f32 v30, v30, v52
    v_sub_f32 v31, v31, v52
    v_sub_f32 v32, v32, v52
    v_sub_f32 v33, v33, v52
    v_sub_f32 v34, v34, v52
    v_sub_f32 v35, v35, v52
    v_sub_f32 v36, v36, v52
    v_sub_f32 v37, v37, v52
    v_sub_f32 v38, v38, v52
    v_sub_f32 v39, v39, v52
    v_sub_f32 v40, v40, v52
    v_sub_f32 v41, v41, v52
    v_sub_f32 v42, v42, v52
    v_sub_f32 v43, v43, v52
    v_exp_f32 v28, v28
    v_exp_f32 v29, v29
    v_exp_f32 v30, v30
    v_exp_f32 v31, v31
    v_exp_f32 v32, v32
    v_exp_f32 v33, v33
    v_exp_f32 v34, v34
    v_exp_f32 v35, v35
    v_exp_f32 v36, v36
    v_exp_f32 v37, v37
    v_exp_f32 v38, v38
    v_exp_f32 v39, v39
    v_exp_f32 v40, v40
    v_exp_f32 v41, v41
    v_exp_f32 v42, v42
    v_exp_f32 v43, v43
    v_cvt_pk_bf16_f32 v44, v28, v29
    v_cvt_pk_bf16_f32 v45, v30, v31
    v_cvt_pk_bf16_f32 v46, v32, v33
    v_cvt_pk_bf16_f32 v47, v34, v35
    v_cvt_pk_bf16_f32 v48, v36, v37
    v_cvt_pk_bf16_f32 v49, v38, v39
    v_cvt_pk_bf16_f32 v50, v40, v41
    v_cvt_pk_bf16_f32 v51, v42, v43
    s_waitcnt lgkmcnt(1)
    v_mfma_f32_32x32x16_bf16 v[80:95], v[72:75], v[44:47], v[80:95]
    s_waitcnt lgkmcnt(0)
    v_mfma_f32_32x32x16_bf16 v[80:95], v[76:79], v[48:51], v[80:95]
Lsafe_37_n:
    s_waitcnt lgkmcnt(0)
    s_nop 15
    s_add_u32 s44, s44, 1
    s_cmp_lt_u32 s44, 9
    s_cbranch_scc1 Lsafe_37_b
    v_mov_b32 v53, v52
    s_nop 1
    v_permlane32_swap_b32 v53, v52
    v_max_f32 v52, v52, v53
    s_add_u32 s53, s53, 1
    s_cmp_lt_u32 s53, 2
    s_cbranch_scc1 Lsafe_37_p
    s_cmp_eq_u32 s43, 1
    s_cselect_b64 vcc, -1, 0
    v_cndmask_b32 v53, v88, v80, vcc
    v_rcp_f32 v53, v53
    v_cndmask_b32 v28, v80, v88, vcc
    v_cndmask_b32 v29, v81, v89, vcc
    v_cndmask_b32 v30, v82, v90, vcc
    v_cndmask_b32 v31, v83, v91, vcc
    v_cndmask_b32 v32, v84, v92, vcc
    v_cndmask_b32 v33, v85, v93, vcc
    v_cndmask_b32 v34, v86, v94, vcc
    v_cndmask_b32 v35, v87, v95, vcc
    v_mul_f32 v28, v28, v53
    v_mul_f32 v29, v29, v53
    v_mul_f32 v30, v30, v53
    v_mul_f32 v31, v31, v53
    v_mul_f32 v32, v32, v53
    v_mul_f32 v33, v33, v53
    v_mul_f32 v34, v34, v53
    v_mul_f32 v35, v35, v53
    v_cvt_pk_bf16_f32 v44, v28, v29
    v_cvt_pk_bf16_f32 v45, v30, v31
    v_cvt_pk_bf16_f32 v46, v32, v33
    v_cvt_pk_bf16_f32 v47, v34, v35
    s_lshl_b32 s46, s43, 10
    s_add_u32 s46, s46, s55
    buffer_store_dwordx4 v[44:47], v1, s[4:7], s46 offen sc1
    s_waitcnt vmcnt(0)
    s_add_u32 s43, s43, 1
    s_cmp_lt_u32 s43, 2
    s_cbranch_scc1 Lsafe_37_h
    s_branch Lsafeback_38
Lspin_39:
    s_mov_b32 s53, 0
Lspin_39_l:
    buffer_load_dword v92, v16, s[4:7], s59 offen sc1
    s_add_u32 s53, s53, 1
    s_cmp_gt_u32 s53, 0x40000
    s_cbranch_scc1 L_exit
    s_waitcnt vmcnt(0)
    v_cmp_gt_u32 vcc, 2, v92
    s_cbranch_vccz Lback_40

    s_branch Lspin_39_l
Lspin_41:
    s_waitcnt vmcnt(2)
    v_cmp_gt_u32 vcc, 2, v150
    s_cbranch_vccz Lback_42
    s_waitcnt vmcnt(0)
    v_cmp_gt_u32 vcc, 2, v151
    s_cbranch_vccz Lback_42
    s_mov_b32 s53, 0
Lspin_41_l:
    buffer_load_dword v18, v16, s[4:7], s59 offen sc1
    s_add_u32 s53, s53, 1
    s_cmp_gt_u32 s53, 0x40000
    s_cbranch_scc1 L_exit
    s_waitcnt vmcnt(0)
    v_cmp_gt_u32 vcc, 2, v18
    s_cbranch_vccz Lback_42
    s_branch Lspin_41_l
Lspin_43:
    s_mov_b32 s53, 0
Lspin_43_l:
    buffer_load_dword v18, v15, s[4:7], s101 offen sc1
    s_add_u32 s53, s53, 1
    s_cmp_gt_u32 s53, 0x40000
    s_cbranch_scc1 L_exit
    s_waitcnt vmcnt(0)
    v_cmp_gt_u32 vcc, 2, v18
    s_cbranch_vccz Lback_44

    s_branch Lspin_43_l
Lspin_45:
    s_mov_b32 s53, 0
Lspin_45_l:
    buffer_load_dword v112, v16, s[4:7], s59 offen sc1
    s_add_u32 s53, s53, 1
    s_cmp_gt_u32 s53, 0x40000
    s_cbranch_scc1 L_exit
    s_waitcnt vmcnt(0)
    v_cmp_gt_u32 vcc, 2, v112
    s_cbranch_vccz Lback_46

    s_branch Lspin_45_l
Lspin_47:
    s_mov_b32 s53, 0
Lspin_47_l:
    buffer_load_dword v18, v16, s[4:7], s0 offen sc1
    s_add_u32 s53, s53, 1
    s_cmp_gt_u32 s53, 0x40000
    s_cbranch_scc1 L_exit
    s_waitcnt vmcnt(0)
    v_cmp_gt_u32 vcc, 2, v18
    s_cbranch_vccz Lback_48

    s_branch Lspin_47_l
Lspin_49:
    s_mov_b32 s53, 0
Lspin_49_l:
    buffer_load_dword v18, v16, s[4:7], s0 offen sc1
    s_add_u32 s53, s53, 1
    s_cmp_gt_u32 s53, 0x40000
    s_cbranch_scc1 L_exit
    s_waitcnt vmcnt(0)
    v_cmp_gt_u32 vcc, 2, v18
    s_cbranch_vccz Lback_50

    s_branch Lspin_49_l
Lslow_51:
    buffer_store_dwordx4 v[88:91], v1, s[4:7], s55 offen offset:0 sc1
    s_branch Ldual_51
Lslow_52:
    buffer_store_dwordx4 v[28:31], v1, s[4:7], s55 offen offset:1024 sc1
    s_branch Ldual_52
Lslow_53:
    buffer_store_dword v17, v19, s[4:7], s42 offen offset:0 sc1
    s_branch Ldual_53
Lslow_54:
    buffer_store_dwordx4 v[4:7], v1, s[4:7], s54 offen sc1
    s_branch Ldual_54
Lslow_55:
    buffer_store_dword v17, v19, s[4:7], s56 offen offset:0 sc1
    s_branch Ldual_55
Lslow_56:
    buffer_store_dwordx4 v[8:11], v1, s[4:7], s54 offen sc1
    s_branch Ldual_56
Lslow_57:
    buffer_store_dwordx2 v[100:101], v109, s[4:7], s48 offen sc1
    s_branch Ldual_57
Lslow_58:
    buffer_store_dword v17, v19, s[4:7], s56 offen offset:256 sc1
    s_branch Ldual_58
Lslow_59:
    buffer_store_dword v17, v19, s[4:7], s3 offen offset:2304 sc1
    s_branch Ldual_59
Lslow_60:
    buffer_store_dword v17, v19, s[4:7], s94 offen offset:1536 sc1
    s_branch Ldual_60
Lslow_61:
    buffer_store_dword v17, v19, s[4:7], s94 offen offset:2048 sc1
    s_branch Ldual_61
Lslow_62:
    buffer_store_dwordx4 v[4:7], v1, s[4:7], s54 offen sc1
    s_branch Ldual_62
Lslow_63:
    buffer_store_dword v17, v19, s[4:7], s56 offen offset:0 sc1
    s_branch Ldual_63
Lslow_64:
    buffer_store_dwordx4 v[8:11], v1, s[4:7], s54 offen sc1
    s_branch Ldual_64
Lslow_65:
    buffer_store_dwordx2 v[52:53], v61, s[4:7], s48 offen sc1
    s_branch Ldual_65
Lslow_66:
    buffer_store_dword v17, v19, s[4:7], s56 offen offset:256 sc1
    s_branch Ldual_66
Lslow_67:
    buffer_store_dword v156, v157, s[4:7], s3 offen offset:2432 sc1
    s_branch Ldual_67
Lslow_68:
    buffer_store_dwordx4 v[88:91], v1, s[4:7], s55 offen offset:0 sc1
    s_branch Ldual_68
Lslow_69:
    buffer_store_dwordx4 v[28:31], v1, s[4:7], s55 offen offset:1024 sc1
    s_branch Ldual_69
Lslow_70:
    buffer_store_dword v17, v19, s[4:7], s42 offen offset:0 sc1
    s_branch Ldual_70
Lslow_71:
    buffer_store_dwordx4 v[4:7], v1, s[4:7], s54 offen sc1
    s_branch Ldual_71
Lslow_72:
    buffer_store_dword v17, v19, s[4:7], s56 offen offset:0 sc1
    s_branch Ldual_72
Lslow_73:
    buffer_store_dwordx4 v[8:11], v1, s[4:7], s54 offen sc1
    s_branch Ldual_73
Lslow_74:
    buffer_store_dwordx2 v[100:101], v109, s[4:7], s48 offen sc1
    s_branch Ldual_74
Lslow_75:
    buffer_store_dword v17, v19, s[4:7], s56 offen offset:256 sc1
    s_branch Ldual_75
Lslow_76:
    buffer_store_dword v17, v19, s[4:7], s3 offen offset:2304 sc1
    s_branch Ldual_76
Lslow_77:
    buffer_store_dwordx4 v[116:119], v1, s[4:7], s93 offen offset:0 sc1
    buffer_store_dwordx4 v[120:123], v1, s[4:7], s93 offen offset:1024 sc1
    s_branch Ldual_77
Lslow_78:
    buffer_store_dwordx4 v[116:119], v1, s[4:7], s93 offen offset:0 sc1
    buffer_store_dwordx4 v[120:123], v1, s[4:7], s93 offen offset:1024 sc1
    s_branch Ldual_78
Lslow_79:
    buffer_store_dword v17, v19, s[4:7], s94 offen offset:1536 sc1
    s_branch Ldual_79
Lslow_80:
    buffer_store_dwordx4 v[116:119], v1, s[4:7], s93 offen offset:0 sc1
    buffer_store_dwordx4 v[120:123], v1, s[4:7], s93 offen offset:1024 sc1
    s_branch Ldual_80
Lslow_81:
    buffer_store_dwordx4 v[116:119], v1, s[4:7], s93 offen offset:0 sc1
    buffer_store_dwordx4 v[120:123], v1, s[4:7], s93 offen offset:1024 sc1
    s_branch Ldual_81
Lslow_82:
    buffer_store_dword v17, v19, s[4:7], s94 offen offset:2048 sc1
    s_branch Ldual_82
L_codeend:
    s_endpgm
.section .rodata,"a"
.p2align 6
.amdhsa_kernel interleave_layers__sliding_block__dense_activation_silu__prompt_kernel
  .amdhsa_next_free_vgpr 512
  .amdhsa_next_free_sgpr 102
  .amdhsa_accum_offset 256
  .amdhsa_group_segment_fixed_size 0
  .amdhsa_kernarg_size 72
  .amdhsa_user_sgpr_count 2
  .amdhsa_user_sgpr_kernarg_segment_ptr 1
  .amdhsa_system_sgpr_workgroup_id_x 1
.end_amdhsa_kernel
```
